```python
import torch

def _softmax(x, axis=-1):
    return torch.softmax(x, dim=axis)
def _gelu(x):
    return torch.nn.functional.gelu(x, approximate="tanh")
def _silu(x):
    return torch.nn.functional.silu(x)
def _sigmoid(x):
    return torch.sigmoid(x)
def _layernorm(x, axis=-1, eps=1e-5):
    m = x.mean(dim=axis, keepdim=True)
    v = x.var(dim=axis, keepdim=True, unbiased=False)
    return (x - m) / torch.sqrt(v + eps)
def _scatter_add(tgt, idx, src, axis=0):
    return tgt.clone().index_add_(axis, idx, src)
def _segment_sum(src, seg, n):
    out = torch.zeros((n,) + src.shape[1:], dtype=src.dtype)
    return out.index_add_(0, seg, src)
def _pad(x, pw):
    flat = tuple(v for pair in reversed(pw) for v in pair)
    return torch.nn.functional.pad(x, flat)

kernel_name = 'parallel_sum__linear_kernel_hedgehog__dense_activation_silu__prompt'

def setup_inputs():

    _w = (lambda a: (lambda t: t.to(torch.bfloat16) if t.is_floating_point() else t)(torch.as_tensor(a)))
    def _A_setup():
        B, S, D, H = 1, 2048, 512, 32
        Dh = D // H
        return {
            "x": _w((lambda *s: torch.randn(*s, dtype=torch.bfloat16) * 0.05)(B, S, D)),
            "wqkv": _w((lambda *s: torch.randn(*s, dtype=torch.bfloat16) * 0.2)(D, 3 * D)),
            "w_phi": _w((lambda *s: torch.randn(*s, dtype=torch.bfloat16) * 0.2)(H, Dh, Dh) * (Dh ** -0.5)),
            "wo": _w((lambda *s: torch.randn(*s, dtype=torch.bfloat16) * 0.05)(D, D)),
        }
    _A_in = _A_setup()

    def _B_setup():
        B, S, D, F = 1, 2048, 512, 1792
        return {
            "x": _w((lambda *s: torch.randn(*s, dtype=torch.bfloat16) * 0.05)(B, S, D)),
            "w1": _w((lambda *s: torch.randn(*s, dtype=torch.bfloat16) * 0.8)(D, F) * (D ** -0.5)),
            "w2": _w((lambda *s: torch.randn(*s, dtype=torch.bfloat16) * 0.1)(F, D) * (F ** -0.5)),
        }
    _B_in = _B_setup()

    return {
        "A_x": _A_in["x"],
        "A_wqkv": _A_in["wqkv"],
        "A_w_phi": _A_in["w_phi"],
        "A_wo": _A_in["wo"],
        "B_x": _B_in["x"],
        "B_w1": _B_in["w1"],
        "B_w2": _B_in["w2"],
    }

def reference(A_x, A_wqkv, A_w_phi, A_wo, B_x, B_w1, B_w2):
    def _A_ref(x, wqkv, w_phi, wo):
        B, S, D = x.shape
        H = 32; Dh = D // H
        qkv = (lambda x, *d: x.permute(*d))((x @ wqkv).reshape(B, S, 3, H, Dh), 2, 0, 3, 1, 4)
        q, k, v = qkv[0], qkv[1], qkv[2]
        pq = torch.einsum("bhsd,hdf->bhsf", q, w_phi)
        pk = torch.einsum("bhsd,hdf->bhsf", k, w_phi)
        phi_q = torch.concatenate([_softmax(pq, axis=-1), _softmax(-pq, axis=-1)], axis=-1)
        phi_k = torch.concatenate([_softmax(pk, axis=-1), _softmax(-pk, axis=-1)], axis=-1)
        kv = torch.einsum("bhsf,bhsd->bhfd", phi_k, v)
        z  = torch.einsum("bhsf->bhf", phi_k)
        num = torch.einsum("bhqf,bhfd->bhqd", phi_q, kv)
        den = torch.einsum("bhqf,bhf->bhq", phi_q, z)[..., None] + 1e-6
        o = num / den
        return (lambda x, *d: x.permute(*d))(o, 0, 2, 1, 3).reshape(B, S, D) @ wo

    def _B_ref(x, w1, w2):
        h = torch.einsum("bsd,df->bsf", x, w1)
        h = _silu(h)
        out = torch.einsum("bsf,fd->bsd", h, w2)
        return out

    x = A_x
    xn = _layernorm(x, axis=-1)
    return x + _A_ref(xn, A_wqkv, A_w_phi, A_wo) + _B_ref(xn, B_w1, B_w2)
```

```asm
; @launch kernel=hh_k1_kernel grid=(256,1,1) block=(512,1,1) lds=156672
; @launch kernel=hh_k2_kernel grid=(256,1,1) block=(512,1,1) lds=147456
.amdgcn_target "amdgcn-amd-amdhsa--gfx950"
.text
.globl hh_k1_kernel
.p2align 8
.type hh_k1_kernel,@function
hh_k1_kernel:
    s_cmp_ge_u32 s2, 0x100
    s_cbranch_scc1 hh_k1_exit
    s_load_dwordx4 s[4:7], s[0:1], 0
    s_load_dwordx4 s[8:11], s[0:1], 16
    s_load_dwordx4 s[12:15], s[0:1], 40
    s_load_dwordx2 s[16:17], s[0:1], 72
    v_lshrrev_b32 v2, 6, v0
    v_and_b32 v1, 63, v0
    v_readfirstlane_b32 s44, v2
    s_and_b32 s50, s2, 7
    s_lshr_b32 s51, s2, 3
    s_getpc_b64 s[70:71]
hh_k1_pc:
    s_sub_u32 s70, s70, hh_k1_pc-hh_k1_kernel
    s_subb_u32 s71, s71, 0
    s_and_b32 s52, s51, 7
    s_lshl_b32 s52, s52, 13
    v_lshrrev_b32 v3, 3, v0
    v_lshl_add_u32 v3, v3, 7, s52
    v_min_u32 v3, hh_code_end-hh_k1_kernel-4, v3
    global_load_dword v4, v3, s[70:71]
    s_and_b32 s52, s50, 1
    s_lshl_b32 s52, s52, 3
    s_and_b32 s53, s51, 7
    s_or_b32 s47, s52, s53
    s_lshr_b32 s49, s51, 4
    s_lshr_b32 s52, s50, 1
    s_lshl_b32 s52, s52, 1
    s_bfe_u32 s53, s51, 0x10003
    s_or_b32 s48, s52, s53
    s_and_b32 s45, s44, 3
    s_lshr_b32 s46, s44, 2
    s_lshl_b32 s52, s2, 3
    s_add_u32 s61, s52, s44
    s_mov_b32 s60, 0x3f803f80
    s_lshl_b32 s52, s49, 1
    s_add_u32 s52, s52, s46
    s_cmp_eq_u32 s52, 1
    s_cbranch_scc1 hh_k1_r1
    s_cmp_eq_u32 s52, 2
    s_cbranch_scc1 hh_k1_r2
    s_cmp_eq_u32 s52, 3
    s_cbranch_scc1 hh_k1_r3
hh_k1_r0:
    v_lshrrev_b32 v10, 3, v1
    v_lshrrev_b32 v11, 4, v1
    v_and_b32 v12, 7, v1
    s_lshl_b32 s52, s44, 4
    v_add_u32 v13, s52, v10
    v_lshlrev_b32 v5, 10, v13
    v_xor_b32 v13, v12, v11
    v_lshl_add_u32 v5, v13, 4, v5
    v_add_u32 v13, s52, v10
    v_add_u32 v13, 8, v13
    v_lshlrev_b32 v6, 10, v13
    v_xor_b32 v13, v12, v11
    v_xor_b32 v13, 4, v13
    v_lshl_add_u32 v6, v13, 4, v6
    s_add_u32 s53, s44, 4
    s_and_b32 s53, s53, 7
    s_lshl_b32 s59, s53, 10
    s_add_u32 s59, s59, 0xc000
    s_lshl_b32 s58, s44, 11
    s_lshl_b32 s53, s53, 6
    v_add_u32 v10, s53, v1
    v_mul_u32_u24 v11, 0x925, v10
    v_lshrrev_b32 v11, 16, v11
    v_mul_u32_u24 v12, 28, v11
    v_sub_u32 v12, v10, v12
    v_mul_u32_u24 v7, 0xc00, v11
    v_lshrrev_b32 v13, 3, v12
    v_lshl_add_u32 v7, v13, 10, v7
    v_and_b32 v13, 7, v12
    v_lshl_add_u32 v7, v13, 4, v7
    v_cmp_le_u32 vcc, 24, v12
    v_mov_b32 v13, 0x80000000
    s_nop 0
    v_cndmask_b32 v7, v7, v13, vcc
    v_add_u32 v10, s53, v1
    v_add_u32 v10, 0x200, v10
    v_mul_u32_u24 v11, 0x925, v10
    v_lshrrev_b32 v11, 16, v11
    v_mul_u32_u24 v12, 28, v11
    v_sub_u32 v12, v10, v12
    v_mul_u32_u24 v8, 0xc00, v11
    v_lshrrev_b32 v13, 3, v12
    v_lshl_add_u32 v8, v13, 10, v8
    v_and_b32 v13, 7, v12
    v_lshl_add_u32 v8, v13, 4, v8
    v_cmp_le_u32 vcc, 24, v12
    v_mov_b32 v13, 0x80000000
    s_nop 0
    v_cndmask_b32 v8, v8, v13, vcc
    v_add_u32 v10, s53, v1
    v_add_u32 v10, 0x400, v10
    v_mul_u32_u24 v11, 0x925, v10
    v_lshrrev_b32 v11, 16, v11
    v_mul_u32_u24 v12, 28, v11
    v_sub_u32 v12, v10, v12
    v_mul_u32_u24 v9, 0xc00, v11
    v_lshrrev_b32 v13, 3, v12
    v_lshl_add_u32 v9, v13, 10, v9
    v_and_b32 v13, 7, v12
    v_lshl_add_u32 v9, v13, 4, v9
    v_cmp_le_u32 vcc, 24, v12
    v_mov_b32 v13, 0x80000000
    s_nop 0
    v_cndmask_b32 v9, v9, v13, vcc
    s_mov_b32 s56, 0
    s_mov_b32 s57, 0
    s_waitcnt lgkmcnt(0)
    s_lshl_b32 s52, s47, 17
    s_add_u32 s20, s4, s52
    s_addc_u32 s21, s5, 0
    s_mov_b32 s22, 0x20000
    s_mov_b32 s23, 0x20000
    s_lshl_b32 s52, s48, 7
    s_add_u32 s24, s6, s52
    s_addc_u32 s25, s7, 0
    s_mov_b32 s26, 0x17fc80
    s_mov_b32 s27, 0x20000
    s_mov_b32 s28, s16
    s_mov_b32 s29, s17
    s_mov_b32 s30, 0x1600000
    s_mov_b32 s31, 0x20000
    s_mov_b32 s56, 0
    s_add_u32 m0, s58, 0
    s_nop 0
    buffer_load_dwordx4 v5, s[20:23], s56 offen lds
    s_mov_b32 s56, 0
    s_add_u32 m0, s58, 0x400
    s_nop 0
    buffer_load_dwordx4 v6, s[20:23], s56 offen lds
    s_mov_b32 s57, 0
    s_add_u32 m0, s59, 0
    s_nop 0
    buffer_load_dwordx4 v7, s[24:27], s57 offen lds
    s_mov_b32 s57, 0
    s_add_u32 m0, s59, 0x2000
    s_nop 0
    buffer_load_dwordx4 v8, s[24:27], s57 offen lds
    s_mov_b32 s57, 0
    s_add_u32 m0, s59, 0x4000
    s_nop 0
    buffer_load_dwordx4 v9, s[24:27], s57 offen lds
    s_barrier
    v_and_b32 v10, 31, v1
    s_lshl_b32 s52, s45, 5
    v_add_u32 v10, s52, v10
    v_lshlrev_b32 v10, 7, v10
    v_lshrrev_b32 v11, 5, v1
    v_bfe_u32 v12, v1, 1, 3
    v_xor_b32 v11, v11, v12
    v_lshl_add_u32 v10, v11, 4, v10
    v_lshrrev_b32 v11, 5, v1
    v_bfe_u32 v12, v1, 2, 2
    v_lshl_add_u32 v11, v11, 3, v12
    v_mul_u32_u24 v11, 0x1c0, v11
    v_bfe_u32 v12, v1, 4, 1
    v_lshl_add_u32 v11, v12, 5, v11
    v_and_b32 v12, 3, v1
    v_lshl_add_u32 v11, v12, 3, v11
    v_add_u32 v11, 0xc000, v11
    s_add_u32 s52, s45, 0
    s_and_b32 s52, s52, 3
    s_lshl_b32 s53, s52, 5
    v_xor_b32 v14, s53, v10
    s_mul_i32 s53, s52, 0x1c00
    v_add_u32 v18, s53, v11
    v_add_u32 v22, 0xe000, v18
    s_add_u32 s52, s45, 1
    s_and_b32 s52, s52, 3
    s_lshl_b32 s53, s52, 5
    v_xor_b32 v15, s53, v10
    s_mul_i32 s53, s52, 0x1c00
    v_add_u32 v19, s53, v11
    v_add_u32 v23, 0xe000, v19
    s_add_u32 s52, s45, 2
    s_and_b32 s52, s52, 3
    s_lshl_b32 s53, s52, 5
    v_xor_b32 v16, s53, v10
    s_mul_i32 s53, s52, 0x1c00
    v_add_u32 v20, s53, v11
    v_add_u32 v24, 0xe000, v20
    s_add_u32 s52, s45, 3
    s_and_b32 s52, s52, 3
    s_lshl_b32 s53, s52, 5
    v_xor_b32 v17, s53, v10
    s_mul_i32 s53, s52, 0x1c00
    v_add_u32 v21, s53, v11
    v_add_u32 v25, 0xe000, v21
    s_mov_b32 s56, 0x80
    s_add_u32 m0, s58, 0x4000
    s_nop 0
    buffer_load_dwordx4 v5, s[20:23], s56 offen lds
    s_mov_b32 s56, 0x80
    s_add_u32 m0, s58, 0x4400
    s_nop 0
    buffer_load_dwordx4 v6, s[20:23], s56 offen lds
    s_mov_b32 s57, 0x30000
    s_add_u32 m0, s59, 0x7000
    s_nop 0
    buffer_load_dwordx4 v7, s[24:27], s57 offen lds
    s_mov_b32 s57, 0x30000
    s_add_u32 m0, s59, 0x9000
    s_nop 0
    buffer_load_dwordx4 v8, s[24:27], s57 offen lds
    s_mov_b32 s57, 0x30000
    s_add_u32 m0, s59, 0xb000
    s_nop 0
    buffer_load_dwordx4 v9, s[24:27], s57 offen lds
    s_mov_b32 s96, s4
    s_mov_b32 s97, s5
    s_mov_b32 s98, 0
    s_mov_b32 s99, 0x20000
    s_mov_b32 s19, 0
    s_mov_b32 s52, 0
    s_mov_b32 s53, 0
    s_mov_b32 s54, 7
    s_cmp_eq_u32 s45, 0
    s_cselect_b32 s54, 10, s54
    s_cselect_b32 s98, 0x200000, s98
    s_cselect_b32 s19, 0x80, s19
    s_cselect_b32 s52, 8, s52
    s_cselect_b32 s53, 0x2000, s53
    s_cmp_eq_u32 s45, 1
    s_cselect_b32 s96, s6, s96
    s_cselect_b32 s97, s7, s97
    s_cselect_b32 s98, 0x180000, s98
    s_cselect_b32 s19, 0x30000, s19
    s_cselect_b32 s52, 6, s52
    s_cselect_b32 s53, 0x300, s53
    s_cmp_eq_u32 s45, 2
    s_cselect_b32 s96, s12, s96
    s_cselect_b32 s97, s13, s97
    s_cselect_b32 s98, 0x1c0000, s98
    s_cselect_b32 s19, 0x38000, s19
    s_cselect_b32 s52, 7, s52
    s_cselect_b32 s53, 0x380, s53
    s_mul_i32 s53, s53, s2
    v_lshlrev_b32 v26, s54, v1
    v_add_u32 v26, s53, v26
    v_cmp_le_u32 vcc, s52, v1
    v_mov_b32 v11, 0x80000000
    s_nop 0
    v_cndmask_b32 v26, v26, v11, vcc
    v_lshrrev_b32 v11, 2, v1
    v_and_b32 v12, 3, v1
    v_lshlrev_b32 v12, 4, v12
    v_lshl_add_u32 v27, v11, 10, v12
    v_lshlrev_b32 v28, 4, v1
    s_mov_b32 s55, s61
    s_lshr_b32 s52, s55, 4
    s_and_b32 s53, s55, 15
    s_mul_i32 s66, s53, 0x90
    s_add_u32 s66, s66, s52
    s_lshl_b32 s66, s66, 10
    s_add_u32 s66, s66, 0xb00000
    s_cmp_ge_u32 s52, 0x70
    s_cselect_b32 s32, s10, s14
    s_cselect_b32 s33, s11, s15
    s_mov_b32 s55, 0x1c0000
    s_cselect_b32 s34, 0x80000, s55
    s_mov_b32 s35, 0x20000
    s_cselect_b32 s54, 0x70, 0
    s_sub_u32 s54, s52, s54
    s_lshl_b32 s64, s54, 14
    s_lshl_b32 s53, s53, 6
    s_add_u32 s64, s64, s53
    s_add_u32 s55, s61, 0x400
    s_lshr_b32 s52, s55, 4
    s_and_b32 s53, s55, 15
    s_mul_i32 s67, s53, 0x90
    s_add_u32 s67, s67, s52
    s_lshl_b32 s67, s67, 10
    s_add_u32 s67, s67, 0xb00000
    s_cmp_ge_u32 s52, 0x70
    s_cselect_b32 s36, s10, s14
    s_cselect_b32 s37, s11, s15
    s_mov_b32 s55, 0x1c0000
    s_cselect_b32 s38, 0x80000, s55
    s_mov_b32 s39, 0x20000
    s_cselect_b32 s54, 0x70, 0
    s_sub_u32 s54, s52, s54
    s_lshl_b32 s65, s54, 14
    s_lshl_b32 s53, s53, 6
    s_add_u32 s65, s65, s53
    s_lshl_b32 s18, s44, 10
    s_add_u32 s18, s18, 0x21000
    v_lshrrev_b32 v11, 5, v1
    v_bfe_u32 v12, v1, 2, 2
    v_lshl_add_u32 v11, v11, 2, v12
    v_bfe_u32 v12, v1, 4, 1
    v_and_b32 v13, 3, v1
    v_lshl_add_u32 v40, v12, 2, v13
    v_lshlrev_b32 v40, 3, v40
    v_lshl_add_u32 v40, v11, 6, v40
    v_add_u32 v40, s18, v40
    s_mov_b32 s40, s8
    s_mov_b32 s41, s9
    s_mov_b32 s42, 0x4000
    s_mov_b32 s43, 0x20000
    v_lshrrev_b32 v13, 1, v13
    v_lshl_add_u32 v41, v12, 1, v13
    v_lshlrev_b32 v41, 3, v41
    v_lshl_add_u32 v41, v11, 5, v41
    v_bfe_u32 v11, v1, 2, 1
    s_mov_b32 s52, 0x80008000
    v_mul_lo_u32 v42, v11, s52
    s_lshl_b32 s52, s48, 2
    s_add_u32 s52, s52, 0
    s_lshl_b32 s69, s52, 9
    v_add_u32 v41, 0x20000, v41
    v_lshrrev_b32 v11, 4, v1
    v_xor_b32 v11, v11, v1
    v_and_b32 v11, 1, v11
    v_cmp_eq_u32 vcc, 0, v11
    v_mov_b32 v11, 0
    v_mov_b32 v12, 0x3f803f80
    v_cndmask_b32 v148, v11, v12, vcc
    v_cndmask_b32 v149, v11, v12, vcc
    v_cndmask_b32 v150, v11, v12, vcc
    v_cndmask_b32 v151, v11, v12, vcc
    s_mov_b32 s60, 0xffff0000
    v_mov_b32 v132, 0
    v_mov_b32 v133, 0
    v_mov_b32 v134, 0
    v_mov_b32 v135, 0
    s_mul_i32 s54, s19, 3
    buffer_load_dword v4, v26, s[96:99], s54 offen
    s_waitcnt vmcnt(6)
    s_barrier
    ds_read_b128 v[100:103], v14
    ds_read_b64_tr_b16 v[108:109], v18
    ds_read_b64_tr_b16 v[110:111], v18 offset:1792
    ds_read_b64_tr_b16 v[112:113], v18 offset:128
    ds_read_b64_tr_b16 v[114:115], v18 offset:1920
    ds_read_b64_tr_b16 v[116:117], v18 offset:256
    ds_read_b64_tr_b16 v[118:119], v18 offset:2048
    s_waitcnt lgkmcnt(4)
    v_mfma_f32_32x32x16_bf16 v[52:67], v[108:111], v[100:103], 0
    ds_read_b128 v[104:107], v15
    ds_read_b64_tr_b16 v[120:121], v19
    ds_read_b64_tr_b16 v[122:123], v19 offset:1792
    v_mfma_f32_16x16x32_bf16 v[136:139], v[108:111], v[148:151], 0
    v_lshlrev_b32 v152, 16, v100
    v_and_b32 v153, s60, v100
    v_add_f32 v132, v132, v152
    v_add_f32 v134, v134, v153
    s_waitcnt lgkmcnt(5)
    v_mfma_f32_32x32x16_bf16 v[68:83], v[112:115], v[100:103], 0
    ds_read_b64_tr_b16 v[124:125], v19 offset:128
    ds_read_b64_tr_b16 v[126:127], v19 offset:1920
    s_mov_b32 s56, 0x100
    s_add_u32 m0, s58, 0x8000
    s_nop 0
    buffer_load_dwordx4 v5, s[20:23], s56 offen lds
    v_fma_f32 v133, v152, v152, v133
    v_fma_f32 v135, v153, v153, v135
    v_lshlrev_b32 v154, 16, v101
    v_and_b32 v155, s60, v101
    s_waitcnt lgkmcnt(5)
    v_mfma_f32_32x32x16_bf16 v[84:99], v[116:119], v[100:103], 0
    ds_read_b64_tr_b16 v[128:129], v19 offset:256
    ds_read_b64_tr_b16 v[130:131], v19 offset:2048
    v_add_f32 v132, v132, v154
    v_add_f32 v134, v134, v155
    v_fma_f32 v133, v154, v154, v133
    v_fma_f32 v135, v155, v155, v135
    s_waitcnt lgkmcnt(4)
    v_mfma_f32_32x32x16_bf16 v[52:67], v[120:123], v[104:107], v[52:67]
    ds_read_b128 v[100:103], v16
    ds_read_b64_tr_b16 v[108:109], v20
    ds_read_b64_tr_b16 v[110:111], v20 offset:1792
    s_mov_b32 s56, 0x100
    s_add_u32 m0, s58, 0x8400
    s_nop 0
    buffer_load_dwordx4 v6, s[20:23], s56 offen lds
    s_mul_i32 s54, s19, 4
    buffer_load_dword v4, v26, s[96:99], s54 offen
    v_lshlrev_b32 v152, 16, v104
    v_and_b32 v153, s60, v104
    v_add_f32 v132, v132, v152
    v_add_f32 v134, v134, v153
    s_waitcnt lgkmcnt(5)
    v_mfma_f32_32x32x16_bf16 v[68:83], v[124:127], v[104:107], v[68:83]
    ds_read_b64_tr_b16 v[112:113], v20 offset:128
    ds_read_b64_tr_b16 v[114:115], v20 offset:1920
    v_mfma_f32_16x16x32_bf16 v[140:143], v[124:127], v[148:151], 0
    v_fma_f32 v133, v152, v152, v133
    v_fma_f32 v135, v153, v153, v135
    v_lshlrev_b32 v154, 16, v105
    v_and_b32 v155, s60, v105
    s_waitcnt lgkmcnt(5)
    v_mfma_f32_32x32x16_bf16 v[84:99], v[128:131], v[104:107], v[84:99]
    ds_read_b64_tr_b16 v[116:117], v20 offset:256
    ds_read_b64_tr_b16 v[118:119], v20 offset:2048
    s_mov_b32 s57, 0x60000
    s_add_u32 m0, s59, 0xe000
    s_nop 0
    buffer_load_dwordx4 v7, s[24:27], s57 offen lds
    v_add_f32 v132, v132, v154
    v_add_f32 v134, v134, v155
    v_fma_f32 v133, v154, v154, v133
    v_fma_f32 v135, v155, v155, v135
    s_waitcnt lgkmcnt(4)
    v_mfma_f32_32x32x16_bf16 v[52:67], v[108:111], v[100:103], v[52:67]
    ds_read_b128 v[104:107], v17
    ds_read_b64_tr_b16 v[120:121], v21
    ds_read_b64_tr_b16 v[122:123], v21 offset:1792
    v_lshlrev_b32 v152, 16, v100
    v_and_b32 v153, s60, v100
    v_add_f32 v132, v132, v152
    v_add_f32 v134, v134, v153
    s_waitcnt lgkmcnt(5)
    v_mfma_f32_32x32x16_bf16 v[68:83], v[112:115], v[100:103], v[68:83]
    ds_read_b64_tr_b16 v[124:125], v21 offset:128
    ds_read_b64_tr_b16 v[126:127], v21 offset:1920
    s_mov_b32 s57, 0x60000
    s_add_u32 m0, s59, 0x10000
    s_nop 0
    buffer_load_dwordx4 v8, s[24:27], s57 offen lds
    v_fma_f32 v133, v152, v152, v133
    v_fma_f32 v135, v153, v153, v135
    v_lshlrev_b32 v154, 16, v101
    v_and_b32 v155, s60, v101
    s_waitcnt lgkmcnt(5)
    v_mfma_f32_32x32x16_bf16 v[84:99], v[116:119], v[100:103], v[84:99]
    ds_read_b64_tr_b16 v[128:129], v21 offset:256
    ds_read_b64_tr_b16 v[130:131], v21 offset:2048
    s_mov_b32 s57, 0x60000
    s_add_u32 m0, s59, 0x12000
    s_nop 0
    buffer_load_dwordx4 v9, s[24:27], s57 offen lds
    v_mfma_f32_16x16x32_bf16 v[144:147], v[116:119], v[148:151], 0
    v_add_f32 v132, v132, v154
    v_add_f32 v134, v134, v155
    v_fma_f32 v133, v154, v154, v133
    v_fma_f32 v135, v155, v155, v135
    s_waitcnt lgkmcnt(4)
    v_mfma_f32_32x32x16_bf16 v[52:67], v[120:123], v[104:107], v[52:67]
    v_lshlrev_b32 v152, 16, v104
    v_and_b32 v153, s60, v104
    v_add_f32 v132, v132, v152
    v_add_f32 v134, v134, v153
    s_waitcnt lgkmcnt(2)
    v_mfma_f32_32x32x16_bf16 v[68:83], v[124:127], v[104:107], v[68:83]
    s_waitcnt lgkmcnt(0)
    s_waitcnt vmcnt(7)
    s_barrier
    ds_read_b128 v[100:103], v14 offset:16384
    ds_read_b64_tr_b16 v[108:109], v18 offset:28672
    ds_read_b64_tr_b16 v[110:111], v18 offset:30464
    ds_read_b64_tr_b16 v[112:113], v18 offset:28800
    ds_read_b64_tr_b16 v[114:115], v18 offset:30592
    ds_read_b64_tr_b16 v[116:117], v18 offset:28928
    ds_read_b64_tr_b16 v[118:119], v18 offset:30720
    v_fma_f32 v133, v152, v152, v133
    v_fma_f32 v135, v153, v153, v135
    v_lshlrev_b32 v154, 16, v105
    v_and_b32 v155, s60, v105
    v_mfma_f32_32x32x16_bf16 v[84:99], v[128:131], v[104:107], v[84:99]
    v_add_f32 v132, v132, v154
    v_add_f32 v134, v134, v155
    v_fma_f32 v133, v154, v154, v133
    v_fma_f32 v135, v155, v155, v135
    s_waitcnt lgkmcnt(4)
    v_mfma_f32_32x32x16_bf16 v[52:67], v[108:111], v[100:103], v[52:67]
    ds_read_b128 v[104:107], v15 offset:16384
    ds_read_b64_tr_b16 v[120:121], v19 offset:28672
    ds_read_b64_tr_b16 v[122:123], v19 offset:30464
    s_mov_b32 s56, 0x180
    s_add_u32 m0, s58, 0
    s_nop 0
    buffer_load_dwordx4 v5, s[20:23], s56 offen lds
    s_mul_i32 s54, s19, 5
    buffer_load_dword v4, v26, s[96:99], s54 offen
    v_mfma_f32_16x16x32_bf16 v[136:139], v[108:111], v[148:151], v[136:139]
    v_lshlrev_b32 v152, 16, v100
    v_and_b32 v153, s60, v100
    v_add_f32 v132, v132, v152
    v_add_f32 v134, v134, v153
    s_waitcnt lgkmcnt(5)
    v_mfma_f32_32x32x16_bf16 v[68:83], v[112:115], v[100:103], v[68:83]
    ds_read_b64_tr_b16 v[124:125], v19 offset:28800
    ds_read_b64_tr_b16 v[126:127], v19 offset:30592
    v_fma_f32 v133, v152, v152, v133
    v_fma_f32 v135, v153, v153, v135
    v_lshlrev_b32 v154, 16, v101
    v_and_b32 v155, s60, v101
    s_waitcnt lgkmcnt(5)
    v_mfma_f32_32x32x16_bf16 v[84:99], v[116:119], v[100:103], v[84:99]
    ds_read_b64_tr_b16 v[128:129], v19 offset:28928
    ds_read_b64_tr_b16 v[130:131], v19 offset:30720
    s_mov_b32 s56, 0x180
    s_add_u32 m0, s58, 0x400
    s_nop 0
    buffer_load_dwordx4 v6, s[20:23], s56 offen lds
    v_add_f32 v132, v132, v154
    v_add_f32 v134, v134, v155
    v_fma_f32 v133, v154, v154, v133
    v_fma_f32 v135, v155, v155, v135
    s_waitcnt lgkmcnt(4)
    v_mfma_f32_32x32x16_bf16 v[52:67], v[120:123], v[104:107], v[52:67]
    ds_read_b128 v[100:103], v16 offset:16384
    ds_read_b64_tr_b16 v[108:109], v20 offset:28672
    ds_read_b64_tr_b16 v[110:111], v20 offset:30464
    v_lshlrev_b32 v152, 16, v104
    v_and_b32 v153, s60, v104
    v_add_f32 v132, v132, v152
    v_add_f32 v134, v134, v153
    s_waitcnt lgkmcnt(5)
    v_mfma_f32_32x32x16_bf16 v[68:83], v[124:127], v[104:107], v[68:83]
    ds_read_b64_tr_b16 v[112:113], v20 offset:28800
    ds_read_b64_tr_b16 v[114:115], v20 offset:30592
    s_mov_b32 s57, 0x90000
    s_add_u32 m0, s59, 0
    s_nop 0
    buffer_load_dwordx4 v7, s[24:27], s57 offen lds
    v_mfma_f32_16x16x32_bf16 v[140:143], v[124:127], v[148:151], v[140:143]
    v_fma_f32 v133, v152, v152, v133
    v_fma_f32 v135, v153, v153, v135
    v_lshlrev_b32 v154, 16, v105
    v_and_b32 v155, s60, v105
    s_waitcnt lgkmcnt(5)
    v_mfma_f32_32x32x16_bf16 v[84:99], v[128:131], v[104:107], v[84:99]
    ds_read_b64_tr_b16 v[116:117], v20 offset:28928
    ds_read_b64_tr_b16 v[118:119], v20 offset:30720
    v_add_f32 v132, v132, v154
    v_add_f32 v134, v134, v155
    v_fma_f32 v133, v154, v154, v133
    v_fma_f32 v135, v155, v155, v135
    s_waitcnt lgkmcnt(4)
    v_mfma_f32_32x32x16_bf16 v[52:67], v[108:111], v[100:103], v[52:67]
    ds_read_b128 v[104:107], v17 offset:16384
    ds_read_b64_tr_b16 v[120:121], v21 offset:28672
    ds_read_b64_tr_b16 v[122:123], v21 offset:30464
    s_mov_b32 s57, 0x90000
    s_add_u32 m0, s59, 0x2000
    s_nop 0
    buffer_load_dwordx4 v8, s[24:27], s57 offen lds
    v_lshlrev_b32 v152, 16, v100
    v_and_b32 v153, s60, v100
    v_add_f32 v132, v132, v152
    v_add_f32 v134, v134, v153
    s_waitcnt lgkmcnt(5)
    v_mfma_f32_32x32x16_bf16 v[68:83], v[112:115], v[100:103], v[68:83]
    ds_read_b64_tr_b16 v[124:125], v21 offset:28800
    ds_read_b64_tr_b16 v[126:127], v21 offset:30592
    v_fma_f32 v133, v152, v152, v133
    v_fma_f32 v135, v153, v153, v135
    v_lshlrev_b32 v154, 16, v101
    v_and_b32 v155, s60, v101
    s_waitcnt lgkmcnt(5)
    v_mfma_f32_32x32x16_bf16 v[84:99], v[116:119], v[100:103], v[84:99]
    ds_read_b64_tr_b16 v[128:129], v21 offset:28928
    ds_read_b64_tr_b16 v[130:131], v21 offset:30720
    s_mov_b32 s57, 0x90000
    s_add_u32 m0, s59, 0x4000
    s_nop 0
    buffer_load_dwordx4 v9, s[24:27], s57 offen lds
    v_mfma_f32_16x16x32_bf16 v[144:147], v[116:119], v[148:151], v[144:147]
    v_add_f32 v132, v132, v154
    v_add_f32 v134, v134, v155
    v_fma_f32 v133, v154, v154, v133
    v_fma_f32 v135, v155, v155, v135
    s_waitcnt lgkmcnt(4)
    v_mfma_f32_32x32x16_bf16 v[52:67], v[120:123], v[104:107], v[52:67]
    v_lshlrev_b32 v152, 16, v104
    v_and_b32 v153, s60, v104
    v_add_f32 v132, v132, v152
    v_add_f32 v134, v134, v153
    s_waitcnt lgkmcnt(2)
    v_mfma_f32_32x32x16_bf16 v[68:83], v[124:127], v[104:107], v[68:83]
    s_waitcnt lgkmcnt(0)
    s_waitcnt vmcnt(6)
    s_barrier
    ds_read_b128 v[100:103], v14 offset:32768
    ds_read_b64_tr_b16 v[108:109], v22
    ds_read_b64_tr_b16 v[110:111], v22 offset:1792
    ds_read_b64_tr_b16 v[112:113], v22 offset:128
    ds_read_b64_tr_b16 v[114:115], v22 offset:1920
    ds_read_b64_tr_b16 v[116:117], v22 offset:256
    ds_read_b64_tr_b16 v[118:119], v22 offset:2048
    v_fma_f32 v133, v152, v152, v133
    v_fma_f32 v135, v153, v153, v135
    v_lshlrev_b32 v154, 16, v105
    v_and_b32 v155, s60, v105
    v_mfma_f32_32x32x16_bf16 v[84:99], v[128:131], v[104:107], v[84:99]
    v_add_f32 v132, v132, v154
    v_add_f32 v134, v134, v155
    v_fma_f32 v133, v154, v154, v133
    v_fma_f32 v135, v155, v155, v135
    s_waitcnt lgkmcnt(4)
    v_mfma_f32_32x32x16_bf16 v[52:67], v[108:111], v[100:103], v[52:67]
    ds_read_b128 v[104:107], v15 offset:32768
    ds_read_b64_tr_b16 v[120:121], v23
    ds_read_b64_tr_b16 v[122:123], v23 offset:1792
    s_mov_b32 s56, 0x200
    s_add_u32 m0, s58, 0x4000
    s_nop 0
    buffer_load_dwordx4 v5, s[20:23], s56 offen lds
    s_mul_i32 s54, s19, 6
    buffer_load_dword v4, v26, s[96:99], s54 offen
    v_mfma_f32_16x16x32_bf16 v[136:139], v[108:111], v[148:151], v[136:139]
    v_lshlrev_b32 v152, 16, v100
    v_and_b32 v153, s60, v100
    v_add_f32 v132, v132, v152
    v_add_f32 v134, v134, v153
    s_waitcnt lgkmcnt(5)
    v_mfma_f32_32x32x16_bf16 v[68:83], v[112:115], v[100:103], v[68:83]
    ds_read_b64_tr_b16 v[124:125], v23 offset:128
    ds_read_b64_tr_b16 v[126:127], v23 offset:1920
    v_fma_f32 v133, v152, v152, v133
    v_fma_f32 v135, v153, v153, v135
    v_lshlrev_b32 v154, 16, v101
    v_and_b32 v155, s60, v101
    s_waitcnt lgkmcnt(5)
    v_mfma_f32_32x32x16_bf16 v[84:99], v[116:119], v[100:103], v[84:99]
    ds_read_b64_tr_b16 v[128:129], v23 offset:256
    ds_read_b64_tr_b16 v[130:131], v23 offset:2048
    s_mov_b32 s56, 0x200
    s_add_u32 m0, s58, 0x4400
    s_nop 0
    buffer_load_dwordx4 v6, s[20:23], s56 offen lds
    v_add_f32 v132, v132, v154
    v_add_f32 v134, v134, v155
    v_fma_f32 v133, v154, v154, v133
    v_fma_f32 v135, v155, v155, v135
    s_waitcnt lgkmcnt(4)
    v_mfma_f32_32x32x16_bf16 v[52:67], v[120:123], v[104:107], v[52:67]
    ds_read_b128 v[100:103], v16 offset:32768
    ds_read_b64_tr_b16 v[108:109], v24
    ds_read_b64_tr_b16 v[110:111], v24 offset:1792
    v_lshlrev_b32 v152, 16, v104
    v_and_b32 v153, s60, v104
    v_add_f32 v132, v132, v152
    v_add_f32 v134, v134, v153
    s_waitcnt lgkmcnt(5)
    v_mfma_f32_32x32x16_bf16 v[68:83], v[124:127], v[104:107], v[68:83]
    ds_read_b64_tr_b16 v[112:113], v24 offset:128
    ds_read_b64_tr_b16 v[114:115], v24 offset:1920
    s_mov_b32 s57, 0xc0000
    s_add_u32 m0, s59, 0x7000
    s_nop 0
    buffer_load_dwordx4 v7, s[24:27], s57 offen lds
    v_mfma_f32_16x16x32_bf16 v[140:143], v[124:127], v[148:151], v[140:143]
    v_fma_f32 v133, v152, v152, v133
    v_fma_f32 v135, v153, v153, v135
    v_lshlrev_b32 v154, 16, v105
    v_and_b32 v155, s60, v105
    s_waitcnt lgkmcnt(5)
    v_mfma_f32_32x32x16_bf16 v[84:99], v[128:131], v[104:107], v[84:99]
    ds_read_b64_tr_b16 v[116:117], v24 offset:256
    ds_read_b64_tr_b16 v[118:119], v24 offset:2048
    v_add_f32 v132, v132, v154
    v_add_f32 v134, v134, v155
    v_fma_f32 v133, v154, v154, v133
    v_fma_f32 v135, v155, v155, v135
    s_waitcnt lgkmcnt(4)
    v_mfma_f32_32x32x16_bf16 v[52:67], v[108:111], v[100:103], v[52:67]
    ds_read_b128 v[104:107], v17 offset:32768
    ds_read_b64_tr_b16 v[120:121], v25
    ds_read_b64_tr_b16 v[122:123], v25 offset:1792
    s_mov_b32 s57, 0xc0000
    s_add_u32 m0, s59, 0x9000
    s_nop 0
    buffer_load_dwordx4 v8, s[24:27], s57 offen lds
    v_lshlrev_b32 v152, 16, v100
    v_and_b32 v153, s60, v100
    v_add_f32 v132, v132, v152
    v_add_f32 v134, v134, v153
    s_waitcnt lgkmcnt(5)
    v_mfma_f32_32x32x16_bf16 v[68:83], v[112:115], v[100:103], v[68:83]
    ds_read_b64_tr_b16 v[124:125], v25 offset:128
    ds_read_b64_tr_b16 v[126:127], v25 offset:1920
    v_fma_f32 v133, v152, v152, v133
    v_fma_f32 v135, v153, v153, v135
    v_lshlrev_b32 v154, 16, v101
    v_and_b32 v155, s60, v101
    s_waitcnt lgkmcnt(5)
    v_mfma_f32_32x32x16_bf16 v[84:99], v[116:119], v[100:103], v[84:99]
    ds_read_b64_tr_b16 v[128:129], v25 offset:256
    ds_read_b64_tr_b16 v[130:131], v25 offset:2048
    s_mov_b32 s57, 0xc0000
    s_add_u32 m0, s59, 0xb000
    s_nop 0
    buffer_load_dwordx4 v9, s[24:27], s57 offen lds
    v_mfma_f32_16x16x32_bf16 v[144:147], v[116:119], v[148:151], v[144:147]
    v_add_f32 v132, v132, v154
    v_add_f32 v134, v134, v155
    v_fma_f32 v133, v154, v154, v133
    v_fma_f32 v135, v155, v155, v135
    s_waitcnt lgkmcnt(4)
    v_mfma_f32_32x32x16_bf16 v[52:67], v[120:123], v[104:107], v[52:67]
    v_lshlrev_b32 v152, 16, v104
    v_and_b32 v153, s60, v104
    v_add_f32 v132, v132, v152
    v_add_f32 v134, v134, v153
    s_waitcnt lgkmcnt(2)
    v_mfma_f32_32x32x16_bf16 v[68:83], v[124:127], v[104:107], v[68:83]
    s_waitcnt lgkmcnt(0)
    s_waitcnt vmcnt(6)
    s_barrier
    ds_read_b128 v[100:103], v14
    ds_read_b64_tr_b16 v[108:109], v18
    ds_read_b64_tr_b16 v[110:111], v18 offset:1792
    ds_read_b64_tr_b16 v[112:113], v18 offset:128
    ds_read_b64_tr_b16 v[114:115], v18 offset:1920
    ds_read_b64_tr_b16 v[116:117], v18 offset:256
    ds_read_b64_tr_b16 v[118:119], v18 offset:2048
    v_fma_f32 v133, v152, v152, v133
    v_fma_f32 v135, v153, v153, v135
    v_lshlrev_b32 v154, 16, v105
    v_and_b32 v155, s60, v105
    v_mfma_f32_32x32x16_bf16 v[84:99], v[128:131], v[104:107], v[84:99]
    v_add_f32 v132, v132, v154
    v_add_f32 v134, v134, v155
    v_fma_f32 v133, v154, v154, v133
    v_fma_f32 v135, v155, v155, v135
    s_waitcnt lgkmcnt(4)
    v_mfma_f32_32x32x16_bf16 v[52:67], v[108:111], v[100:103], v[52:67]
    ds_read_b128 v[104:107], v15
    ds_read_b64_tr_b16 v[120:121], v19
    ds_read_b64_tr_b16 v[122:123], v19 offset:1792
    s_mov_b32 s56, 0x280
    s_add_u32 m0, s58, 0x8000
    s_nop 0
    buffer_load_dwordx4 v5, s[20:23], s56 offen lds
    s_mul_i32 s54, s19, 7
    buffer_load_dword v4, v26, s[96:99], s54 offen
    v_mfma_f32_16x16x32_bf16 v[136:139], v[108:111], v[148:151], v[136:139]
    v_lshlrev_b32 v152, 16, v100
    v_and_b32 v153, s60, v100
    v_add_f32 v132, v132, v152
    v_add_f32 v134, v134, v153
    s_waitcnt lgkmcnt(5)
    v_mfma_f32_32x32x16_bf16 v[68:83], v[112:115], v[100:103], v[68:83]
    ds_read_b64_tr_b16 v[124:125], v19 offset:128
    ds_read_b64_tr_b16 v[126:127], v19 offset:1920
    v_fma_f32 v133, v152, v152, v133
    v_fma_f32 v135, v153, v153, v135
    v_lshlrev_b32 v154, 16, v101
    v_and_b32 v155, s60, v101
    s_waitcnt lgkmcnt(5)
    v_mfma_f32_32x32x16_bf16 v[84:99], v[116:119], v[100:103], v[84:99]
    ds_read_b64_tr_b16 v[128:129], v19 offset:256
    ds_read_b64_tr_b16 v[130:131], v19 offset:2048
    s_mov_b32 s56, 0x280
    s_add_u32 m0, s58, 0x8400
    s_nop 0
    buffer_load_dwordx4 v6, s[20:23], s56 offen lds
    v_add_f32 v132, v132, v154
    v_add_f32 v134, v134, v155
    v_fma_f32 v133, v154, v154, v133
    v_fma_f32 v135, v155, v155, v135
    s_waitcnt lgkmcnt(4)
    v_mfma_f32_32x32x16_bf16 v[52:67], v[120:123], v[104:107], v[52:67]
    ds_read_b128 v[100:103], v16
    ds_read_b64_tr_b16 v[108:109], v20
    ds_read_b64_tr_b16 v[110:111], v20 offset:1792
    v_lshlrev_b32 v152, 16, v104
    v_and_b32 v153, s60, v104
    v_add_f32 v132, v132, v152
    v_add_f32 v134, v134, v153
    s_waitcnt lgkmcnt(5)
    v_mfma_f32_32x32x16_bf16 v[68:83], v[124:127], v[104:107], v[68:83]
    ds_read_b64_tr_b16 v[112:113], v20 offset:128
    ds_read_b64_tr_b16 v[114:115], v20 offset:1920
    s_mov_b32 s57, 0xf0000
    s_add_u32 m0, s59, 0xe000
    s_nop 0
    buffer_load_dwordx4 v7, s[24:27], s57 offen lds
    v_mfma_f32_16x16x32_bf16 v[140:143], v[124:127], v[148:151], v[140:143]
    v_fma_f32 v133, v152, v152, v133
    v_fma_f32 v135, v153, v153, v135
    v_lshlrev_b32 v154, 16, v105
    v_and_b32 v155, s60, v105
    s_waitcnt lgkmcnt(5)
    v_mfma_f32_32x32x16_bf16 v[84:99], v[128:131], v[104:107], v[84:99]
    ds_read_b64_tr_b16 v[116:117], v20 offset:256
    ds_read_b64_tr_b16 v[118:119], v20 offset:2048
    v_add_f32 v132, v132, v154
    v_add_f32 v134, v134, v155
    v_fma_f32 v133, v154, v154, v133
    v_fma_f32 v135, v155, v155, v135
    s_waitcnt lgkmcnt(4)
    v_mfma_f32_32x32x16_bf16 v[52:67], v[108:111], v[100:103], v[52:67]
    ds_read_b128 v[104:107], v17
    ds_read_b64_tr_b16 v[120:121], v21
    ds_read_b64_tr_b16 v[122:123], v21 offset:1792
    s_mov_b32 s57, 0xf0000
    s_add_u32 m0, s59, 0x10000
    s_nop 0
    buffer_load_dwordx4 v8, s[24:27], s57 offen lds
    v_lshlrev_b32 v152, 16, v100
    v_and_b32 v153, s60, v100
    v_add_f32 v132, v132, v152
    v_add_f32 v134, v134, v153
    s_waitcnt lgkmcnt(5)
    v_mfma_f32_32x32x16_bf16 v[68:83], v[112:115], v[100:103], v[68:83]
    ds_read_b64_tr_b16 v[124:125], v21 offset:128
    ds_read_b64_tr_b16 v[126:127], v21 offset:1920
    v_fma_f32 v133, v152, v152, v133
    v_fma_f32 v135, v153, v153, v135
    v_lshlrev_b32 v154, 16, v101
    v_and_b32 v155, s60, v101
    s_waitcnt lgkmcnt(5)
    v_mfma_f32_32x32x16_bf16 v[84:99], v[116:119], v[100:103], v[84:99]
    ds_read_b64_tr_b16 v[128:129], v21 offset:256
    ds_read_b64_tr_b16 v[130:131], v21 offset:2048
    s_mov_b32 s57, 0xf0000
    s_add_u32 m0, s59, 0x12000
    s_nop 0
    buffer_load_dwordx4 v9, s[24:27], s57 offen lds
    v_mfma_f32_16x16x32_bf16 v[144:147], v[116:119], v[148:151], v[144:147]
    v_add_f32 v132, v132, v154
    v_add_f32 v134, v134, v155
    v_fma_f32 v133, v154, v154, v133
    v_fma_f32 v135, v155, v155, v135
    s_waitcnt lgkmcnt(4)
    v_mfma_f32_32x32x16_bf16 v[52:67], v[120:123], v[104:107], v[52:67]
    v_lshlrev_b32 v152, 16, v104
    v_and_b32 v153, s60, v104
    v_add_f32 v132, v132, v152
    v_add_f32 v134, v134, v153
    s_waitcnt lgkmcnt(2)
    v_mfma_f32_32x32x16_bf16 v[68:83], v[124:127], v[104:107], v[68:83]
    s_waitcnt lgkmcnt(0)
    s_waitcnt vmcnt(6)
    s_barrier
    ds_read_b128 v[100:103], v14 offset:16384
    ds_read_b64_tr_b16 v[108:109], v18 offset:28672
    ds_read_b64_tr_b16 v[110:111], v18 offset:30464
    ds_read_b64_tr_b16 v[112:113], v18 offset:28800
    ds_read_b64_tr_b16 v[114:115], v18 offset:30592
    ds_read_b64_tr_b16 v[116:117], v18 offset:28928
    ds_read_b64_tr_b16 v[118:119], v18 offset:30720
    v_fma_f32 v133, v152, v152, v133
    v_fma_f32 v135, v153, v153, v135
    v_lshlrev_b32 v154, 16, v105
    v_and_b32 v155, s60, v105
    v_mfma_f32_32x32x16_bf16 v[84:99], v[128:131], v[104:107], v[84:99]
    v_add_f32 v132, v132, v154
    v_add_f32 v134, v134, v155
    v_fma_f32 v133, v154, v154, v133
    v_fma_f32 v135, v155, v155, v135
    s_waitcnt lgkmcnt(4)
    v_mfma_f32_32x32x16_bf16 v[52:67], v[108:111], v[100:103], v[52:67]
    ds_read_b128 v[104:107], v15 offset:16384
    ds_read_b64_tr_b16 v[120:121], v19 offset:28672
    ds_read_b64_tr_b16 v[122:123], v19 offset:30464
    s_mov_b32 s56, 0x300
    s_add_u32 m0, s58, 0
    s_nop 0
    buffer_load_dwordx4 v5, s[20:23], s56 offen lds
    s_add_u32 m0, s18, 0x3400
    s_nop 0
    buffer_load_dwordx4 v27, s[32:35], s64 offen lds
    v_mfma_f32_16x16x32_bf16 v[136:139], v[108:111], v[148:151], v[136:139]
    v_lshlrev_b32 v152, 16, v100
    v_and_b32 v153, s60, v100
    v_add_f32 v132, v132, v152
    v_add_f32 v134, v134, v153
    s_waitcnt lgkmcnt(5)
    v_mfma_f32_32x32x16_bf16 v[68:83], v[112:115], v[100:103], v[68:83]
    ds_read_b64_tr_b16 v[124:125], v19 offset:28800
    ds_read_b64_tr_b16 v[126:127], v19 offset:30592
    v_fma_f32 v133, v152, v152, v133
    v_fma_f32 v135, v153, v153, v135
    v_lshlrev_b32 v154, 16, v101
    v_and_b32 v155, s60, v101
    s_waitcnt lgkmcnt(5)
    v_mfma_f32_32x32x16_bf16 v[84:99], v[116:119], v[100:103], v[84:99]
    ds_read_b64_tr_b16 v[128:129], v19 offset:28928
    ds_read_b64_tr_b16 v[130:131], v19 offset:30720
    s_mov_b32 s56, 0x300
    s_add_u32 m0, s58, 0x400
    s_nop 0
    buffer_load_dwordx4 v6, s[20:23], s56 offen lds
    v_add_f32 v132, v132, v154
    v_add_f32 v134, v134, v155
    v_fma_f32 v133, v154, v154, v133
    v_fma_f32 v135, v155, v155, v135
    s_waitcnt lgkmcnt(4)
    v_mfma_f32_32x32x16_bf16 v[52:67], v[120:123], v[104:107], v[52:67]
    ds_read_b128 v[100:103], v16 offset:16384
    ds_read_b64_tr_b16 v[108:109], v20 offset:28672
    ds_read_b64_tr_b16 v[110:111], v20 offset:30464
    s_add_u32 m0, s18, 0
    s_nop 0
    buffer_load_dwordx4 v27, s[36:39], s65 offen lds
    v_lshlrev_b32 v152, 16, v104
    v_and_b32 v153, s60, v104
    v_add_f32 v132, v132, v152
    v_add_f32 v134, v134, v153
    s_waitcnt lgkmcnt(5)
    v_mfma_f32_32x32x16_bf16 v[68:83], v[124:127], v[104:107], v[68:83]
    ds_read_b64_tr_b16 v[112:113], v20 offset:28800
    ds_read_b64_tr_b16 v[114:115], v20 offset:30592
    s_mov_b32 s57, 0x120000
    s_add_u32 m0, s59, 0
    s_nop 0
    buffer_load_dwordx4 v7, s[24:27], s57 offen lds
    v_mfma_f32_16x16x32_bf16 v[140:143], v[124:127], v[148:151], v[140:143]
    v_fma_f32 v133, v152, v152, v133
    v_fma_f32 v135, v153, v153, v135
    v_lshlrev_b32 v154, 16, v105
    v_and_b32 v155, s60, v105
    s_waitcnt lgkmcnt(5)
    v_mfma_f32_32x32x16_bf16 v[84:99], v[128:131], v[104:107], v[84:99]
    ds_read_b64_tr_b16 v[116:117], v20 offset:28928
    ds_read_b64_tr_b16 v[118:119], v20 offset:30720
    v_add_f32 v132, v132, v154
    v_add_f32 v134, v134, v155
    v_fma_f32 v133, v154, v154, v133
    v_fma_f32 v135, v155, v155, v135
    s_waitcnt lgkmcnt(4)
    v_mfma_f32_32x32x16_bf16 v[52:67], v[108:111], v[100:103], v[52:67]
    ds_read_b128 v[104:107], v17 offset:16384
    ds_read_b64_tr_b16 v[120:121], v21 offset:28672
    ds_read_b64_tr_b16 v[122:123], v21 offset:30464
    s_mov_b32 s57, 0x120000
    s_add_u32 m0, s59, 0x2000
    s_nop 0
    buffer_load_dwordx4 v8, s[24:27], s57 offen lds
    s_mov_b32 m0, 0x23c00
    s_nop 0
    buffer_load_dwordx4 v28, s[40:43], s69 offen lds
    v_lshlrev_b32 v152, 16, v100
    v_and_b32 v153, s60, v100
    v_add_f32 v132, v132, v152
    v_add_f32 v134, v134, v153
    s_waitcnt lgkmcnt(5)
    v_mfma_f32_32x32x16_bf16 v[68:83], v[112:115], v[100:103], v[68:83]
    ds_read_b64_tr_b16 v[124:125], v21 offset:28800
    ds_read_b64_tr_b16 v[126:127], v21 offset:30592
    v_fma_f32 v133, v152, v152, v133
    v_fma_f32 v135, v153, v153, v135
    v_lshlrev_b32 v154, 16, v101
    v_and_b32 v155, s60, v101
    s_waitcnt lgkmcnt(5)
    v_mfma_f32_32x32x16_bf16 v[84:99], v[116:119], v[100:103], v[84:99]
    ds_read_b64_tr_b16 v[128:129], v21 offset:28928
    ds_read_b64_tr_b16 v[130:131], v21 offset:30720
    s_mov_b32 s57, 0x120000
    s_add_u32 m0, s59, 0x4000
    s_nop 0
    buffer_load_dwordx4 v9, s[24:27], s57 offen lds
    v_mfma_f32_16x16x32_bf16 v[144:147], v[116:119], v[148:151], v[144:147]
    v_add_f32 v132, v132, v154
    v_add_f32 v134, v134, v155
    v_fma_f32 v133, v154, v154, v133
    v_fma_f32 v135, v155, v155, v135
    s_waitcnt lgkmcnt(4)
    v_mfma_f32_32x32x16_bf16 v[52:67], v[120:123], v[104:107], v[52:67]
    v_lshlrev_b32 v152, 16, v104
    v_and_b32 v153, s60, v104
    v_add_f32 v132, v132, v152
    v_add_f32 v134, v134, v153
    s_waitcnt lgkmcnt(2)
    v_mfma_f32_32x32x16_bf16 v[68:83], v[124:127], v[104:107], v[68:83]
    s_waitcnt lgkmcnt(0)
    s_waitcnt vmcnt(8)
    s_barrier
    ds_read_b128 v[100:103], v14 offset:32768
    ds_read_b64_tr_b16 v[108:109], v22
    ds_read_b64_tr_b16 v[110:111], v22 offset:1792
    ds_read_b64_tr_b16 v[112:113], v22 offset:128
    ds_read_b64_tr_b16 v[114:115], v22 offset:1920
    ds_read_b64_tr_b16 v[116:117], v22 offset:256
    ds_read_b64_tr_b16 v[118:119], v22 offset:2048
    v_fma_f32 v133, v152, v152, v133
    v_fma_f32 v135, v153, v153, v135
    v_lshlrev_b32 v154, 16, v105
    v_and_b32 v155, s60, v105
    v_mfma_f32_32x32x16_bf16 v[84:99], v[128:131], v[104:107], v[84:99]
    v_add_f32 v132, v132, v154
    v_add_f32 v134, v134, v155
    v_fma_f32 v133, v154, v154, v133
    v_fma_f32 v135, v155, v155, v135
    s_waitcnt lgkmcnt(4)
    v_mfma_f32_32x32x16_bf16 v[52:67], v[108:111], v[100:103], v[52:67]
    ds_read_b128 v[104:107], v15 offset:32768
    ds_read_b64_tr_b16 v[120:121], v23
    ds_read_b64_tr_b16 v[122:123], v23 offset:1792
    s_mov_b32 s56, 0x380
    s_add_u32 m0, s58, 0x4000
    s_nop 0
    buffer_load_dwordx4 v5, s[20:23], s56 offen lds
    v_mfma_f32_16x16x32_bf16 v[136:139], v[108:111], v[148:151], v[136:139]
    v_lshlrev_b32 v152, 16, v100
    v_and_b32 v153, s60, v100
    v_add_f32 v132, v132, v152
    v_add_f32 v134, v134, v153
    s_waitcnt lgkmcnt(5)
    v_mfma_f32_32x32x16_bf16 v[68:83], v[112:115], v[100:103], v[68:83]
    ds_read_b64_tr_b16 v[124:125], v23 offset:128
    ds_read_b64_tr_b16 v[126:127], v23 offset:1920
    v_fma_f32 v133, v152, v152, v133
    v_fma_f32 v135, v153, v153, v135
    v_lshlrev_b32 v154, 16, v101
    v_and_b32 v155, s60, v101
    s_waitcnt lgkmcnt(5)
    v_mfma_f32_32x32x16_bf16 v[84:99], v[116:119], v[100:103], v[84:99]
    ds_read_b64_tr_b16 v[128:129], v23 offset:256
    ds_read_b64_tr_b16 v[130:131], v23 offset:2048
    s_mov_b32 s56, 0x380
    s_add_u32 m0, s58, 0x4400
    s_nop 0
    buffer_load_dwordx4 v6, s[20:23], s56 offen lds
    v_add_f32 v132, v132, v154
    v_add_f32 v134, v134, v155
    v_fma_f32 v133, v154, v154, v133
    v_fma_f32 v135, v155, v155, v135
    s_waitcnt lgkmcnt(4)
    v_mfma_f32_32x32x16_bf16 v[52:67], v[120:123], v[104:107], v[52:67]
    ds_read_b128 v[100:103], v16 offset:32768
    ds_read_b64_tr_b16 v[108:109], v24
    ds_read_b64_tr_b16 v[110:111], v24 offset:1792
    v_lshlrev_b32 v152, 16, v104
    v_and_b32 v153, s60, v104
    v_add_f32 v132, v132, v152
    v_add_f32 v134, v134, v153
    s_waitcnt lgkmcnt(5)
    v_mfma_f32_32x32x16_bf16 v[68:83], v[124:127], v[104:107], v[68:83]
    ds_read_b64_tr_b16 v[112:113], v24 offset:128
    ds_read_b64_tr_b16 v[114:115], v24 offset:1920
    s_mov_b32 s57, 0x150000
    s_add_u32 m0, s59, 0x7000
    s_nop 0
    buffer_load_dwordx4 v7, s[24:27], s57 offen lds
    v_mfma_f32_16x16x32_bf16 v[140:143], v[124:127], v[148:151], v[140:143]
    v_fma_f32 v133, v152, v152, v133
    v_fma_f32 v135, v153, v153, v135
    v_lshlrev_b32 v154, 16, v105
    v_and_b32 v155, s60, v105
    s_waitcnt lgkmcnt(5)
    v_mfma_f32_32x32x16_bf16 v[84:99], v[128:131], v[104:107], v[84:99]
    ds_read_b64_tr_b16 v[116:117], v24 offset:256
    ds_read_b64_tr_b16 v[118:119], v24 offset:2048
    v_add_f32 v132, v132, v154
    v_add_f32 v134, v134, v155
    v_fma_f32 v133, v154, v154, v133
    v_fma_f32 v135, v155, v155, v135
    s_waitcnt lgkmcnt(4)
    v_mfma_f32_32x32x16_bf16 v[52:67], v[108:111], v[100:103], v[52:67]
    ds_read_b128 v[104:107], v17 offset:32768
    ds_read_b64_tr_b16 v[120:121], v25
    ds_read_b64_tr_b16 v[122:123], v25 offset:1792
    s_mov_b32 s57, 0x150000
    s_add_u32 m0, s59, 0x9000
    s_nop 0
    buffer_load_dwordx4 v8, s[24:27], s57 offen lds
    v_lshlrev_b32 v152, 16, v100
    v_and_b32 v153, s60, v100
    v_add_f32 v132, v132, v152
    v_add_f32 v134, v134, v153
    s_waitcnt lgkmcnt(5)
    v_mfma_f32_32x32x16_bf16 v[68:83], v[112:115], v[100:103], v[68:83]
    ds_read_b64_tr_b16 v[124:125], v25 offset:128
    ds_read_b64_tr_b16 v[126:127], v25 offset:1920
    v_fma_f32 v133, v152, v152, v133
    v_fma_f32 v135, v153, v153, v135
    v_lshlrev_b32 v154, 16, v101
    v_and_b32 v155, s60, v101
    s_waitcnt lgkmcnt(5)
    v_mfma_f32_32x32x16_bf16 v[84:99], v[116:119], v[100:103], v[84:99]
    ds_read_b64_tr_b16 v[128:129], v25 offset:256
    ds_read_b64_tr_b16 v[130:131], v25 offset:2048
    s_mov_b32 s57, 0x150000
    s_add_u32 m0, s59, 0xb000
    s_nop 0
    buffer_load_dwordx4 v9, s[24:27], s57 offen lds
    v_mfma_f32_16x16x32_bf16 v[144:147], v[116:119], v[148:151], v[144:147]
    v_add_f32 v132, v132, v154
    v_add_f32 v134, v134, v155
    v_fma_f32 v133, v154, v154, v133
    v_fma_f32 v135, v155, v155, v135
    s_waitcnt lgkmcnt(4)
    v_mfma_f32_32x32x16_bf16 v[52:67], v[120:123], v[104:107], v[52:67]
    v_lshlrev_b32 v152, 16, v104
    v_and_b32 v153, s60, v104
    v_add_f32 v132, v132, v152
    v_add_f32 v134, v134, v153
    s_waitcnt lgkmcnt(2)
    v_mfma_f32_32x32x16_bf16 v[68:83], v[124:127], v[104:107], v[68:83]
    s_waitcnt lgkmcnt(0)
    s_waitcnt vmcnt(5)
    s_barrier
    ds_read_b128 v[100:103], v14
    ds_read_b64_tr_b16 v[108:109], v18
    ds_read_b64_tr_b16 v[110:111], v18 offset:1792
    ds_read_b64_tr_b16 v[112:113], v18 offset:128
    ds_read_b64_tr_b16 v[114:115], v18 offset:1920
    ds_read_b64_tr_b16 v[116:117], v18 offset:256
    ds_read_b64_tr_b16 v[118:119], v18 offset:2048
    v_fma_f32 v133, v152, v152, v133
    v_fma_f32 v135, v153, v153, v135
    v_lshlrev_b32 v154, 16, v105
    v_and_b32 v155, s60, v105
    v_mfma_f32_32x32x16_bf16 v[84:99], v[128:131], v[104:107], v[84:99]
    v_add_f32 v132, v132, v154
    v_add_f32 v134, v134, v155
    v_fma_f32 v133, v154, v154, v133
    v_fma_f32 v135, v155, v155, v135
    s_waitcnt lgkmcnt(4)
    v_mfma_f32_32x32x16_bf16 v[52:67], v[108:111], v[100:103], v[52:67]
    ds_read_b128 v[104:107], v15
    ds_read_b64_tr_b16 v[120:121], v19
    ds_read_b64_tr_b16 v[122:123], v19 offset:1792
    ds_read_b64_tr_b16 v[32:33], v40 offset:13312
    ds_read_b64_tr_b16 v[34:35], v40 offset:13824
    v_mfma_f32_16x16x32_bf16 v[136:139], v[108:111], v[148:151], v[136:139]
    v_lshlrev_b32 v152, 16, v100
    v_and_b32 v153, s60, v100
    v_add_f32 v132, v132, v152
    v_add_f32 v134, v134, v153
    s_waitcnt lgkmcnt(7)
    v_mfma_f32_32x32x16_bf16 v[68:83], v[112:115], v[100:103], v[68:83]
    ds_read_b64_tr_b16 v[124:125], v19 offset:128
    ds_read_b64_tr_b16 v[126:127], v19 offset:1920
    v_fma_f32 v133, v152, v152, v133
    v_fma_f32 v135, v153, v153, v135
    v_lshlrev_b32 v154, 16, v101
    v_and_b32 v155, s60, v101
    s_waitcnt lgkmcnt(7)
    v_mfma_f32_32x32x16_bf16 v[84:99], v[116:119], v[100:103], v[84:99]
    ds_read_b64_tr_b16 v[128:129], v19 offset:256
    ds_read_b64_tr_b16 v[130:131], v19 offset:2048
    v_add_f32 v132, v132, v154
    v_add_f32 v134, v134, v155
    v_fma_f32 v133, v154, v154, v133
    v_fma_f32 v135, v155, v155, v135
    s_waitcnt lgkmcnt(6)
    v_mfma_f32_32x32x16_bf16 v[52:67], v[120:123], v[104:107], v[52:67]
    ds_read_b128 v[100:103], v16
    ds_read_b64_tr_b16 v[108:109], v20
    ds_read_b64_tr_b16 v[110:111], v20 offset:1792
    ds_read_b64_tr_b16 v[36:37], v40
    ds_read_b64_tr_b16 v[38:39], v40 offset:512
    v_lshlrev_b32 v152, 16, v104
    v_and_b32 v153, s60, v104
    v_add_f32 v132, v132, v152
    v_add_f32 v134, v134, v153
    s_waitcnt lgkmcnt(7)
    v_mfma_f32_32x32x16_bf16 v[68:83], v[124:127], v[104:107], v[68:83]
    ds_read_b64_tr_b16 v[112:113], v20 offset:128
    ds_read_b64_tr_b16 v[114:115], v20 offset:1920
    v_mfma_f32_16x16x32_bf16 v[140:143], v[124:127], v[148:151], v[140:143]
    v_fma_f32 v133, v152, v152, v133
    v_fma_f32 v135, v153, v153, v135
    v_lshlrev_b32 v154, 16, v105
    v_and_b32 v155, s60, v105
    s_waitcnt lgkmcnt(7)
    v_mfma_f32_32x32x16_bf16 v[84:99], v[128:131], v[104:107], v[84:99]
    ds_read_b64_tr_b16 v[116:117], v20 offset:256
    ds_read_b64_tr_b16 v[118:119], v20 offset:2048
    v_add_f32 v132, v132, v154
    v_add_f32 v134, v134, v155
    v_fma_f32 v133, v154, v154, v133
    v_fma_f32 v135, v155, v155, v135
    s_waitcnt lgkmcnt(6)
    v_mfma_f32_32x32x16_bf16 v[52:67], v[108:111], v[100:103], v[52:67]
    ds_read_b128 v[104:107], v17
    ds_read_b64_tr_b16 v[120:121], v21
    ds_read_b64_tr_b16 v[122:123], v21 offset:1792
    ds_read_b64_tr_b16 v[44:45], v41 offset:15360
    ds_read_b64_tr_b16 v[46:47], v41 offset:15616
    ds_read_b64_tr_b16 v[48:49], v41 offset:15872
    ds_read_b64_tr_b16 v[50:51], v41 offset:16128
    v_lshlrev_b32 v152, 16, v100
    v_and_b32 v153, s60, v100
    v_add_f32 v132, v132, v152
    v_add_f32 v134, v134, v153
    s_waitcnt lgkmcnt(9)
    v_mfma_f32_32x32x16_bf16 v[68:83], v[112:115], v[100:103], v[68:83]
    ds_read_b64_tr_b16 v[124:125], v21 offset:128
    ds_read_b64_tr_b16 v[126:127], v21 offset:1920
    v_fma_f32 v133, v152, v152, v133
    v_fma_f32 v135, v153, v153, v135
    v_lshlrev_b32 v154, 16, v101
    v_and_b32 v155, s60, v101
    s_waitcnt lgkmcnt(9)
    v_mfma_f32_32x32x16_bf16 v[84:99], v[116:119], v[100:103], v[84:99]
    ds_read_b64_tr_b16 v[128:129], v21 offset:256
    ds_read_b64_tr_b16 v[130:131], v21 offset:2048
    v_mfma_f32_16x16x32_bf16 v[144:147], v[116:119], v[148:151], v[144:147]
    v_add_f32 v132, v132, v154
    v_add_f32 v134, v134, v155
    v_fma_f32 v133, v154, v154, v133
    v_fma_f32 v135, v155, v155, v135
    s_waitcnt lgkmcnt(8)
    v_mfma_f32_32x32x16_bf16 v[52:67], v[120:123], v[104:107], v[52:67]
    v_lshlrev_b32 v152, 16, v104
    v_and_b32 v153, s60, v104
    v_add_f32 v132, v132, v152
    v_add_f32 v134, v134, v153
    s_waitcnt lgkmcnt(2)
    v_mfma_f32_32x32x16_bf16 v[68:83], v[124:127], v[104:107], v[68:83]
    s_waitcnt lgkmcnt(0)
    s_waitcnt vmcnt(0)
    s_barrier
    ds_read_b128 v[100:103], v14 offset:16384
    ds_read_b64_tr_b16 v[108:109], v18 offset:28672
    ds_read_b64_tr_b16 v[110:111], v18 offset:30464
    ds_read_b64_tr_b16 v[112:113], v18 offset:28800
    ds_read_b64_tr_b16 v[114:115], v18 offset:30592
    ds_read_b64_tr_b16 v[116:117], v18 offset:28928
    ds_read_b64_tr_b16 v[118:119], v18 offset:30720
    v_fma_f32 v133, v152, v152, v133
    v_fma_f32 v135, v153, v153, v135
    v_lshlrev_b32 v154, 16, v105
    v_and_b32 v155, s60, v105
    v_mfma_f32_32x32x16_bf16 v[84:99], v[128:131], v[104:107], v[84:99]
    v_add_f32 v132, v132, v154
    v_add_f32 v134, v134, v155
    v_fma_f32 v133, v154, v154, v133
    v_fma_f32 v135, v155, v155, v135
    s_waitcnt lgkmcnt(4)
    v_mfma_f32_32x32x16_bf16 v[52:67], v[108:111], v[100:103], v[52:67]
    ds_read_b128 v[104:107], v15 offset:16384
    ds_read_b64_tr_b16 v[120:121], v19 offset:28672
    ds_read_b64_tr_b16 v[122:123], v19 offset:30464
    v_mov_b32 v156, -1
    v_mov_b32 v157, -1
    v_mov_b32 v158, -1
    v_mov_b32 v159, -1
    s_lshl_b32 s52, s61, 10
    s_add_u32 s52, s52, 0x1000000
    s_cmp_lt_u32 s61, 0x48
    s_cselect_b32 s52, s52, 0x7fff0000
    buffer_store_dwordx4 v[156:159], v28, s[28:31], s52 offen sc0 sc1
    v_mfma_f32_16x16x32_bf16 v[136:139], v[108:111], v[148:151], v[136:139]
    v_lshlrev_b32 v152, 16, v100
    v_and_b32 v153, s60, v100
    v_add_f32 v132, v132, v152
    v_add_f32 v134, v134, v153
    s_waitcnt lgkmcnt(5)
    v_mfma_f32_32x32x16_bf16 v[68:83], v[112:115], v[100:103], v[68:83]
    ds_read_b64_tr_b16 v[124:125], v19 offset:28800
    ds_read_b64_tr_b16 v[126:127], v19 offset:30592
    buffer_store_dwordx4 v[32:35], v28, s[28:31], s66 offen sc0 sc1
    v_fma_f32 v133, v152, v152, v133
    v_fma_f32 v135, v153, v153, v135
    v_lshlrev_b32 v154, 16, v101
    v_and_b32 v155, s60, v101
    s_waitcnt lgkmcnt(5)
    v_mfma_f32_32x32x16_bf16 v[84:99], v[116:119], v[100:103], v[84:99]
    ds_read_b64_tr_b16 v[128:129], v19 offset:28928
    ds_read_b64_tr_b16 v[130:131], v19 offset:30720
    buffer_store_dwordx4 v[36:39], v28, s[28:31], s67 offen sc0 sc1
    v_add_f32 v132, v132, v154
    v_add_f32 v134, v134, v155
    v_fma_f32 v133, v154, v154, v133
    v_fma_f32 v135, v155, v155, v135
    s_waitcnt lgkmcnt(4)
    v_mfma_f32_32x32x16_bf16 v[52:67], v[120:123], v[104:107], v[52:67]
    ds_read_b128 v[100:103], v16 offset:16384
    ds_read_b64_tr_b16 v[108:109], v20 offset:28672
    ds_read_b64_tr_b16 v[110:111], v20 offset:30464
    v_lshlrev_b32 v152, 16, v104
    v_and_b32 v153, s60, v104
    v_add_f32 v132, v132, v152
    v_add_f32 v134, v134, v153
    s_waitcnt lgkmcnt(5)
    v_mfma_f32_32x32x16_bf16 v[68:83], v[124:127], v[104:107], v[68:83]
    ds_read_b64_tr_b16 v[112:113], v20 offset:28800
    ds_read_b64_tr_b16 v[114:115], v20 offset:30592
    v_mfma_f32_16x16x32_bf16 v[140:143], v[124:127], v[148:151], v[140:143]
    v_fma_f32 v133, v152, v152, v133
    v_fma_f32 v135, v153, v153, v135
    v_lshlrev_b32 v154, 16, v105
    v_and_b32 v155, s60, v105
    s_waitcnt lgkmcnt(5)
    v_mfma_f32_32x32x16_bf16 v[84:99], v[128:131], v[104:107], v[84:99]
    ds_read_b64_tr_b16 v[116:117], v20 offset:28928
    ds_read_b64_tr_b16 v[118:119], v20 offset:30720
    v_add_f32 v132, v132, v154
    v_add_f32 v134, v134, v155
    v_fma_f32 v133, v154, v154, v133
    v_fma_f32 v135, v155, v155, v135
    s_waitcnt lgkmcnt(4)
    v_mfma_f32_32x32x16_bf16 v[52:67], v[108:111], v[100:103], v[52:67]
    ds_read_b128 v[104:107], v17 offset:16384
    ds_read_b64_tr_b16 v[120:121], v21 offset:28672
    ds_read_b64_tr_b16 v[122:123], v21 offset:30464
    v_lshlrev_b32 v152, 16, v100
    v_and_b32 v153, s60, v100
    v_add_f32 v132, v132, v152
    v_add_f32 v134, v134, v153
    s_waitcnt lgkmcnt(5)
    v_mfma_f32_32x32x16_bf16 v[68:83], v[112:115], v[100:103], v[68:83]
    ds_read_b64_tr_b16 v[124:125], v21 offset:28800
    ds_read_b64_tr_b16 v[126:127], v21 offset:30592
    v_fma_f32 v133, v152, v152, v133
    v_fma_f32 v135, v153, v153, v135
    v_lshlrev_b32 v154, 16, v101
    v_and_b32 v155, s60, v101
    s_waitcnt lgkmcnt(5)
    v_mfma_f32_32x32x16_bf16 v[84:99], v[116:119], v[100:103], v[84:99]
    ds_read_b64_tr_b16 v[128:129], v21 offset:28928
    ds_read_b64_tr_b16 v[130:131], v21 offset:30720
    v_mfma_f32_16x16x32_bf16 v[144:147], v[116:119], v[148:151], v[144:147]
    v_add_f32 v132, v132, v154
    v_add_f32 v134, v134, v155
    v_fma_f32 v133, v154, v154, v133
    v_fma_f32 v135, v155, v155, v135
    s_waitcnt lgkmcnt(4)
    v_mfma_f32_32x32x16_bf16 v[52:67], v[120:123], v[104:107], v[52:67]
    v_lshlrev_b32 v152, 16, v104
    v_and_b32 v153, s60, v104
    v_add_f32 v132, v132, v152
    v_add_f32 v134, v134, v153
    s_waitcnt lgkmcnt(2)
    v_mfma_f32_32x32x16_bf16 v[68:83], v[124:127], v[104:107], v[68:83]
    v_fma_f32 v133, v152, v152, v133
    v_fma_f32 v135, v153, v153, v135
    v_lshlrev_b32 v154, 16, v105
    v_and_b32 v155, s60, v105
    s_waitcnt lgkmcnt(0)
    v_mfma_f32_32x32x16_bf16 v[84:99], v[128:131], v[104:107], v[84:99]
    v_add_f32 v132, v132, v154
    v_add_f32 v134, v134, v155
    v_fma_f32 v133, v154, v154, v133
    v_fma_f32 v135, v155, v155, v135
    v_and_b32 v10, 31, v1
    v_lshrrev_b32 v12, 5, v1
    s_lshl_b32 s52, s45, 5
    v_add_u32 v11, s52, v10
    v_lshlrev_b32 v162, 5, v11
    v_add_u32 v162, 0x21000, v162
    v_lshl_add_u32 v160, v12, 3, v162
    v_lshlrev_b32 v163, 2, v10
    v_add_u32 v163, 0x22000, v163
    v_and_b32 v11, 1, v1
    v_lshlrev_b32 v11, 6, v11
    v_lshrrev_b32 v12, 4, v1
    v_lshl_add_u32 v161, v12, 4, v11
    s_lshl_b32 s52, s45, 7
    s_add_u32 s52, s52, 0x22000
    v_add_u32 v161, s52, v161
    v_add_f32 v132, v132, v134
    v_add_f32 v133, v133, v135
    ds_write_b64 v160, v[132:133]
    s_mov_b32 exec_lo, 0x30003
    s_mov_b32 exec_hi, 0x30003
    ds_write_b128 v161, v[136:139]
    ds_write_b128 v161, v[140:143] offset:1024
    ds_write_b128 v161, v[144:147] offset:2048
    s_mov_b64 exec, -1
    s_waitcnt lgkmcnt(0)
    s_barrier
    ds_read_b128 v[164:167], v162
    ds_read_b128 v[168:171], v162 offset:16
    ds_read_b32 v180, v163
    ds_read_b32 v181, v163 offset:128
    ds_read_b32 v182, v163 offset:256
    ds_read_b32 v183, v163 offset:384
    ds_read_b32 v184, v163 offset:1024
    ds_read_b32 v185, v163 offset:1152
    ds_read_b32 v186, v163 offset:1280
    ds_read_b32 v187, v163 offset:1408
    ds_read_b32 v188, v163 offset:2048
    ds_read_b32 v189, v163 offset:2176
    ds_read_b32 v190, v163 offset:2304
    ds_read_b32 v191, v163 offset:2432
    s_waitcnt lgkmcnt(13)
    v_add_f32 v164, v164, v166
    v_add_f32 v165, v165, v167
    s_waitcnt lgkmcnt(12)
    v_add_f32 v168, v168, v170
    v_add_f32 v169, v169, v171
    v_add_f32 v164, v164, v168
    v_add_f32 v165, v165, v169
    v_mul_f32 v199, 0x3b000000, v164
    v_mul_f32 v197, 0x3b000000, v165
    v_fma_f32 v197, -v199, v199, v197
    v_cvt_pk_bf16_f32 v100, -v199, -v199
    v_cmp_gt_u32 vcc, 32, v1
    v_mov_b32 v102, 0
    v_mov_b32 v103, 0
    v_cndmask_b32 v100, v102, v100, vcc
    v_and_b32 v101, 0xffff, v100
    v_cvt_pk_bf16_f32 v197, v197, v197
    v_lshlrev_b32 v197, 16, v197
    v_add_f32 v197, 0x3727c5ac, v197
    v_cvt_pk_bf16_f32 v197, v197, v197
    v_lshlrev_b32 v197, 16, v197
    v_sqrt_f32 v197, v197
    s_nop 0
    v_cvt_pk_bf16_f32 v197, v197, v197
    v_lshlrev_b32 v197, 16, v197
    v_rcp_f32 v198, v197
    s_mov_b32 s55, 0x7060302
    s_waitcnt lgkmcnt(10)
    v_add_f32 v180, v180, v181
    s_waitcnt lgkmcnt(8)
    v_add_f32 v182, v182, v183
    v_add_f32 v180, v180, v182
    v_and_b32 v181, s60, v180
    v_sub_f32 v181, v180, v181
    v_and_b32 v182, s60, v181
    v_sub_f32 v182, v181, v182
    v_perm_b32 v108, v181, v180, s55
    v_lshrrev_b32 v109, 16, v182
    v_mov_b32 v110, 0
    v_mov_b32 v111, 0
    s_nop 1
    v_mfma_f32_32x32x16_bf16 v[52:67], v[108:111], v[100:103], v[52:67]
    s_waitcnt lgkmcnt(6)
    v_add_f32 v184, v184, v185
    s_waitcnt lgkmcnt(4)
    v_add_f32 v186, v186, v187
    v_add_f32 v184, v184, v186
    v_and_b32 v185, s60, v184
    v_sub_f32 v185, v184, v185
    v_and_b32 v186, s60, v185
    v_sub_f32 v186, v185, v186
    v_perm_b32 v112, v185, v184, s55
    v_lshrrev_b32 v113, 16, v186
    v_mov_b32 v114, 0
    v_mov_b32 v115, 0
    s_nop 1
    v_mfma_f32_32x32x16_bf16 v[68:83], v[112:115], v[100:103], v[68:83]
    s_waitcnt lgkmcnt(2)
    v_add_f32 v188, v188, v189
    s_waitcnt lgkmcnt(0)
    v_add_f32 v190, v190, v191
    v_add_f32 v188, v188, v190
    v_and_b32 v189, s60, v188
    v_sub_f32 v189, v188, v189
    v_and_b32 v190, s60, v189
    v_sub_f32 v190, v189, v190
    v_perm_b32 v116, v189, v188, s55
    v_lshrrev_b32 v117, 16, v190
    v_mov_b32 v118, 0
    v_mov_b32 v119, 0
    s_nop 1
    v_mfma_f32_32x32x16_bf16 v[84:99], v[116:119], v[100:103], v[84:99]
    v_mul_f32 v196, 0xbfb8aa3b, v198
    v_xor_b32 v44, v42, v44
    v_xor_b32 v45, v42, v45
    v_xor_b32 v46, v42, v46
    v_xor_b32 v47, v42, v47
    v_xor_b32 v48, v42, v48
    v_xor_b32 v49, v42, v49
    v_xor_b32 v50, v42, v50
    v_xor_b32 v51, v42, v51
    v_pk_mul_f32 v[52:53], v[198:199], v[52:53] op_sel_hi:[0,1]
    v_pk_mul_f32 v[54:55], v[198:199], v[54:55] op_sel_hi:[0,1]
    v_pk_mul_f32 v[56:57], v[198:199], v[56:57] op_sel_hi:[0,1]
    v_pk_mul_f32 v[58:59], v[198:199], v[58:59] op_sel_hi:[0,1]
    v_pk_mul_f32 v[60:61], v[198:199], v[60:61] op_sel_hi:[0,1]
    v_pk_mul_f32 v[62:63], v[198:199], v[62:63] op_sel_hi:[0,1]
    v_pk_mul_f32 v[64:65], v[198:199], v[64:65] op_sel_hi:[0,1]
    v_pk_mul_f32 v[66:67], v[198:199], v[66:67] op_sel_hi:[0,1]
    s_lshl_b32 s52, s47, 2
    s_add_u32 s52, s52, s45
    s_lshl_b32 s54, s52, 5
    s_lshl_b32 s53, s48, 2
    s_add_u32 s53, s53, 0
    s_add_u32 s54, s54, s53
    s_lshl_b32 s68, s54, 10
    s_add_u32 s68, s68, 0x700000
    s_lshl_b32 s53, s53, 10
    s_add_u32 s53, s53, 0x900000
    v_cvt_pk_bf16_f32 v200, v52, v53
    v_cvt_pk_bf16_f32 v201, v54, v55
    v_cvt_pk_bf16_f32 v202, v56, v57
    v_cvt_pk_bf16_f32 v203, v58, v59
    v_cvt_pk_bf16_f32 v204, v60, v61
    v_cvt_pk_bf16_f32 v205, v62, v63
    v_cvt_pk_bf16_f32 v206, v64, v65
    v_cvt_pk_bf16_f32 v207, v66, v67
    buffer_store_dwordx4 v[200:203], v28, s[28:31], s68 offen sc0 sc1
    buffer_store_dwordx4 v[204:207], v28, s[28:31], s68 offen offset:1024 sc0 sc1
    s_cmp_lg_u32 s52, 0
    s_cbranch_scc1 hh_k1_noph0
    buffer_store_dwordx4 v[44:47], v28, s[28:31], s53 offen sc0 sc1
    buffer_store_dwordx4 v[48:51], v28, s[28:31], s53 offen offset:1024 sc0 sc1
hh_k1_noph0:
    v_pk_mul_f32 v[84:85], v[198:199], v[84:85] op_sel_hi:[0,1]
    v_pk_mul_f32 v[86:87], v[198:199], v[86:87] op_sel_hi:[0,1]
    v_pk_mul_f32 v[88:89], v[198:199], v[88:89] op_sel_hi:[0,1]
    v_pk_mul_f32 v[90:91], v[198:199], v[90:91] op_sel_hi:[0,1]
    v_pk_mul_f32 v[92:93], v[198:199], v[92:93] op_sel_hi:[0,1]
    v_pk_mul_f32 v[94:95], v[198:199], v[94:95] op_sel_hi:[0,1]
    v_pk_mul_f32 v[96:97], v[198:199], v[96:97] op_sel_hi:[0,1]
    v_pk_mul_f32 v[98:99], v[198:199], v[98:99] op_sel_hi:[0,1]
    v_pk_mul_f32 v[68:69], v[198:199], v[68:69] op_sel_hi:[0,1]
    v_pk_mul_f32 v[70:71], v[198:199], v[70:71] op_sel_hi:[0,1]
    v_pk_mul_f32 v[72:73], v[198:199], v[72:73] op_sel_hi:[0,1]
    v_pk_mul_f32 v[74:75], v[198:199], v[74:75] op_sel_hi:[0,1]
    v_pk_mul_f32 v[76:77], v[198:199], v[76:77] op_sel_hi:[0,1]
    v_pk_mul_f32 v[78:79], v[198:199], v[78:79] op_sel_hi:[0,1]
    v_pk_mul_f32 v[80:81], v[198:199], v[80:81] op_sel_hi:[0,1]
    v_pk_mul_f32 v[82:83], v[198:199], v[82:83] op_sel_hi:[0,1]
    v_and_b32 v10, 31, v1
    s_lshl_b32 s52, s45, 5
    v_add_u32 v10, s52, v10
    v_lshlrev_b32 v10, 6, v10
    v_lshrrev_b32 v11, 5, v1
    v_bfe_u32 v12, v1, 2, 3
    v_xor_b32 v11, v11, v12
    v_lshl_add_u32 v212, v11, 3, v10
    v_xor_b32 v213, 16, v212
    v_xor_b32 v214, 32, v212
    v_xor_b32 v215, 48, v212
    v_mov_b32 v220, 0x3fb8aa3b
    v_cvt_pk_bf16_f32 v124, v84, v85
    v_cvt_pk_bf16_f32 v125, v86, v87
    v_cvt_pk_bf16_f32 v126, v88, v89
    v_cvt_pk_bf16_f32 v127, v90, v91
    v_cvt_pk_bf16_f32 v128, v92, v93
    v_cvt_pk_bf16_f32 v129, v94, v95
    v_cvt_pk_bf16_f32 v130, v96, v97
    v_cvt_pk_bf16_f32 v131, v98, v99
    ds_write_b64 v212, v[124:125] offset:32768
    ds_write_b64 v213, v[126:127] offset:32768
    ds_write_b64 v214, v[128:129] offset:32768
    ds_write_b64 v215, v[130:131] offset:32768
    s_mov_b32 s55, 0x3fb8aa3b
    v_cvt_pk_bf16_f32 v100, v68, v69
    v_cvt_pk_bf16_f32 v101, v70, v71
    v_cvt_pk_bf16_f32 v102, v72, v73
    v_cvt_pk_bf16_f32 v103, v74, v75
    v_cvt_pk_bf16_f32 v104, v76, v77
    v_cvt_pk_bf16_f32 v105, v78, v79
    v_cvt_pk_bf16_f32 v106, v80, v81
    v_cvt_pk_bf16_f32 v107, v82, v83
    v_mfma_f32_32x32x16_bf16 v[164:179], v[44:47], v[100:103], 0
    s_nop 0
    v_mfma_f32_32x32x16_bf16 v[180:195], v[48:51], v[104:107], 0
    s_nop 9
    v_max3_f32 v216, v164, v165, v166
    v_max3_f32 v216, v216, v167, v168
    v_max3_f32 v216, v216, v169, v170
    v_max3_f32 v216, v216, v171, v172
    v_max3_f32 v216, v216, v173, v174
    v_max3_f32 v216, v216, v175, v176
    v_max3_f32 v216, v216, v177, v178
    v_max_f32 v216, v216, v179
    v_mul_f32 v216, 0xbfb8aa3b, v216
    v_pk_fma_f32 v[164:165], v[164:165], v[220:221], v[216:217] op_sel_hi:[1,0,0]
    v_pk_fma_f32 v[166:167], v[166:167], v[220:221], v[216:217] op_sel_hi:[1,0,0]
    v_pk_fma_f32 v[168:169], v[168:169], v[220:221], v[216:217] op_sel_hi:[1,0,0]
    v_pk_fma_f32 v[170:171], v[170:171], v[220:221], v[216:217] op_sel_hi:[1,0,0]
    v_pk_fma_f32 v[172:173], v[172:173], v[220:221], v[216:217] op_sel_hi:[1,0,0]
    v_pk_fma_f32 v[174:175], v[174:175], v[220:221], v[216:217] op_sel_hi:[1,0,0]
    v_pk_fma_f32 v[176:177], v[176:177], v[220:221], v[216:217] op_sel_hi:[1,0,0]
    v_pk_fma_f32 v[178:179], v[178:179], v[220:221], v[216:217] op_sel_hi:[1,0,0]
    v_exp_f32 v164, v164
    v_exp_f32 v165, v165
    v_exp_f32 v166, v166
    v_exp_f32 v167, v167
    v_exp_f32 v168, v168
    v_exp_f32 v169, v169
    v_exp_f32 v170, v170
    v_exp_f32 v171, v171
    v_exp_f32 v172, v172
    v_pk_add_f32 v[218:219], v[164:165], v[166:167]
    v_exp_f32 v173, v173
    v_pk_add_f32 v[218:219], v[218:219], v[168:169]
    v_exp_f32 v174, v174
    v_pk_add_f32 v[218:219], v[218:219], v[170:171]
    v_exp_f32 v175, v175
    v_exp_f32 v176, v176
    v_exp_f32 v177, v177
    v_exp_f32 v178, v178
    v_exp_f32 v179, v179
    v_pk_add_f32 v[218:219], v[218:219], v[172:173]
    v_pk_add_f32 v[218:219], v[218:219], v[174:175]
    v_pk_add_f32 v[218:219], v[218:219], v[176:177]
    v_pk_add_f32 v[218:219], v[218:219], v[178:179]
    v_add_f32 v218, v218, v219
    v_rcp_f32 v218, v218
    s_nop 0
    v_pk_mul_f32 v[164:165], v[218:219], v[164:165] op_sel_hi:[0,1]
    v_pk_mul_f32 v[166:167], v[218:219], v[166:167] op_sel_hi:[0,1]
    v_pk_mul_f32 v[168:169], v[218:219], v[168:169] op_sel_hi:[0,1]
    v_pk_mul_f32 v[170:171], v[218:219], v[170:171] op_sel_hi:[0,1]
    v_pk_mul_f32 v[172:173], v[218:219], v[172:173] op_sel_hi:[0,1]
    v_pk_mul_f32 v[174:175], v[218:219], v[174:175] op_sel_hi:[0,1]
    v_pk_mul_f32 v[176:177], v[218:219], v[176:177] op_sel_hi:[0,1]
    v_pk_mul_f32 v[178:179], v[218:219], v[178:179] op_sel_hi:[0,1]
    v_cvt_pk_bf16_f32 v124, v164, v165
    v_cvt_pk_bf16_f32 v125, v166, v167
    v_cvt_pk_bf16_f32 v126, v168, v169
    v_cvt_pk_bf16_f32 v127, v170, v171
    v_cvt_pk_bf16_f32 v128, v172, v173
    v_cvt_pk_bf16_f32 v129, v174, v175
    v_cvt_pk_bf16_f32 v130, v176, v177
    v_cvt_pk_bf16_f32 v131, v178, v179
    ds_write_b64 v212, v[124:125]
    ds_write_b64 v213, v[126:127]
    ds_write_b64 v214, v[128:129]
    ds_write_b64 v215, v[130:131]
    v_max3_f32 v216, v180, v181, v182
    v_max3_f32 v216, v216, v183, v184
    v_max3_f32 v216, v216, v185, v186
    v_max3_f32 v216, v216, v187, v188
    v_max3_f32 v216, v216, v189, v190
    v_max3_f32 v216, v216, v191, v192
    v_max3_f32 v216, v216, v193, v194
    v_max_f32 v216, v216, v195
    v_mul_f32 v216, 0xbfb8aa3b, v216
    v_pk_fma_f32 v[180:181], v[180:181], v[220:221], v[216:217] op_sel_hi:[1,0,0]
    v_pk_fma_f32 v[182:183], v[182:183], v[220:221], v[216:217] op_sel_hi:[1,0,0]
    v_pk_fma_f32 v[184:185], v[184:185], v[220:221], v[216:217] op_sel_hi:[1,0,0]
    v_pk_fma_f32 v[186:187], v[186:187], v[220:221], v[216:217] op_sel_hi:[1,0,0]
    v_pk_fma_f32 v[188:189], v[188:189], v[220:221], v[216:217] op_sel_hi:[1,0,0]
    v_pk_fma_f32 v[190:191], v[190:191], v[220:221], v[216:217] op_sel_hi:[1,0,0]
    v_pk_fma_f32 v[192:193], v[192:193], v[220:221], v[216:217] op_sel_hi:[1,0,0]
    v_pk_fma_f32 v[194:195], v[194:195], v[220:221], v[216:217] op_sel_hi:[1,0,0]
    v_exp_f32 v180, v180
    v_exp_f32 v181, v181
    v_exp_f32 v182, v182
    v_exp_f32 v183, v183
    v_exp_f32 v184, v184
    v_exp_f32 v185, v185
    v_exp_f32 v186, v186
    v_exp_f32 v187, v187
    v_exp_f32 v188, v188
    v_pk_add_f32 v[218:219], v[180:181], v[182:183]
    v_exp_f32 v189, v189
    v_pk_add_f32 v[218:219], v[218:219], v[184:185]
    v_exp_f32 v190, v190
    v_pk_add_f32 v[218:219], v[218:219], v[186:187]
    v_exp_f32 v191, v191
    v_exp_f32 v192, v192
    v_exp_f32 v193, v193
    v_exp_f32 v194, v194
    v_exp_f32 v195, v195
    v_pk_add_f32 v[218:219], v[218:219], v[188:189]
    v_pk_add_f32 v[218:219], v[218:219], v[190:191]
    v_pk_add_f32 v[218:219], v[218:219], v[192:193]
    v_pk_add_f32 v[218:219], v[218:219], v[194:195]
    v_add_f32 v218, v218, v219
    v_rcp_f32 v218, v218
    s_nop 0
    v_pk_mul_f32 v[180:181], v[218:219], v[180:181] op_sel_hi:[0,1]
    v_pk_mul_f32 v[182:183], v[218:219], v[182:183] op_sel_hi:[0,1]
    v_pk_mul_f32 v[184:185], v[218:219], v[184:185] op_sel_hi:[0,1]
    v_pk_mul_f32 v[186:187], v[218:219], v[186:187] op_sel_hi:[0,1]
    v_pk_mul_f32 v[188:189], v[218:219], v[188:189] op_sel_hi:[0,1]
    v_pk_mul_f32 v[190:191], v[218:219], v[190:191] op_sel_hi:[0,1]
    v_pk_mul_f32 v[192:193], v[218:219], v[192:193] op_sel_hi:[0,1]
    v_pk_mul_f32 v[194:195], v[218:219], v[194:195] op_sel_hi:[0,1]
    v_cvt_pk_bf16_f32 v124, v180, v181
    v_cvt_pk_bf16_f32 v125, v182, v183
    v_cvt_pk_bf16_f32 v126, v184, v185
    v_cvt_pk_bf16_f32 v127, v186, v187
    v_cvt_pk_bf16_f32 v128, v188, v189
    v_cvt_pk_bf16_f32 v129, v190, v191
    v_cvt_pk_bf16_f32 v130, v192, v193
    v_cvt_pk_bf16_f32 v131, v194, v195
    ds_write_b64 v212, v[124:125] offset:8192
    ds_write_b64 v213, v[126:127] offset:8192
    ds_write_b64 v214, v[128:129] offset:8192
    ds_write_b64 v215, v[130:131] offset:8192
    s_waitcnt lgkmcnt(0)
    s_barrier
    v_lshrrev_b32 v11, 5, v1
    v_bfe_u32 v12, v1, 2, 2
    v_lshl_add_u32 v11, v11, 3, v12
    v_lshlrev_b32 v11, 6, v11
    v_and_b32 v12, 3, v1
    v_lshl_add_u32 v11, v12, 3, v11
    v_bfe_u32 v12, v1, 4, 1
    v_lshl_add_u32 v12, v12, 5, v11
    s_lshl_b32 s52, s45, 13
    v_add_u32 v222, s52, v12
    s_lshr_b32 s52, s45, 1
    s_lshl_b32 s52, s52, 13
    s_and_b32 s53, s45, 1
    s_lshl_b32 s53, s53, 5
    s_add_u32 s52, s52, s53
    s_add_u32 s52, s52, 0x8000
    v_add_u32 v223, s52, v11
    v_lshrrev_b32 v11, 5, v1
    v_lshlrev_b32 v11, 4, v11
    v_xor_b32 v222, v222, v11
    v_xor_b32 v223, v223, v11
    v_xor_b32 v225, 8, v222
    v_xor_b32 v228, 8, v223
    v_xor_b32 v226, 32, v222
    v_xor_b32 v229, 32, v223
    v_xor_b32 v227, 40, v222
    v_xor_b32 v230, 40, v223
    v_mov_b32 v224, 0x3f803f80
    s_mov_b32 s62, 0xffff0000
    s_mov_b32 s63, 0xffff0000
    ds_read_b64_tr_b16 v[68:69], v222
    ds_read_b64_tr_b16 v[70:71], v225 offset:256
    ds_read_b64_tr_b16 v[72:73], v223
    ds_read_b64_tr_b16 v[74:75], v228 offset:256
    ds_read_b64_tr_b16 v[76:77], v226 offset:1024
    ds_read_b64_tr_b16 v[78:79], v227 offset:1280
    ds_read_b64_tr_b16 v[80:81], v229 offset:1024
    ds_read_b64_tr_b16 v[82:83], v230 offset:1280
    ds_read_b64_tr_b16 v[84:85], v222 offset:2048
    ds_read_b64_tr_b16 v[86:87], v225 offset:2304
    ds_read_b64_tr_b16 v[88:89], v223 offset:2048
    ds_read_b64_tr_b16 v[90:91], v228 offset:2304
    ds_read_b64_tr_b16 v[92:93], v226 offset:3072
    ds_read_b64_tr_b16 v[94:95], v227 offset:3328
    ds_read_b64_tr_b16 v[96:97], v229 offset:3072
    ds_read_b64_tr_b16 v[98:99], v230 offset:3328
    s_waitcnt lgkmcnt(13)
    v_cndmask_b32_e64 v72, v72, v224, s[62:63]
    v_cndmask_b32_e64 v73, v73, v224, s[62:63]
    s_waitcnt lgkmcnt(12)
    v_cndmask_b32_e64 v74, v74, v224, s[62:63]
    v_cndmask_b32_e64 v75, v75, v224, s[62:63]
    s_nop 1
    v_mfma_f32_32x32x16_bf16 v[164:179], v[68:71], v[72:75], 0
    ds_read_b64_tr_b16 v[108:109], v222 offset:4096
    ds_read_b64_tr_b16 v[110:111], v225 offset:4352
    ds_read_b64_tr_b16 v[112:113], v223 offset:4096
    ds_read_b64_tr_b16 v[114:115], v228 offset:4352
    s_waitcnt lgkmcnt(13)
    v_cndmask_b32_e64 v80, v80, v224, s[62:63]
    v_cndmask_b32_e64 v81, v81, v224, s[62:63]
    s_waitcnt lgkmcnt(12)
    v_cndmask_b32_e64 v82, v82, v224, s[62:63]
    v_cndmask_b32_e64 v83, v83, v224, s[62:63]
    s_nop 1
    v_mfma_f32_32x32x16_bf16 v[164:179], v[76:79], v[80:83], v[164:179]
    ds_read_b64_tr_b16 v[116:117], v226 offset:5120
    ds_read_b64_tr_b16 v[118:119], v227 offset:5376
    ds_read_b64_tr_b16 v[120:121], v229 offset:5120
    ds_read_b64_tr_b16 v[122:123], v230 offset:5376
    s_waitcnt lgkmcnt(13)
    v_cndmask_b32_e64 v88, v88, v224, s[62:63]
    v_cndmask_b32_e64 v89, v89, v224, s[62:63]
    s_waitcnt lgkmcnt(12)
    v_cndmask_b32_e64 v90, v90, v224, s[62:63]
    v_cndmask_b32_e64 v91, v91, v224, s[62:63]
    s_nop 1
    v_mfma_f32_32x32x16_bf16 v[164:179], v[84:87], v[88:91], v[164:179]
    ds_read_b64_tr_b16 v[52:53], v222 offset:6144
    ds_read_b64_tr_b16 v[54:55], v225 offset:6400
    ds_read_b64_tr_b16 v[56:57], v223 offset:6144
    ds_read_b64_tr_b16 v[58:59], v228 offset:6400
    s_waitcnt lgkmcnt(13)
    v_cndmask_b32_e64 v96, v96, v224, s[62:63]
    v_cndmask_b32_e64 v97, v97, v224, s[62:63]
    s_waitcnt lgkmcnt(12)
    v_cndmask_b32_e64 v98, v98, v224, s[62:63]
    v_cndmask_b32_e64 v99, v99, v224, s[62:63]
    s_nop 1
    v_mfma_f32_32x32x16_bf16 v[164:179], v[92:95], v[96:99], v[164:179]
    ds_read_b64_tr_b16 v[60:61], v226 offset:7168
    ds_read_b64_tr_b16 v[62:63], v227 offset:7424
    ds_read_b64_tr_b16 v[64:65], v229 offset:7168
    ds_read_b64_tr_b16 v[66:67], v230 offset:7424
    s_waitcnt lgkmcnt(13)
    v_cndmask_b32_e64 v112, v112, v224, s[62:63]
    v_cndmask_b32_e64 v113, v113, v224, s[62:63]
    s_waitcnt lgkmcnt(12)
    v_cndmask_b32_e64 v114, v114, v224, s[62:63]
    v_cndmask_b32_e64 v115, v115, v224, s[62:63]
    s_nop 1
    v_mfma_f32_32x32x16_bf16 v[164:179], v[108:111], v[112:115], v[164:179]
    s_waitcnt lgkmcnt(9)
    v_cndmask_b32_e64 v120, v120, v224, s[62:63]
    v_cndmask_b32_e64 v121, v121, v224, s[62:63]
    s_waitcnt lgkmcnt(8)
    v_cndmask_b32_e64 v122, v122, v224, s[62:63]
    v_cndmask_b32_e64 v123, v123, v224, s[62:63]
    s_nop 1
    v_mfma_f32_32x32x16_bf16 v[164:179], v[116:119], v[120:123], v[164:179]
    s_waitcnt lgkmcnt(5)
    v_cndmask_b32_e64 v56, v56, v224, s[62:63]
    v_cndmask_b32_e64 v57, v57, v224, s[62:63]
    s_waitcnt lgkmcnt(4)
    v_cndmask_b32_e64 v58, v58, v224, s[62:63]
    v_cndmask_b32_e64 v59, v59, v224, s[62:63]
    s_nop 1
    v_mfma_f32_32x32x16_bf16 v[164:179], v[52:55], v[56:59], v[164:179]
    s_waitcnt lgkmcnt(1)
    v_cndmask_b32_e64 v64, v64, v224, s[62:63]
    v_cndmask_b32_e64 v65, v65, v224, s[62:63]
    s_waitcnt lgkmcnt(0)
    v_cndmask_b32_e64 v66, v66, v224, s[62:63]
    v_cndmask_b32_e64 v67, v67, v224, s[62:63]
    s_nop 1
    v_mfma_f32_32x32x16_bf16 v[164:179], v[60:63], v[64:67], v[164:179]
    s_lshl_b32 s52, s47, 5
    s_lshl_b32 s53, s48, 2
    s_add_u32 s52, s52, s53
    s_add_u32 s52, s52, s45
    s_lshl_b32 s68, s52, 11
    s_add_u32 s68, s68, 0xe00000
    s_nop 5
    v_cvt_pk_bf16_f32 v200, v164, v165
    v_cvt_pk_bf16_f32 v201, v166, v167
    v_cvt_pk_bf16_f32 v202, v168, v169
    v_cvt_pk_bf16_f32 v203, v170, v171
    v_cvt_pk_bf16_f32 v204, v172, v173
    v_cvt_pk_bf16_f32 v205, v174, v175
    v_cvt_pk_bf16_f32 v206, v176, v177
    v_cvt_pk_bf16_f32 v207, v178, v179
    buffer_store_dwordx4 v[200:203], v28, s[28:31], s68 offen sc0 sc1
    buffer_store_dwordx4 v[204:207], v28, s[28:31], s68 offen offset:1024 sc0 sc1
    s_waitcnt vmcnt(0)
    s_endpgm
hh_k1_r1:
    v_lshrrev_b32 v11, 3, v1
    v_lshrrev_b32 v12, 4, v1
    v_and_b32 v13, 7, v1
    s_lshl_b32 s52, s44, 4
    v_add_u32 v14, s52, v11
    v_lshlrev_b32 v5, 10, v14
    v_xor_b32 v14, v13, v12
    v_lshl_add_u32 v5, v14, 4, v5
    v_add_u32 v14, s52, v11
    v_add_u32 v14, 8, v14
    v_lshlrev_b32 v6, 10, v14
    v_xor_b32 v14, v13, v12
    v_xor_b32 v14, 4, v14
    v_lshl_add_u32 v6, v14, 4, v6
    s_add_u32 s53, s44, 4
    s_and_b32 s53, s53, 7
    s_lshl_b32 s59, s53, 10
    s_add_u32 s59, s59, 0xc000
    s_lshl_b32 s58, s44, 11
    s_lshl_b32 s53, s53, 6
    v_add_u32 v11, s53, v1
    v_mul_u32_u24 v12, 0x925, v11
    v_lshrrev_b32 v12, 16, v12
    v_mul_u32_u24 v13, 28, v12
    v_sub_u32 v13, v11, v13
    v_mul_u32_u24 v7, 0xc00, v12
    v_lshrrev_b32 v14, 3, v13
    v_lshl_add_u32 v7, v14, 10, v7
    v_and_b32 v14, 7, v13
    v_lshl_add_u32 v7, v14, 4, v7
    v_cmp_le_u32 vcc, 24, v13
    v_mov_b32 v14, 0x80000000
    s_nop 0
    v_cndmask_b32 v7, v7, v14, vcc
    v_add_u32 v11, s53, v1
    v_add_u32 v11, 0x200, v11
    v_mul_u32_u24 v12, 0x925, v11
    v_lshrrev_b32 v12, 16, v12
    v_mul_u32_u24 v13, 28, v12
    v_sub_u32 v13, v11, v13
    v_mul_u32_u24 v8, 0xc00, v12
    v_lshrrev_b32 v14, 3, v13
    v_lshl_add_u32 v8, v14, 10, v8
    v_and_b32 v14, 7, v13
    v_lshl_add_u32 v8, v14, 4, v8
    v_cmp_le_u32 vcc, 24, v13
    v_mov_b32 v14, 0x80000000
    s_nop 0
    v_cndmask_b32 v8, v8, v14, vcc
    v_add_u32 v11, s53, v1
    v_add_u32 v11, 0x400, v11
    v_mul_u32_u24 v12, 0x925, v11
    v_lshrrev_b32 v12, 16, v12
    v_mul_u32_u24 v13, 28, v12
    v_sub_u32 v13, v11, v13
    v_mul_u32_u24 v9, 0xc00, v12
    v_lshrrev_b32 v14, 3, v13
    v_lshl_add_u32 v9, v14, 10, v9
    v_and_b32 v14, 7, v13
    v_lshl_add_u32 v9, v14, 4, v9
    v_cmp_le_u32 vcc, 24, v13
    v_mov_b32 v14, 0x80000000
    s_nop 0
    v_cndmask_b32 v9, v9, v14, vcc
    v_add_u32 v11, s53, v1
    v_add_u32 v11, 0x600, v11
    v_mul_u32_u24 v12, 0x925, v11
    v_lshrrev_b32 v12, 16, v12
    v_mul_u32_u24 v13, 28, v12
    v_sub_u32 v13, v11, v13
    v_mul_u32_u24 v10, 0xc00, v12
    v_lshrrev_b32 v14, 3, v13
    v_lshl_add_u32 v10, v14, 10, v10
    v_and_b32 v14, 7, v13
    v_lshl_add_u32 v10, v14, 4, v10
    v_cmp_le_u32 vcc, 24, v13
    v_mov_b32 v14, 0x80000000
    s_nop 0
    v_cndmask_b32 v10, v10, v14, vcc
    s_mov_b32 s56, 0
    s_mov_b32 s57, 0
    s_waitcnt lgkmcnt(0)
    s_lshl_b32 s52, s47, 17
    s_add_u32 s20, s4, s52
    s_addc_u32 s21, s5, 0
    s_mov_b32 s22, 0x20000
    s_mov_b32 s23, 0x20000
    s_lshl_b32 s52, s48, 7
    s_add_u32 s24, s6, s52
    s_addc_u32 s25, s7, 0
    s_mov_b32 s26, 0x17fc80
    s_mov_b32 s27, 0x20000
    s_mov_b32 s28, s16
    s_mov_b32 s29, s17
    s_mov_b32 s30, 0x1600000
    s_mov_b32 s31, 0x20000
    s_mov_b32 s56, 0
    s_add_u32 m0, s58, 0
    s_nop 0
    buffer_load_dwordx4 v5, s[20:23], s56 offen lds
    s_mov_b32 s56, 0
    s_add_u32 m0, s58, 0x400
    s_nop 0
    buffer_load_dwordx4 v6, s[20:23], s56 offen lds
    s_mov_b32 s57, 0
    s_add_u32 m0, s59, 0
    s_nop 0
    buffer_load_dwordx4 v7, s[24:27], s57 offen lds
    s_mov_b32 s57, 0
    s_add_u32 m0, s59, 0x2000
    s_nop 0
    buffer_load_dwordx4 v8, s[24:27], s57 offen lds
    s_mov_b32 s57, 0
    s_add_u32 m0, s59, 0x4000
    s_nop 0
    buffer_load_dwordx4 v9, s[24:27], s57 offen lds
    s_mov_b32 s57, 0
    s_add_u32 m0, s59, 0x6000
    s_nop 0
    buffer_load_dwordx4 v10, s[24:27], s57 offen lds
    s_barrier
    v_and_b32 v11, 31, v1
    s_lshl_b32 s52, s45, 5
    v_add_u32 v11, s52, v11
    v_lshlrev_b32 v11, 7, v11
    v_lshrrev_b32 v12, 5, v1
    v_bfe_u32 v13, v1, 1, 3
    v_xor_b32 v12, v12, v13
    v_lshl_add_u32 v11, v12, 4, v11
    v_lshrrev_b32 v12, 5, v1
    v_bfe_u32 v13, v1, 2, 2
    v_lshl_add_u32 v12, v12, 3, v13
    v_mul_u32_u24 v12, 0x1c0, v12
    v_bfe_u32 v13, v1, 4, 1
    v_lshl_add_u32 v12, v13, 5, v12
    v_and_b32 v13, 3, v1
    v_lshl_add_u32 v12, v13, 3, v12
    v_add_u32 v12, 0xc040, v12
    s_add_u32 s52, s45, 2
    s_and_b32 s52, s52, 3
    s_lshl_b32 s53, s52, 5
    v_xor_b32 v15, s53, v11
    s_mul_i32 s53, s52, 0x1c00
    v_add_u32 v19, s53, v12
    v_add_u32 v23, 0xe000, v19
    s_add_u32 s52, s45, 3
    s_and_b32 s52, s52, 3
    s_lshl_b32 s53, s52, 5
    v_xor_b32 v16, s53, v11
    s_mul_i32 s53, s52, 0x1c00
    v_add_u32 v20, s53, v12
    v_add_u32 v24, 0xe000, v20
    s_add_u32 s52, s45, 4
    s_and_b32 s52, s52, 3
    s_lshl_b32 s53, s52, 5
    v_xor_b32 v17, s53, v11
    s_mul_i32 s53, s52, 0x1c00
    v_add_u32 v21, s53, v12
    v_add_u32 v25, 0xe000, v21
    s_add_u32 s52, s45, 5
    s_and_b32 s52, s52, 3
    s_lshl_b32 s53, s52, 5
    v_xor_b32 v18, s53, v11
    s_mul_i32 s53, s52, 0x1c00
    v_add_u32 v22, s53, v12
    v_add_u32 v26, 0xe000, v22
    s_mov_b32 s56, 0x80
    s_add_u32 m0, s58, 0x4000
    s_nop 0
    buffer_load_dwordx4 v5, s[20:23], s56 offen lds
    s_mov_b32 s56, 0x80
    s_add_u32 m0, s58, 0x4400
    s_nop 0
    buffer_load_dwordx4 v6, s[20:23], s56 offen lds
    s_mov_b32 s57, 0x30000
    s_add_u32 m0, s59, 0x7000
    s_nop 0
    buffer_load_dwordx4 v7, s[24:27], s57 offen lds
    s_mov_b32 s57, 0x30000
    s_add_u32 m0, s59, 0x9000
    s_nop 0
    buffer_load_dwordx4 v8, s[24:27], s57 offen lds
    s_mov_b32 s57, 0x30000
    s_add_u32 m0, s59, 0xb000
    s_nop 0
    buffer_load_dwordx4 v9, s[24:27], s57 offen lds
    s_mov_b32 s57, 0x30000
    s_add_u32 m0, s59, 0xd000
    s_nop 0
    buffer_load_dwordx4 v10, s[24:27], s57 offen lds
    v_lshrrev_b32 v12, 2, v1
    v_and_b32 v13, 3, v1
    v_lshlrev_b32 v13, 4, v13
    v_lshl_add_u32 v27, v12, 10, v13
    v_lshlrev_b32 v28, 4, v1
    s_mov_b32 s55, s61
    s_lshr_b32 s52, s55, 4
    s_and_b32 s53, s55, 15
    s_mul_i32 s66, s53, 0x90
    s_add_u32 s66, s66, s52
    s_lshl_b32 s66, s66, 10
    s_add_u32 s66, s66, 0xb00000
    s_cmp_ge_u32 s52, 0x70
    s_cselect_b32 s32, s10, s14
    s_cselect_b32 s33, s11, s15
    s_mov_b32 s55, 0x1c0000
    s_cselect_b32 s34, 0x80000, s55
    s_mov_b32 s35, 0x20000
    s_cselect_b32 s54, 0x70, 0
    s_sub_u32 s54, s52, s54
    s_lshl_b32 s64, s54, 14
    s_lshl_b32 s53, s53, 6
    s_add_u32 s64, s64, s53
    s_add_u32 s55, s61, 0x400
    s_lshr_b32 s52, s55, 4
    s_and_b32 s53, s55, 15
    s_mul_i32 s67, s53, 0x90
    s_add_u32 s67, s67, s52
    s_lshl_b32 s67, s67, 10
    s_add_u32 s67, s67, 0xb00000
    s_cmp_ge_u32 s52, 0x70
    s_cselect_b32 s36, s10, s14
    s_cselect_b32 s37, s11, s15
    s_mov_b32 s55, 0x1c0000
    s_cselect_b32 s38, 0x80000, s55
    s_mov_b32 s39, 0x20000
    s_cselect_b32 s54, 0x70, 0
    s_sub_u32 s54, s52, s54
    s_lshl_b32 s65, s54, 14
    s_lshl_b32 s53, s53, 6
    s_add_u32 s65, s65, s53
    s_lshl_b32 s18, s44, 10
    s_add_u32 s18, s18, 0x21000
    v_lshrrev_b32 v12, 5, v1
    v_bfe_u32 v13, v1, 2, 2
    v_lshl_add_u32 v12, v12, 2, v13
    v_bfe_u32 v13, v1, 4, 1
    v_and_b32 v14, 3, v1
    v_lshl_add_u32 v40, v13, 2, v14
    v_lshlrev_b32 v40, 3, v40
    v_lshl_add_u32 v40, v12, 6, v40
    v_add_u32 v40, s18, v40
    s_mov_b32 s40, s8
    s_mov_b32 s41, s9
    s_mov_b32 s42, 0x4000
    s_mov_b32 s43, 0x20000
    v_lshrrev_b32 v14, 1, v14
    v_lshl_add_u32 v41, v13, 1, v14
    v_lshlrev_b32 v41, 3, v41
    v_lshl_add_u32 v41, v12, 5, v41
    v_bfe_u32 v12, v1, 2, 1
    s_mov_b32 s52, 0x80008000
    v_mul_lo_u32 v42, v12, s52
    s_lshl_b32 s52, s48, 2
    s_add_u32 s52, s52, 2
    s_lshl_b32 s69, s52, 9
    v_add_u32 v41, 0x20000, v41
    v_lshrrev_b32 v12, 4, v1
    v_xor_b32 v12, v12, v1
    v_and_b32 v12, 1, v12
    v_cmp_eq_u32 vcc, 0, v12
    v_mov_b32 v12, 0
    v_mov_b32 v13, 0x3f803f80
    v_cndmask_b32 v148, v12, v13, vcc
    v_cndmask_b32 v149, v12, v13, vcc
    v_cndmask_b32 v150, v12, v13, vcc
    v_cndmask_b32 v151, v12, v13, vcc
    s_mov_b32 s60, 0xffff0000
    v_mov_b32 v132, 0
    v_mov_b32 v133, 0
    v_mov_b32 v134, 0
    v_mov_b32 v135, 0
    s_waitcnt vmcnt(6)
    s_barrier
    ds_read_b128 v[100:103], v15
    ds_read_b64_tr_b16 v[108:109], v19
    ds_read_b64_tr_b16 v[110:111], v19 offset:1792
    ds_read_b64_tr_b16 v[112:113], v19 offset:128
    ds_read_b64_tr_b16 v[114:115], v19 offset:1920
    ds_read_b64_tr_b16 v[116:117], v19 offset:256
    ds_read_b64_tr_b16 v[118:119], v19 offset:2048
    s_waitcnt lgkmcnt(4)
    v_mfma_f32_32x32x16_bf16 v[52:67], v[108:111], v[100:103], 0
    ds_read_b128 v[104:107], v16
    ds_read_b64_tr_b16 v[120:121], v20
    ds_read_b64_tr_b16 v[122:123], v20 offset:1792
    v_mfma_f32_16x16x32_bf16 v[136:139], v[108:111], v[148:151], 0
    v_lshlrev_b32 v152, 16, v102
    v_and_b32 v153, s60, v102
    v_add_f32 v132, v132, v152
    v_add_f32 v134, v134, v153
    s_waitcnt lgkmcnt(5)
    v_mfma_f32_32x32x16_bf16 v[68:83], v[112:115], v[100:103], 0
    ds_read_b64_tr_b16 v[124:125], v20 offset:128
    ds_read_b64_tr_b16 v[126:127], v20 offset:1920
    s_mov_b32 s56, 0x100
    s_add_u32 m0, s58, 0x8000
    s_nop 0
    buffer_load_dwordx4 v5, s[20:23], s56 offen lds
    v_fma_f32 v133, v152, v152, v133
    v_fma_f32 v135, v153, v153, v135
    v_lshlrev_b32 v154, 16, v103
    v_and_b32 v155, s60, v103
    s_waitcnt lgkmcnt(5)
    v_mfma_f32_32x32x16_bf16 v[84:99], v[116:119], v[100:103], 0
    ds_read_b64_tr_b16 v[128:129], v20 offset:256
    ds_read_b64_tr_b16 v[130:131], v20 offset:2048
    s_mov_b32 s56, 0x100
    s_add_u32 m0, s58, 0x8400
    s_nop 0
    buffer_load_dwordx4 v6, s[20:23], s56 offen lds
    v_add_f32 v132, v132, v154
    v_add_f32 v134, v134, v155
    v_fma_f32 v133, v154, v154, v133
    v_fma_f32 v135, v155, v155, v135
    s_waitcnt lgkmcnt(4)
    v_mfma_f32_32x32x16_bf16 v[52:67], v[120:123], v[104:107], v[52:67]
    ds_read_b128 v[100:103], v17
    ds_read_b64_tr_b16 v[108:109], v21
    ds_read_b64_tr_b16 v[110:111], v21 offset:1792
    v_lshlrev_b32 v152, 16, v106
    v_and_b32 v153, s60, v106
    v_add_f32 v132, v132, v152
    v_add_f32 v134, v134, v153
    s_waitcnt lgkmcnt(5)
    v_mfma_f32_32x32x16_bf16 v[68:83], v[124:127], v[104:107], v[68:83]
    ds_read_b64_tr_b16 v[112:113], v21 offset:128
    ds_read_b64_tr_b16 v[114:115], v21 offset:1920
    s_mov_b32 s57, 0x60000
    s_add_u32 m0, s59, 0xe000
    s_nop 0
    buffer_load_dwordx4 v7, s[24:27], s57 offen lds
    v_mfma_f32_16x16x32_bf16 v[140:143], v[124:127], v[148:151], 0
    v_fma_f32 v133, v152, v152, v133
    v_fma_f32 v135, v153, v153, v135
    v_lshlrev_b32 v154, 16, v107
    v_and_b32 v155, s60, v107
    s_waitcnt lgkmcnt(5)
    v_mfma_f32_32x32x16_bf16 v[84:99], v[128:131], v[104:107], v[84:99]
    ds_read_b64_tr_b16 v[116:117], v21 offset:256
    ds_read_b64_tr_b16 v[118:119], v21 offset:2048
    s_mov_b32 s57, 0x60000
    s_add_u32 m0, s59, 0x10000
    s_nop 0
    buffer_load_dwordx4 v8, s[24:27], s57 offen lds
    v_add_f32 v132, v132, v154
    v_add_f32 v134, v134, v155
    v_fma_f32 v133, v154, v154, v133
    v_fma_f32 v135, v155, v155, v135
    s_waitcnt lgkmcnt(4)
    v_mfma_f32_32x32x16_bf16 v[52:67], v[108:111], v[100:103], v[52:67]
    ds_read_b128 v[104:107], v18
    ds_read_b64_tr_b16 v[120:121], v22
    ds_read_b64_tr_b16 v[122:123], v22 offset:1792
    v_lshlrev_b32 v152, 16, v102
    v_and_b32 v153, s60, v102
    v_add_f32 v132, v132, v152
    v_add_f32 v134, v134, v153
    s_waitcnt lgkmcnt(5)
    v_mfma_f32_32x32x16_bf16 v[68:83], v[112:115], v[100:103], v[68:83]
    ds_read_b64_tr_b16 v[124:125], v22 offset:128
    ds_read_b64_tr_b16 v[126:127], v22 offset:1920
    s_mov_b32 s57, 0x60000
    s_add_u32 m0, s59, 0x12000
    s_nop 0
    buffer_load_dwordx4 v9, s[24:27], s57 offen lds
    v_fma_f32 v133, v152, v152, v133
    v_fma_f32 v135, v153, v153, v135
    v_lshlrev_b32 v154, 16, v103
    v_and_b32 v155, s60, v103
    s_waitcnt lgkmcnt(5)
    v_mfma_f32_32x32x16_bf16 v[84:99], v[116:119], v[100:103], v[84:99]
    ds_read_b64_tr_b16 v[128:129], v22 offset:256
    ds_read_b64_tr_b16 v[130:131], v22 offset:2048
    s_mov_b32 s57, 0x60000
    s_add_u32 m0, s59, 0x14000
    s_nop 0
    buffer_load_dwordx4 v10, s[24:27], s57 offen lds
    v_mfma_f32_16x16x32_bf16 v[144:147], v[116:119], v[148:151], 0
    v_add_f32 v132, v132, v154
    v_add_f32 v134, v134, v155
    v_fma_f32 v133, v154, v154, v133
    v_fma_f32 v135, v155, v155, v135
    s_waitcnt lgkmcnt(4)
    v_mfma_f32_32x32x16_bf16 v[52:67], v[120:123], v[104:107], v[52:67]
    v_lshlrev_b32 v152, 16, v106
    v_and_b32 v153, s60, v106
    v_add_f32 v132, v132, v152
    v_add_f32 v134, v134, v153
    s_waitcnt lgkmcnt(2)
    v_mfma_f32_32x32x16_bf16 v[68:83], v[124:127], v[104:107], v[68:83]
    s_waitcnt lgkmcnt(0)
    s_waitcnt vmcnt(6)
    s_barrier
    ds_read_b128 v[100:103], v15 offset:16384
    ds_read_b64_tr_b16 v[108:109], v19 offset:28672
    ds_read_b64_tr_b16 v[110:111], v19 offset:30464
    ds_read_b64_tr_b16 v[112:113], v19 offset:28800
    ds_read_b64_tr_b16 v[114:115], v19 offset:30592
    ds_read_b64_tr_b16 v[116:117], v19 offset:28928
    ds_read_b64_tr_b16 v[118:119], v19 offset:30720
    v_fma_f32 v133, v152, v152, v133
    v_fma_f32 v135, v153, v153, v135
    v_lshlrev_b32 v154, 16, v107
    v_and_b32 v155, s60, v107
    v_mfma_f32_32x32x16_bf16 v[84:99], v[128:131], v[104:107], v[84:99]
    v_add_f32 v132, v132, v154
    v_add_f32 v134, v134, v155
    v_fma_f32 v133, v154, v154, v133
    v_fma_f32 v135, v155, v155, v135
    s_waitcnt lgkmcnt(4)
    v_mfma_f32_32x32x16_bf16 v[52:67], v[108:111], v[100:103], v[52:67]
    ds_read_b128 v[104:107], v16 offset:16384
    ds_read_b64_tr_b16 v[120:121], v20 offset:28672
    ds_read_b64_tr_b16 v[122:123], v20 offset:30464
    s_mov_b32 s56, 0x180
    s_add_u32 m0, s58, 0
    s_nop 0
    buffer_load_dwordx4 v5, s[20:23], s56 offen lds
    v_mfma_f32_16x16x32_bf16 v[136:139], v[108:111], v[148:151], v[136:139]
    v_lshlrev_b32 v152, 16, v102
    v_and_b32 v153, s60, v102
    v_add_f32 v132, v132, v152
    v_add_f32 v134, v134, v153
    s_waitcnt lgkmcnt(5)
    v_mfma_f32_32x32x16_bf16 v[68:83], v[112:115], v[100:103], v[68:83]
    ds_read_b64_tr_b16 v[124:125], v20 offset:28800
    ds_read_b64_tr_b16 v[126:127], v20 offset:30592
    v_fma_f32 v133, v152, v152, v133
    v_fma_f32 v135, v153, v153, v135
    v_lshlrev_b32 v154, 16, v103
    v_and_b32 v155, s60, v103
    s_waitcnt lgkmcnt(5)
    v_mfma_f32_32x32x16_bf16 v[84:99], v[116:119], v[100:103], v[84:99]
    ds_read_b64_tr_b16 v[128:129], v20 offset:28928
    ds_read_b64_tr_b16 v[130:131], v20 offset:30720
    s_mov_b32 s56, 0x180
    s_add_u32 m0, s58, 0x400
    s_nop 0
    buffer_load_dwordx4 v6, s[20:23], s56 offen lds
    v_add_f32 v132, v132, v154
    v_add_f32 v134, v134, v155
    v_fma_f32 v133, v154, v154, v133
    v_fma_f32 v135, v155, v155, v135
    s_waitcnt lgkmcnt(4)
    v_mfma_f32_32x32x16_bf16 v[52:67], v[120:123], v[104:107], v[52:67]
    ds_read_b128 v[100:103], v17 offset:16384
    ds_read_b64_tr_b16 v[108:109], v21 offset:28672
    ds_read_b64_tr_b16 v[110:111], v21 offset:30464
    s_mov_b32 s57, 0x90000
    s_add_u32 m0, s59, 0
    s_nop 0
    buffer_load_dwordx4 v7, s[24:27], s57 offen lds
    v_lshlrev_b32 v152, 16, v106
    v_and_b32 v153, s60, v106
    v_add_f32 v132, v132, v152
    v_add_f32 v134, v134, v153
    s_waitcnt lgkmcnt(5)
    v_mfma_f32_32x32x16_bf16 v[68:83], v[124:127], v[104:107], v[68:83]
    ds_read_b64_tr_b16 v[112:113], v21 offset:28800
    ds_read_b64_tr_b16 v[114:115], v21 offset:30592
    v_mfma_f32_16x16x32_bf16 v[140:143], v[124:127], v[148:151], v[140:143]
    v_fma_f32 v133, v152, v152, v133
    v_fma_f32 v135, v153, v153, v135
    v_lshlrev_b32 v154, 16, v107
    v_and_b32 v155, s60, v107
    s_waitcnt lgkmcnt(5)
    v_mfma_f32_32x32x16_bf16 v[84:99], v[128:131], v[104:107], v[84:99]
    ds_read_b64_tr_b16 v[116:117], v21 offset:28928
    ds_read_b64_tr_b16 v[118:119], v21 offset:30720
    s_mov_b32 s57, 0x90000
    s_add_u32 m0, s59, 0x2000
    s_nop 0
    buffer_load_dwordx4 v8, s[24:27], s57 offen lds
    v_add_f32 v132, v132, v154
    v_add_f32 v134, v134, v155
    v_fma_f32 v133, v154, v154, v133
    v_fma_f32 v135, v155, v155, v135
    s_waitcnt lgkmcnt(4)
    v_mfma_f32_32x32x16_bf16 v[52:67], v[108:111], v[100:103], v[52:67]
    ds_read_b128 v[104:107], v18 offset:16384
    ds_read_b64_tr_b16 v[120:121], v22 offset:28672
    ds_read_b64_tr_b16 v[122:123], v22 offset:30464
    v_lshlrev_b32 v152, 16, v102
    v_and_b32 v153, s60, v102
    v_add_f32 v132, v132, v152
    v_add_f32 v134, v134, v153
    s_waitcnt lgkmcnt(5)
    v_mfma_f32_32x32x16_bf16 v[68:83], v[112:115], v[100:103], v[68:83]
    ds_read_b64_tr_b16 v[124:125], v22 offset:28800
    ds_read_b64_tr_b16 v[126:127], v22 offset:30592
    s_mov_b32 s57, 0x90000
    s_add_u32 m0, s59, 0x4000
    s_nop 0
    buffer_load_dwordx4 v9, s[24:27], s57 offen lds
    v_fma_f32 v133, v152, v152, v133
    v_fma_f32 v135, v153, v153, v135
    v_lshlrev_b32 v154, 16, v103
    v_and_b32 v155, s60, v103
    s_waitcnt lgkmcnt(5)
    v_mfma_f32_32x32x16_bf16 v[84:99], v[116:119], v[100:103], v[84:99]
    ds_read_b64_tr_b16 v[128:129], v22 offset:28928
    ds_read_b64_tr_b16 v[130:131], v22 offset:30720
    s_mov_b32 s57, 0x90000
    s_add_u32 m0, s59, 0x6000
    s_nop 0
    buffer_load_dwordx4 v10, s[24:27], s57 offen lds
    v_mfma_f32_16x16x32_bf16 v[144:147], v[116:119], v[148:151], v[144:147]
    v_add_f32 v132, v132, v154
    v_add_f32 v134, v134, v155
    v_fma_f32 v133, v154, v154, v133
    v_fma_f32 v135, v155, v155, v135
    s_waitcnt lgkmcnt(4)
    v_mfma_f32_32x32x16_bf16 v[52:67], v[120:123], v[104:107], v[52:67]
    v_lshlrev_b32 v152, 16, v106
    v_and_b32 v153, s60, v106
    v_add_f32 v132, v132, v152
    v_add_f32 v134, v134, v153
    s_waitcnt lgkmcnt(2)
    v_mfma_f32_32x32x16_bf16 v[68:83], v[124:127], v[104:107], v[68:83]
    s_waitcnt lgkmcnt(0)
    s_waitcnt vmcnt(6)
    s_barrier
    ds_read_b128 v[100:103], v15 offset:32768
    ds_read_b64_tr_b16 v[108:109], v23
    ds_read_b64_tr_b16 v[110:111], v23 offset:1792
    ds_read_b64_tr_b16 v[112:113], v23 offset:128
    ds_read_b64_tr_b16 v[114:115], v23 offset:1920
    ds_read_b64_tr_b16 v[116:117], v23 offset:256
    ds_read_b64_tr_b16 v[118:119], v23 offset:2048
    v_fma_f32 v133, v152, v152, v133
    v_fma_f32 v135, v153, v153, v135
    v_lshlrev_b32 v154, 16, v107
    v_and_b32 v155, s60, v107
    v_mfma_f32_32x32x16_bf16 v[84:99], v[128:131], v[104:107], v[84:99]
    v_add_f32 v132, v132, v154
    v_add_f32 v134, v134, v155
    v_fma_f32 v133, v154, v154, v133
    v_fma_f32 v135, v155, v155, v135
    s_waitcnt lgkmcnt(4)
    v_mfma_f32_32x32x16_bf16 v[52:67], v[108:111], v[100:103], v[52:67]
    ds_read_b128 v[104:107], v16 offset:32768
    ds_read_b64_tr_b16 v[120:121], v24
    ds_read_b64_tr_b16 v[122:123], v24 offset:1792
    s_mov_b32 s56, 0x200
    s_add_u32 m0, s58, 0x4000
    s_nop 0
    buffer_load_dwordx4 v5, s[20:23], s56 offen lds
    v_mfma_f32_16x16x32_bf16 v[136:139], v[108:111], v[148:151], v[136:139]
    v_lshlrev_b32 v152, 16, v102
    v_and_b32 v153, s60, v102
    v_add_f32 v132, v132, v152
    v_add_f32 v134, v134, v153
    s_waitcnt lgkmcnt(5)
    v_mfma_f32_32x32x16_bf16 v[68:83], v[112:115], v[100:103], v[68:83]
    ds_read_b64_tr_b16 v[124:125], v24 offset:128
    ds_read_b64_tr_b16 v[126:127], v24 offset:1920
    v_fma_f32 v133, v152, v152, v133
    v_fma_f32 v135, v153, v153, v135
    v_lshlrev_b32 v154, 16, v103
    v_and_b32 v155, s60, v103
    s_waitcnt lgkmcnt(5)
    v_mfma_f32_32x32x16_bf16 v[84:99], v[116:119], v[100:103], v[84:99]
    ds_read_b64_tr_b16 v[128:129], v24 offset:256
    ds_read_b64_tr_b16 v[130:131], v24 offset:2048
    s_mov_b32 s56, 0x200
    s_add_u32 m0, s58, 0x4400
    s_nop 0
    buffer_load_dwordx4 v6, s[20:23], s56 offen lds
    v_add_f32 v132, v132, v154
    v_add_f32 v134, v134, v155
    v_fma_f32 v133, v154, v154, v133
    v_fma_f32 v135, v155, v155, v135
    s_waitcnt lgkmcnt(4)
    v_mfma_f32_32x32x16_bf16 v[52:67], v[120:123], v[104:107], v[52:67]
    ds_read_b128 v[100:103], v17 offset:32768
    ds_read_b64_tr_b16 v[108:109], v25
    ds_read_b64_tr_b16 v[110:111], v25 offset:1792
    s_mov_b32 s57, 0xc0000
    s_add_u32 m0, s59, 0x7000
    s_nop 0
    buffer_load_dwordx4 v7, s[24:27], s57 offen lds
    v_lshlrev_b32 v152, 16, v106
    v_and_b32 v153, s60, v106
    v_add_f32 v132, v132, v152
    v_add_f32 v134, v134, v153
    s_waitcnt lgkmcnt(5)
    v_mfma_f32_32x32x16_bf16 v[68:83], v[124:127], v[104:107], v[68:83]
    ds_read_b64_tr_b16 v[112:113], v25 offset:128
    ds_read_b64_tr_b16 v[114:115], v25 offset:1920
    v_mfma_f32_16x16x32_bf16 v[140:143], v[124:127], v[148:151], v[140:143]
    v_fma_f32 v133, v152, v152, v133
    v_fma_f32 v135, v153, v153, v135
    v_lshlrev_b32 v154, 16, v107
    v_and_b32 v155, s60, v107
    s_waitcnt lgkmcnt(5)
    v_mfma_f32_32x32x16_bf16 v[84:99], v[128:131], v[104:107], v[84:99]
    ds_read_b64_tr_b16 v[116:117], v25 offset:256
    ds_read_b64_tr_b16 v[118:119], v25 offset:2048
    s_mov_b32 s57, 0xc0000
    s_add_u32 m0, s59, 0x9000
    s_nop 0
    buffer_load_dwordx4 v8, s[24:27], s57 offen lds
    v_add_f32 v132, v132, v154
    v_add_f32 v134, v134, v155
    v_fma_f32 v133, v154, v154, v133
    v_fma_f32 v135, v155, v155, v135
    s_waitcnt lgkmcnt(4)
    v_mfma_f32_32x32x16_bf16 v[52:67], v[108:111], v[100:103], v[52:67]
    ds_read_b128 v[104:107], v18 offset:32768
    ds_read_b64_tr_b16 v[120:121], v26
    ds_read_b64_tr_b16 v[122:123], v26 offset:1792
    v_lshlrev_b32 v152, 16, v102
    v_and_b32 v153, s60, v102
    v_add_f32 v132, v132, v152
    v_add_f32 v134, v134, v153
    s_waitcnt lgkmcnt(5)
    v_mfma_f32_32x32x16_bf16 v[68:83], v[112:115], v[100:103], v[68:83]
    ds_read_b64_tr_b16 v[124:125], v26 offset:128
    ds_read_b64_tr_b16 v[126:127], v26 offset:1920
    s_mov_b32 s57, 0xc0000
    s_add_u32 m0, s59, 0xb000
    s_nop 0
    buffer_load_dwordx4 v9, s[24:27], s57 offen lds
    v_fma_f32 v133, v152, v152, v133
    v_fma_f32 v135, v153, v153, v135
    v_lshlrev_b32 v154, 16, v103
    v_and_b32 v155, s60, v103
    s_waitcnt lgkmcnt(5)
    v_mfma_f32_32x32x16_bf16 v[84:99], v[116:119], v[100:103], v[84:99]
    ds_read_b64_tr_b16 v[128:129], v26 offset:256
    ds_read_b64_tr_b16 v[130:131], v26 offset:2048
    s_mov_b32 s57, 0xc0000
    s_add_u32 m0, s59, 0xd000
    s_nop 0
    buffer_load_dwordx4 v10, s[24:27], s57 offen lds
    v_mfma_f32_16x16x32_bf16 v[144:147], v[116:119], v[148:151], v[144:147]
    v_add_f32 v132, v132, v154
    v_add_f32 v134, v134, v155
    v_fma_f32 v133, v154, v154, v133
    v_fma_f32 v135, v155, v155, v135
    s_waitcnt lgkmcnt(4)
    v_mfma_f32_32x32x16_bf16 v[52:67], v[120:123], v[104:107], v[52:67]
    v_lshlrev_b32 v152, 16, v106
    v_and_b32 v153, s60, v106
    v_add_f32 v132, v132, v152
    v_add_f32 v134, v134, v153
    s_waitcnt lgkmcnt(2)
    v_mfma_f32_32x32x16_bf16 v[68:83], v[124:127], v[104:107], v[68:83]
    s_waitcnt lgkmcnt(0)
    s_waitcnt vmcnt(6)
    s_barrier
    ds_read_b128 v[100:103], v15
    ds_read_b64_tr_b16 v[108:109], v19
    ds_read_b64_tr_b16 v[110:111], v19 offset:1792
    ds_read_b64_tr_b16 v[112:113], v19 offset:128
    ds_read_b64_tr_b16 v[114:115], v19 offset:1920
    ds_read_b64_tr_b16 v[116:117], v19 offset:256
    ds_read_b64_tr_b16 v[118:119], v19 offset:2048
    v_fma_f32 v133, v152, v152, v133
    v_fma_f32 v135, v153, v153, v135
    v_lshlrev_b32 v154, 16, v107
    v_and_b32 v155, s60, v107
    v_mfma_f32_32x32x16_bf16 v[84:99], v[128:131], v[104:107], v[84:99]
    v_add_f32 v132, v132, v154
    v_add_f32 v134, v134, v155
    v_fma_f32 v133, v154, v154, v133
    v_fma_f32 v135, v155, v155, v135
    s_waitcnt lgkmcnt(4)
    v_mfma_f32_32x32x16_bf16 v[52:67], v[108:111], v[100:103], v[52:67]
    ds_read_b128 v[104:107], v16
    ds_read_b64_tr_b16 v[120:121], v20
    ds_read_b64_tr_b16 v[122:123], v20 offset:1792
    s_mov_b32 s56, 0x280
    s_add_u32 m0, s58, 0x8000
    s_nop 0
    buffer_load_dwordx4 v5, s[20:23], s56 offen lds
    v_mfma_f32_16x16x32_bf16 v[136:139], v[108:111], v[148:151], v[136:139]
    v_lshlrev_b32 v152, 16, v102
    v_and_b32 v153, s60, v102
    v_add_f32 v132, v132, v152
    v_add_f32 v134, v134, v153
    s_waitcnt lgkmcnt(5)
    v_mfma_f32_32x32x16_bf16 v[68:83], v[112:115], v[100:103], v[68:83]
    ds_read_b64_tr_b16 v[124:125], v20 offset:128
    ds_read_b64_tr_b16 v[126:127], v20 offset:1920
    v_fma_f32 v133, v152, v152, v133
    v_fma_f32 v135, v153, v153, v135
    v_lshlrev_b32 v154, 16, v103
    v_and_b32 v155, s60, v103
    s_waitcnt lgkmcnt(5)
    v_mfma_f32_32x32x16_bf16 v[84:99], v[116:119], v[100:103], v[84:99]
    ds_read_b64_tr_b16 v[128:129], v20 offset:256
    ds_read_b64_tr_b16 v[130:131], v20 offset:2048
    s_mov_b32 s56, 0x280
    s_add_u32 m0, s58, 0x8400
    s_nop 0
    buffer_load_dwordx4 v6, s[20:23], s56 offen lds
    v_add_f32 v132, v132, v154
    v_add_f32 v134, v134, v155
    v_fma_f32 v133, v154, v154, v133
    v_fma_f32 v135, v155, v155, v135
    s_waitcnt lgkmcnt(4)
    v_mfma_f32_32x32x16_bf16 v[52:67], v[120:123], v[104:107], v[52:67]
    ds_read_b128 v[100:103], v17
    ds_read_b64_tr_b16 v[108:109], v21
    ds_read_b64_tr_b16 v[110:111], v21 offset:1792
    s_mov_b32 s57, 0xf0000
    s_add_u32 m0, s59, 0xe000
    s_nop 0
    buffer_load_dwordx4 v7, s[24:27], s57 offen lds
    v_lshlrev_b32 v152, 16, v106
    v_and_b32 v153, s60, v106
    v_add_f32 v132, v132, v152
    v_add_f32 v134, v134, v153
    s_waitcnt lgkmcnt(5)
    v_mfma_f32_32x32x16_bf16 v[68:83], v[124:127], v[104:107], v[68:83]
    ds_read_b64_tr_b16 v[112:113], v21 offset:128
    ds_read_b64_tr_b16 v[114:115], v21 offset:1920
    v_mfma_f32_16x16x32_bf16 v[140:143], v[124:127], v[148:151], v[140:143]
    v_fma_f32 v133, v152, v152, v133
    v_fma_f32 v135, v153, v153, v135
    v_lshlrev_b32 v154, 16, v107
    v_and_b32 v155, s60, v107
    s_waitcnt lgkmcnt(5)
    v_mfma_f32_32x32x16_bf16 v[84:99], v[128:131], v[104:107], v[84:99]
    ds_read_b64_tr_b16 v[116:117], v21 offset:256
    ds_read_b64_tr_b16 v[118:119], v21 offset:2048
    s_mov_b32 s57, 0xf0000
    s_add_u32 m0, s59, 0x10000
    s_nop 0
    buffer_load_dwordx4 v8, s[24:27], s57 offen lds
    v_add_f32 v132, v132, v154
    v_add_f32 v134, v134, v155
    v_fma_f32 v133, v154, v154, v133
    v_fma_f32 v135, v155, v155, v135
    s_waitcnt lgkmcnt(4)
    v_mfma_f32_32x32x16_bf16 v[52:67], v[108:111], v[100:103], v[52:67]
    ds_read_b128 v[104:107], v18
    ds_read_b64_tr_b16 v[120:121], v22
    ds_read_b64_tr_b16 v[122:123], v22 offset:1792
    v_lshlrev_b32 v152, 16, v102
    v_and_b32 v153, s60, v102
    v_add_f32 v132, v132, v152
    v_add_f32 v134, v134, v153
    s_waitcnt lgkmcnt(5)
    v_mfma_f32_32x32x16_bf16 v[68:83], v[112:115], v[100:103], v[68:83]
    ds_read_b64_tr_b16 v[124:125], v22 offset:128
    ds_read_b64_tr_b16 v[126:127], v22 offset:1920
    s_mov_b32 s57, 0xf0000
    s_add_u32 m0, s59, 0x12000
    s_nop 0
    buffer_load_dwordx4 v9, s[24:27], s57 offen lds
    v_fma_f32 v133, v152, v152, v133
    v_fma_f32 v135, v153, v153, v135
    v_lshlrev_b32 v154, 16, v103
    v_and_b32 v155, s60, v103
    s_waitcnt lgkmcnt(5)
    v_mfma_f32_32x32x16_bf16 v[84:99], v[116:119], v[100:103], v[84:99]
    ds_read_b64_tr_b16 v[128:129], v22 offset:256
    ds_read_b64_tr_b16 v[130:131], v22 offset:2048
    s_mov_b32 s57, 0xf0000
    s_add_u32 m0, s59, 0x14000
    s_nop 0
    buffer_load_dwordx4 v10, s[24:27], s57 offen lds
    v_mfma_f32_16x16x32_bf16 v[144:147], v[116:119], v[148:151], v[144:147]
    v_add_f32 v132, v132, v154
    v_add_f32 v134, v134, v155
    v_fma_f32 v133, v154, v154, v133
    v_fma_f32 v135, v155, v155, v135
    s_waitcnt lgkmcnt(4)
    v_mfma_f32_32x32x16_bf16 v[52:67], v[120:123], v[104:107], v[52:67]
    v_lshlrev_b32 v152, 16, v106
    v_and_b32 v153, s60, v106
    v_add_f32 v132, v132, v152
    v_add_f32 v134, v134, v153
    s_waitcnt lgkmcnt(2)
    v_mfma_f32_32x32x16_bf16 v[68:83], v[124:127], v[104:107], v[68:83]
    s_waitcnt lgkmcnt(0)
    s_waitcnt vmcnt(6)
    s_barrier
    ds_read_b128 v[100:103], v15 offset:16384
    ds_read_b64_tr_b16 v[108:109], v19 offset:28672
    ds_read_b64_tr_b16 v[110:111], v19 offset:30464
    ds_read_b64_tr_b16 v[112:113], v19 offset:28800
    ds_read_b64_tr_b16 v[114:115], v19 offset:30592
    ds_read_b64_tr_b16 v[116:117], v19 offset:28928
    ds_read_b64_tr_b16 v[118:119], v19 offset:30720
    v_fma_f32 v133, v152, v152, v133
    v_fma_f32 v135, v153, v153, v135
    v_lshlrev_b32 v154, 16, v107
    v_and_b32 v155, s60, v107
    v_mfma_f32_32x32x16_bf16 v[84:99], v[128:131], v[104:107], v[84:99]
    v_add_f32 v132, v132, v154
    v_add_f32 v134, v134, v155
    v_fma_f32 v133, v154, v154, v133
    v_fma_f32 v135, v155, v155, v135
    s_waitcnt lgkmcnt(4)
    v_mfma_f32_32x32x16_bf16 v[52:67], v[108:111], v[100:103], v[52:67]
    ds_read_b128 v[104:107], v16 offset:16384
    ds_read_b64_tr_b16 v[120:121], v20 offset:28672
    ds_read_b64_tr_b16 v[122:123], v20 offset:30464
    s_mov_b32 s56, 0x300
    s_add_u32 m0, s58, 0
    s_nop 0
    buffer_load_dwordx4 v5, s[20:23], s56 offen lds
    s_add_u32 m0, s18, 0x3400
    s_nop 0
    buffer_load_dwordx4 v27, s[32:35], s64 offen lds
    v_mfma_f32_16x16x32_bf16 v[136:139], v[108:111], v[148:151], v[136:139]
    v_lshlrev_b32 v152, 16, v102
    v_and_b32 v153, s60, v102
    v_add_f32 v132, v132, v152
    v_add_f32 v134, v134, v153
    s_waitcnt lgkmcnt(5)
    v_mfma_f32_32x32x16_bf16 v[68:83], v[112:115], v[100:103], v[68:83]
    ds_read_b64_tr_b16 v[124:125], v20 offset:28800
    ds_read_b64_tr_b16 v[126:127], v20 offset:30592
    v_fma_f32 v133, v152, v152, v133
    v_fma_f32 v135, v153, v153, v135
    v_lshlrev_b32 v154, 16, v103
    v_and_b32 v155, s60, v103
    s_waitcnt lgkmcnt(5)
    v_mfma_f32_32x32x16_bf16 v[84:99], v[116:119], v[100:103], v[84:99]
    ds_read_b64_tr_b16 v[128:129], v20 offset:28928
    ds_read_b64_tr_b16 v[130:131], v20 offset:30720
    s_mov_b32 s56, 0x300
    s_add_u32 m0, s58, 0x400
    s_nop 0
    buffer_load_dwordx4 v6, s[20:23], s56 offen lds
    v_add_f32 v132, v132, v154
    v_add_f32 v134, v134, v155
    v_fma_f32 v133, v154, v154, v133
    v_fma_f32 v135, v155, v155, v135
    s_waitcnt lgkmcnt(4)
    v_mfma_f32_32x32x16_bf16 v[52:67], v[120:123], v[104:107], v[52:67]
    ds_read_b128 v[100:103], v17 offset:16384
    ds_read_b64_tr_b16 v[108:109], v21 offset:28672
    ds_read_b64_tr_b16 v[110:111], v21 offset:30464
    s_mov_b32 s57, 0x120000
    s_add_u32 m0, s59, 0
    s_nop 0
    buffer_load_dwordx4 v7, s[24:27], s57 offen lds
    s_add_u32 m0, s18, 0
    s_nop 0
    buffer_load_dwordx4 v27, s[36:39], s65 offen lds
    v_lshlrev_b32 v152, 16, v106
    v_and_b32 v153, s60, v106
    v_add_f32 v132, v132, v152
    v_add_f32 v134, v134, v153
    s_waitcnt lgkmcnt(5)
    v_mfma_f32_32x32x16_bf16 v[68:83], v[124:127], v[104:107], v[68:83]
    ds_read_b64_tr_b16 v[112:113], v21 offset:28800
    ds_read_b64_tr_b16 v[114:115], v21 offset:30592
    v_mfma_f32_16x16x32_bf16 v[140:143], v[124:127], v[148:151], v[140:143]
    v_fma_f32 v133, v152, v152, v133
    v_fma_f32 v135, v153, v153, v135
    v_lshlrev_b32 v154, 16, v107
    v_and_b32 v155, s60, v107
    s_waitcnt lgkmcnt(5)
    v_mfma_f32_32x32x16_bf16 v[84:99], v[128:131], v[104:107], v[84:99]
    ds_read_b64_tr_b16 v[116:117], v21 offset:28928
    ds_read_b64_tr_b16 v[118:119], v21 offset:30720
    s_mov_b32 s57, 0x120000
    s_add_u32 m0, s59, 0x2000
    s_nop 0
    buffer_load_dwordx4 v8, s[24:27], s57 offen lds
    v_add_f32 v132, v132, v154
    v_add_f32 v134, v134, v155
    v_fma_f32 v133, v154, v154, v133
    v_fma_f32 v135, v155, v155, v135
    s_waitcnt lgkmcnt(4)
    v_mfma_f32_32x32x16_bf16 v[52:67], v[108:111], v[100:103], v[52:67]
    ds_read_b128 v[104:107], v18 offset:16384
    ds_read_b64_tr_b16 v[120:121], v22 offset:28672
    ds_read_b64_tr_b16 v[122:123], v22 offset:30464
    s_mov_b32 m0, 0x24000
    s_nop 0
    buffer_load_dwordx4 v28, s[40:43], s69 offen lds
    v_lshlrev_b32 v152, 16, v102
    v_and_b32 v153, s60, v102
    v_add_f32 v132, v132, v152
    v_add_f32 v134, v134, v153
    s_waitcnt lgkmcnt(5)
    v_mfma_f32_32x32x16_bf16 v[68:83], v[112:115], v[100:103], v[68:83]
    ds_read_b64_tr_b16 v[124:125], v22 offset:28800
    ds_read_b64_tr_b16 v[126:127], v22 offset:30592
    s_mov_b32 s57, 0x120000
    s_add_u32 m0, s59, 0x4000
    s_nop 0
    buffer_load_dwordx4 v9, s[24:27], s57 offen lds
    v_fma_f32 v133, v152, v152, v133
    v_fma_f32 v135, v153, v153, v135
    v_lshlrev_b32 v154, 16, v103
    v_and_b32 v155, s60, v103
    s_waitcnt lgkmcnt(5)
    v_mfma_f32_32x32x16_bf16 v[84:99], v[116:119], v[100:103], v[84:99]
    ds_read_b64_tr_b16 v[128:129], v22 offset:28928
    ds_read_b64_tr_b16 v[130:131], v22 offset:30720
    s_mov_b32 s57, 0x120000
    s_add_u32 m0, s59, 0x6000
    s_nop 0
    buffer_load_dwordx4 v10, s[24:27], s57 offen lds
    v_mfma_f32_16x16x32_bf16 v[144:147], v[116:119], v[148:151], v[144:147]
    v_add_f32 v132, v132, v154
    v_add_f32 v134, v134, v155
    v_fma_f32 v133, v154, v154, v133
    v_fma_f32 v135, v155, v155, v135
    s_waitcnt lgkmcnt(4)
    v_mfma_f32_32x32x16_bf16 v[52:67], v[120:123], v[104:107], v[52:67]
    v_lshlrev_b32 v152, 16, v106
    v_and_b32 v153, s60, v106
    v_add_f32 v132, v132, v152
    v_add_f32 v134, v134, v153
    s_waitcnt lgkmcnt(2)
    v_mfma_f32_32x32x16_bf16 v[68:83], v[124:127], v[104:107], v[68:83]
    s_waitcnt lgkmcnt(0)
    s_waitcnt vmcnt(9)
    s_barrier
    ds_read_b128 v[100:103], v15 offset:32768
    ds_read_b64_tr_b16 v[108:109], v23
    ds_read_b64_tr_b16 v[110:111], v23 offset:1792
    ds_read_b64_tr_b16 v[112:113], v23 offset:128
    ds_read_b64_tr_b16 v[114:115], v23 offset:1920
    ds_read_b64_tr_b16 v[116:117], v23 offset:256
    ds_read_b64_tr_b16 v[118:119], v23 offset:2048
    v_fma_f32 v133, v152, v152, v133
    v_fma_f32 v135, v153, v153, v135
    v_lshlrev_b32 v154, 16, v107
    v_and_b32 v155, s60, v107
    v_mfma_f32_32x32x16_bf16 v[84:99], v[128:131], v[104:107], v[84:99]
    v_add_f32 v132, v132, v154
    v_add_f32 v134, v134, v155
    v_fma_f32 v133, v154, v154, v133
    v_fma_f32 v135, v155, v155, v135
    s_waitcnt lgkmcnt(4)
    v_mfma_f32_32x32x16_bf16 v[52:67], v[108:111], v[100:103], v[52:67]
    ds_read_b128 v[104:107], v16 offset:32768
    ds_read_b64_tr_b16 v[120:121], v24
    ds_read_b64_tr_b16 v[122:123], v24 offset:1792
    s_mov_b32 s56, 0x380
    s_add_u32 m0, s58, 0x4000
    s_nop 0
    buffer_load_dwordx4 v5, s[20:23], s56 offen lds
    v_mfma_f32_16x16x32_bf16 v[136:139], v[108:111], v[148:151], v[136:139]
    v_lshlrev_b32 v152, 16, v102
    v_and_b32 v153, s60, v102
    v_add_f32 v132, v132, v152
    v_add_f32 v134, v134, v153
    s_waitcnt lgkmcnt(5)
    v_mfma_f32_32x32x16_bf16 v[68:83], v[112:115], v[100:103], v[68:83]
    ds_read_b64_tr_b16 v[124:125], v24 offset:128
    ds_read_b64_tr_b16 v[126:127], v24 offset:1920
    v_fma_f32 v133, v152, v152, v133
    v_fma_f32 v135, v153, v153, v135
    v_lshlrev_b32 v154, 16, v103
    v_and_b32 v155, s60, v103
    s_waitcnt lgkmcnt(5)
    v_mfma_f32_32x32x16_bf16 v[84:99], v[116:119], v[100:103], v[84:99]
    ds_read_b64_tr_b16 v[128:129], v24 offset:256
    ds_read_b64_tr_b16 v[130:131], v24 offset:2048
    s_mov_b32 s56, 0x380
    s_add_u32 m0, s58, 0x4400
    s_nop 0
    buffer_load_dwordx4 v6, s[20:23], s56 offen lds
    v_add_f32 v132, v132, v154
    v_add_f32 v134, v134, v155
    v_fma_f32 v133, v154, v154, v133
    v_fma_f32 v135, v155, v155, v135
    s_waitcnt lgkmcnt(4)
    v_mfma_f32_32x32x16_bf16 v[52:67], v[120:123], v[104:107], v[52:67]
    ds_read_b128 v[100:103], v17 offset:32768
    ds_read_b64_tr_b16 v[108:109], v25
    ds_read_b64_tr_b16 v[110:111], v25 offset:1792
    s_mov_b32 s57, 0x150000
    s_add_u32 m0, s59, 0x7000
    s_nop 0
    buffer_load_dwordx4 v7, s[24:27], s57 offen lds
    v_lshlrev_b32 v152, 16, v106
    v_and_b32 v153, s60, v106
    v_add_f32 v132, v132, v152
    v_add_f32 v134, v134, v153
    s_waitcnt lgkmcnt(5)
    v_mfma_f32_32x32x16_bf16 v[68:83], v[124:127], v[104:107], v[68:83]
    ds_read_b64_tr_b16 v[112:113], v25 offset:128
    ds_read_b64_tr_b16 v[114:115], v25 offset:1920
    v_mfma_f32_16x16x32_bf16 v[140:143], v[124:127], v[148:151], v[140:143]
    v_fma_f32 v133, v152, v152, v133
    v_fma_f32 v135, v153, v153, v135
    v_lshlrev_b32 v154, 16, v107
    v_and_b32 v155, s60, v107
    s_waitcnt lgkmcnt(5)
    v_mfma_f32_32x32x16_bf16 v[84:99], v[128:131], v[104:107], v[84:99]
    ds_read_b64_tr_b16 v[116:117], v25 offset:256
    ds_read_b64_tr_b16 v[118:119], v25 offset:2048
    s_mov_b32 s57, 0x150000
    s_add_u32 m0, s59, 0x9000
    s_nop 0
    buffer_load_dwordx4 v8, s[24:27], s57 offen lds
    v_add_f32 v132, v132, v154
    v_add_f32 v134, v134, v155
    v_fma_f32 v133, v154, v154, v133
    v_fma_f32 v135, v155, v155, v135
    s_waitcnt lgkmcnt(4)
    v_mfma_f32_32x32x16_bf16 v[52:67], v[108:111], v[100:103], v[52:67]
    ds_read_b128 v[104:107], v18 offset:32768
    ds_read_b64_tr_b16 v[120:121], v26
    ds_read_b64_tr_b16 v[122:123], v26 offset:1792
    v_lshlrev_b32 v152, 16, v102
    v_and_b32 v153, s60, v102
    v_add_f32 v132, v132, v152
    v_add_f32 v134, v134, v153
    s_waitcnt lgkmcnt(5)
    v_mfma_f32_32x32x16_bf16 v[68:83], v[112:115], v[100:103], v[68:83]
    ds_read_b64_tr_b16 v[124:125], v26 offset:128
    ds_read_b64_tr_b16 v[126:127], v26 offset:1920
    s_mov_b32 s57, 0x150000
    s_add_u32 m0, s59, 0xb000
    s_nop 0
    buffer_load_dwordx4 v9, s[24:27], s57 offen lds
    v_fma_f32 v133, v152, v152, v133
    v_fma_f32 v135, v153, v153, v135
    v_lshlrev_b32 v154, 16, v103
    v_and_b32 v155, s60, v103
    s_waitcnt lgkmcnt(5)
    v_mfma_f32_32x32x16_bf16 v[84:99], v[116:119], v[100:103], v[84:99]
    ds_read_b64_tr_b16 v[128:129], v26 offset:256
    ds_read_b64_tr_b16 v[130:131], v26 offset:2048
    s_mov_b32 s57, 0x150000
    s_add_u32 m0, s59, 0xd000
    s_nop 0
    buffer_load_dwordx4 v10, s[24:27], s57 offen lds
    v_mfma_f32_16x16x32_bf16 v[144:147], v[116:119], v[148:151], v[144:147]
    v_add_f32 v132, v132, v154
    v_add_f32 v134, v134, v155
    v_fma_f32 v133, v154, v154, v133
    v_fma_f32 v135, v155, v155, v135
    s_waitcnt lgkmcnt(4)
    v_mfma_f32_32x32x16_bf16 v[52:67], v[120:123], v[104:107], v[52:67]
    v_lshlrev_b32 v152, 16, v106
    v_and_b32 v153, s60, v106
    v_add_f32 v132, v132, v152
    v_add_f32 v134, v134, v153
    s_waitcnt lgkmcnt(2)
    v_mfma_f32_32x32x16_bf16 v[68:83], v[124:127], v[104:107], v[68:83]
    s_waitcnt lgkmcnt(0)
    s_waitcnt vmcnt(6)
    s_barrier
    ds_read_b128 v[100:103], v15
    ds_read_b64_tr_b16 v[108:109], v19
    ds_read_b64_tr_b16 v[110:111], v19 offset:1792
    ds_read_b64_tr_b16 v[112:113], v19 offset:128
    ds_read_b64_tr_b16 v[114:115], v19 offset:1920
    ds_read_b64_tr_b16 v[116:117], v19 offset:256
    ds_read_b64_tr_b16 v[118:119], v19 offset:2048
    v_fma_f32 v133, v152, v152, v133
    v_fma_f32 v135, v153, v153, v135
    v_lshlrev_b32 v154, 16, v107
    v_and_b32 v155, s60, v107
    v_mfma_f32_32x32x16_bf16 v[84:99], v[128:131], v[104:107], v[84:99]
    v_add_f32 v132, v132, v154
    v_add_f32 v134, v134, v155
    v_fma_f32 v133, v154, v154, v133
    v_fma_f32 v135, v155, v155, v135
    s_waitcnt lgkmcnt(4)
    v_mfma_f32_32x32x16_bf16 v[52:67], v[108:111], v[100:103], v[52:67]
    ds_read_b128 v[104:107], v16
    ds_read_b64_tr_b16 v[120:121], v20
    ds_read_b64_tr_b16 v[122:123], v20 offset:1792
    ds_read_b64_tr_b16 v[32:33], v40 offset:13312
    ds_read_b64_tr_b16 v[34:35], v40 offset:13824
    v_mfma_f32_16x16x32_bf16 v[136:139], v[108:111], v[148:151], v[136:139]
    v_lshlrev_b32 v152, 16, v102
    v_and_b32 v153, s60, v102
    v_add_f32 v132, v132, v152
    v_add_f32 v134, v134, v153
    s_waitcnt lgkmcnt(7)
    v_mfma_f32_32x32x16_bf16 v[68:83], v[112:115], v[100:103], v[68:83]
    ds_read_b64_tr_b16 v[124:125], v20 offset:128
    ds_read_b64_tr_b16 v[126:127], v20 offset:1920
    v_fma_f32 v133, v152, v152, v133
    v_fma_f32 v135, v153, v153, v135
    v_lshlrev_b32 v154, 16, v103
    v_and_b32 v155, s60, v103
    s_waitcnt lgkmcnt(7)
    v_mfma_f32_32x32x16_bf16 v[84:99], v[116:119], v[100:103], v[84:99]
    ds_read_b64_tr_b16 v[128:129], v20 offset:256
    ds_read_b64_tr_b16 v[130:131], v20 offset:2048
    v_add_f32 v132, v132, v154
    v_add_f32 v134, v134, v155
    v_fma_f32 v133, v154, v154, v133
    v_fma_f32 v135, v155, v155, v135
    s_waitcnt lgkmcnt(6)
    v_mfma_f32_32x32x16_bf16 v[52:67], v[120:123], v[104:107], v[52:67]
    ds_read_b128 v[100:103], v17
    ds_read_b64_tr_b16 v[108:109], v21
    ds_read_b64_tr_b16 v[110:111], v21 offset:1792
    ds_read_b64_tr_b16 v[36:37], v40
    ds_read_b64_tr_b16 v[38:39], v40 offset:512
    v_lshlrev_b32 v152, 16, v106
    v_and_b32 v153, s60, v106
    v_add_f32 v132, v132, v152
    v_add_f32 v134, v134, v153
    s_waitcnt lgkmcnt(7)
    v_mfma_f32_32x32x16_bf16 v[68:83], v[124:127], v[104:107], v[68:83]
    ds_read_b64_tr_b16 v[112:113], v21 offset:128
    ds_read_b64_tr_b16 v[114:115], v21 offset:1920
    v_mfma_f32_16x16x32_bf16 v[140:143], v[124:127], v[148:151], v[140:143]
    v_fma_f32 v133, v152, v152, v133
    v_fma_f32 v135, v153, v153, v135
    v_lshlrev_b32 v154, 16, v107
    v_and_b32 v155, s60, v107
    s_waitcnt lgkmcnt(7)
    v_mfma_f32_32x32x16_bf16 v[84:99], v[128:131], v[104:107], v[84:99]
    ds_read_b64_tr_b16 v[116:117], v21 offset:256
    ds_read_b64_tr_b16 v[118:119], v21 offset:2048
    v_add_f32 v132, v132, v154
    v_add_f32 v134, v134, v155
    v_fma_f32 v133, v154, v154, v133
    v_fma_f32 v135, v155, v155, v135
    s_waitcnt lgkmcnt(6)
    v_mfma_f32_32x32x16_bf16 v[52:67], v[108:111], v[100:103], v[52:67]
    ds_read_b128 v[104:107], v18
    ds_read_b64_tr_b16 v[120:121], v22
    ds_read_b64_tr_b16 v[122:123], v22 offset:1792
    ds_read_b64_tr_b16 v[44:45], v41 offset:16384
    ds_read_b64_tr_b16 v[46:47], v41 offset:16640
    ds_read_b64_tr_b16 v[48:49], v41 offset:16896
    ds_read_b64_tr_b16 v[50:51], v41 offset:17152
    v_lshlrev_b32 v152, 16, v102
    v_and_b32 v153, s60, v102
    v_add_f32 v132, v132, v152
    v_add_f32 v134, v134, v153
    s_waitcnt lgkmcnt(9)
    v_mfma_f32_32x32x16_bf16 v[68:83], v[112:115], v[100:103], v[68:83]
    ds_read_b64_tr_b16 v[124:125], v22 offset:128
    ds_read_b64_tr_b16 v[126:127], v22 offset:1920
    v_fma_f32 v133, v152, v152, v133
    v_fma_f32 v135, v153, v153, v135
    v_lshlrev_b32 v154, 16, v103
    v_and_b32 v155, s60, v103
    s_waitcnt lgkmcnt(9)
    v_mfma_f32_32x32x16_bf16 v[84:99], v[116:119], v[100:103], v[84:99]
    ds_read_b64_tr_b16 v[128:129], v22 offset:256
    ds_read_b64_tr_b16 v[130:131], v22 offset:2048
    v_mfma_f32_16x16x32_bf16 v[144:147], v[116:119], v[148:151], v[144:147]
    v_add_f32 v132, v132, v154
    v_add_f32 v134, v134, v155
    v_fma_f32 v133, v154, v154, v133
    v_fma_f32 v135, v155, v155, v135
    s_waitcnt lgkmcnt(8)
    v_mfma_f32_32x32x16_bf16 v[52:67], v[120:123], v[104:107], v[52:67]
    v_lshlrev_b32 v152, 16, v106
    v_and_b32 v153, s60, v106
    v_add_f32 v132, v132, v152
    v_add_f32 v134, v134, v153
    s_waitcnt lgkmcnt(2)
    v_mfma_f32_32x32x16_bf16 v[68:83], v[124:127], v[104:107], v[68:83]
    s_waitcnt lgkmcnt(0)
    s_waitcnt vmcnt(0)
    s_barrier
    ds_read_b128 v[100:103], v15 offset:16384
    ds_read_b64_tr_b16 v[108:109], v19 offset:28672
    ds_read_b64_tr_b16 v[110:111], v19 offset:30464
    ds_read_b64_tr_b16 v[112:113], v19 offset:28800
    ds_read_b64_tr_b16 v[114:115], v19 offset:30592
    ds_read_b64_tr_b16 v[116:117], v19 offset:28928
    ds_read_b64_tr_b16 v[118:119], v19 offset:30720
    v_fma_f32 v133, v152, v152, v133
    v_fma_f32 v135, v153, v153, v135
    v_lshlrev_b32 v154, 16, v107
    v_and_b32 v155, s60, v107
    v_mfma_f32_32x32x16_bf16 v[84:99], v[128:131], v[104:107], v[84:99]
    v_add_f32 v132, v132, v154
    v_add_f32 v134, v134, v155
    v_fma_f32 v133, v154, v154, v133
    v_fma_f32 v135, v155, v155, v135
    s_waitcnt lgkmcnt(4)
    v_mfma_f32_32x32x16_bf16 v[52:67], v[108:111], v[100:103], v[52:67]
    ds_read_b128 v[104:107], v16 offset:16384
    ds_read_b64_tr_b16 v[120:121], v20 offset:28672
    ds_read_b64_tr_b16 v[122:123], v20 offset:30464
    v_mov_b32 v156, -1
    v_mov_b32 v157, -1
    v_mov_b32 v158, -1
    v_mov_b32 v159, -1
    s_lshl_b32 s52, s61, 10
    s_add_u32 s52, s52, 0x1000000
    s_cmp_lt_u32 s61, 0x48
    s_cselect_b32 s52, s52, 0x7fff0000
    buffer_store_dwordx4 v[156:159], v28, s[28:31], s52 offen sc0 sc1
    v_mfma_f32_16x16x32_bf16 v[136:139], v[108:111], v[148:151], v[136:139]
    v_lshlrev_b32 v152, 16, v102
    v_and_b32 v153, s60, v102
    v_add_f32 v132, v132, v152
    v_add_f32 v134, v134, v153
    s_waitcnt lgkmcnt(5)
    v_mfma_f32_32x32x16_bf16 v[68:83], v[112:115], v[100:103], v[68:83]
    ds_read_b64_tr_b16 v[124:125], v20 offset:28800
    ds_read_b64_tr_b16 v[126:127], v20 offset:30592
    buffer_store_dwordx4 v[32:35], v28, s[28:31], s66 offen sc0 sc1
    v_fma_f32 v133, v152, v152, v133
    v_fma_f32 v135, v153, v153, v135
    v_lshlrev_b32 v154, 16, v103
    v_and_b32 v155, s60, v103
    s_waitcnt lgkmcnt(5)
    v_mfma_f32_32x32x16_bf16 v[84:99], v[116:119], v[100:103], v[84:99]
    ds_read_b64_tr_b16 v[128:129], v20 offset:28928
    ds_read_b64_tr_b16 v[130:131], v20 offset:30720
    buffer_store_dwordx4 v[36:39], v28, s[28:31], s67 offen sc0 sc1
    v_add_f32 v132, v132, v154
    v_add_f32 v134, v134, v155
    v_fma_f32 v133, v154, v154, v133
    v_fma_f32 v135, v155, v155, v135
    s_waitcnt lgkmcnt(4)
    v_mfma_f32_32x32x16_bf16 v[52:67], v[120:123], v[104:107], v[52:67]
    ds_read_b128 v[100:103], v17 offset:16384
    ds_read_b64_tr_b16 v[108:109], v21 offset:28672
    ds_read_b64_tr_b16 v[110:111], v21 offset:30464
    v_lshlrev_b32 v152, 16, v106
    v_and_b32 v153, s60, v106
    v_add_f32 v132, v132, v152
    v_add_f32 v134, v134, v153
    s_waitcnt lgkmcnt(5)
    v_mfma_f32_32x32x16_bf16 v[68:83], v[124:127], v[104:107], v[68:83]
    ds_read_b64_tr_b16 v[112:113], v21 offset:28800
    ds_read_b64_tr_b16 v[114:115], v21 offset:30592
    v_mfma_f32_16x16x32_bf16 v[140:143], v[124:127], v[148:151], v[140:143]
    v_fma_f32 v133, v152, v152, v133
    v_fma_f32 v135, v153, v153, v135
    v_lshlrev_b32 v154, 16, v107
    v_and_b32 v155, s60, v107
    s_waitcnt lgkmcnt(5)
    v_mfma_f32_32x32x16_bf16 v[84:99], v[128:131], v[104:107], v[84:99]
    ds_read_b64_tr_b16 v[116:117], v21 offset:28928
    ds_read_b64_tr_b16 v[118:119], v21 offset:30720
    v_add_f32 v132, v132, v154
    v_add_f32 v134, v134, v155
    v_fma_f32 v133, v154, v154, v133
    v_fma_f32 v135, v155, v155, v135
    s_waitcnt lgkmcnt(4)
    v_mfma_f32_32x32x16_bf16 v[52:67], v[108:111], v[100:103], v[52:67]
    ds_read_b128 v[104:107], v18 offset:16384
    ds_read_b64_tr_b16 v[120:121], v22 offset:28672
    ds_read_b64_tr_b16 v[122:123], v22 offset:30464
    v_lshlrev_b32 v152, 16, v102
    v_and_b32 v153, s60, v102
    v_add_f32 v132, v132, v152
    v_add_f32 v134, v134, v153
    s_waitcnt lgkmcnt(5)
    v_mfma_f32_32x32x16_bf16 v[68:83], v[112:115], v[100:103], v[68:83]
    ds_read_b64_tr_b16 v[124:125], v22 offset:28800
    ds_read_b64_tr_b16 v[126:127], v22 offset:30592
    v_fma_f32 v133, v152, v152, v133
    v_fma_f32 v135, v153, v153, v135
    v_lshlrev_b32 v154, 16, v103
    v_and_b32 v155, s60, v103
    s_waitcnt lgkmcnt(5)
    v_mfma_f32_32x32x16_bf16 v[84:99], v[116:119], v[100:103], v[84:99]
    ds_read_b64_tr_b16 v[128:129], v22 offset:28928
    ds_read_b64_tr_b16 v[130:131], v22 offset:30720
    v_mfma_f32_16x16x32_bf16 v[144:147], v[116:119], v[148:151], v[144:147]
    v_add_f32 v132, v132, v154
    v_add_f32 v134, v134, v155
    v_fma_f32 v133, v154, v154, v133
    v_fma_f32 v135, v155, v155, v135
    s_waitcnt lgkmcnt(4)
    v_mfma_f32_32x32x16_bf16 v[52:67], v[120:123], v[104:107], v[52:67]
    v_lshlrev_b32 v152, 16, v106
    v_and_b32 v153, s60, v106
    v_add_f32 v132, v132, v152
    v_add_f32 v134, v134, v153
    s_waitcnt lgkmcnt(2)
    v_mfma_f32_32x32x16_bf16 v[68:83], v[124:127], v[104:107], v[68:83]
    v_fma_f32 v133, v152, v152, v133
    v_fma_f32 v135, v153, v153, v135
    v_lshlrev_b32 v154, 16, v107
    v_and_b32 v155, s60, v107
    s_waitcnt lgkmcnt(0)
    v_mfma_f32_32x32x16_bf16 v[84:99], v[128:131], v[104:107], v[84:99]
    v_add_f32 v132, v132, v154
    v_add_f32 v134, v134, v155
    v_fma_f32 v133, v154, v154, v133
    v_fma_f32 v135, v155, v155, v135
    v_and_b32 v11, 31, v1
    v_lshrrev_b32 v13, 5, v1
    s_lshl_b32 s52, s45, 5
    v_add_u32 v12, s52, v11
    v_lshlrev_b32 v162, 5, v12
    v_add_u32 v162, 0x21000, v162
    v_lshl_add_u32 v160, v13, 3, v162
    v_lshlrev_b32 v163, 2, v11
    v_add_u32 v163, 0x22200, v163
    v_and_b32 v12, 1, v1
    v_lshlrev_b32 v12, 6, v12
    v_lshrrev_b32 v13, 4, v1
    v_lshl_add_u32 v161, v13, 4, v12
    s_lshl_b32 s52, s45, 7
    s_add_u32 s52, s52, 0x22200
    v_add_u32 v161, s52, v161
    v_add_f32 v132, v132, v134
    v_add_f32 v133, v133, v135
    ds_write_b64 v160, v[132:133] offset:16
    s_mov_b32 exec_lo, 0x30003
    s_mov_b32 exec_hi, 0x30003
    ds_write_b128 v161, v[136:139]
    ds_write_b128 v161, v[140:143] offset:1024
    ds_write_b128 v161, v[144:147] offset:2048
    s_mov_b64 exec, -1
    s_waitcnt lgkmcnt(0)
    s_barrier
    ds_read_b128 v[164:167], v162
    ds_read_b128 v[168:171], v162 offset:16
    ds_read_b32 v180, v163
    ds_read_b32 v181, v163 offset:128
    ds_read_b32 v182, v163 offset:256
    ds_read_b32 v183, v163 offset:384
    ds_read_b32 v184, v163 offset:1024
    ds_read_b32 v185, v163 offset:1152
    ds_read_b32 v186, v163 offset:1280
    ds_read_b32 v187, v163 offset:1408
    ds_read_b32 v188, v163 offset:2048
    ds_read_b32 v189, v163 offset:2176
    ds_read_b32 v190, v163 offset:2304
    ds_read_b32 v191, v163 offset:2432
    s_waitcnt lgkmcnt(13)
    v_add_f32 v164, v164, v166
    v_add_f32 v165, v165, v167
    s_waitcnt lgkmcnt(12)
    v_add_f32 v168, v168, v170
    v_add_f32 v169, v169, v171
    v_add_f32 v164, v164, v168
    v_add_f32 v165, v165, v169
    v_mul_f32 v199, 0x3b000000, v164
    v_mul_f32 v197, 0x3b000000, v165
    v_fma_f32 v197, -v199, v199, v197
    v_cvt_pk_bf16_f32 v100, -v199, -v199
    v_cmp_gt_u32 vcc, 32, v1
    v_mov_b32 v102, 0
    v_mov_b32 v103, 0
    v_cndmask_b32 v100, v102, v100, vcc
    v_and_b32 v101, 0xffff, v100
    v_cvt_pk_bf16_f32 v197, v197, v197
    v_lshlrev_b32 v197, 16, v197
    v_add_f32 v197, 0x3727c5ac, v197
    v_cvt_pk_bf16_f32 v197, v197, v197
    v_lshlrev_b32 v197, 16, v197
    v_sqrt_f32 v197, v197
    s_nop 0
    v_cvt_pk_bf16_f32 v197, v197, v197
    v_lshlrev_b32 v197, 16, v197
    v_rcp_f32 v198, v197
    s_mov_b32 s55, 0x7060302
    s_waitcnt lgkmcnt(10)
    v_add_f32 v180, v180, v181
    s_waitcnt lgkmcnt(8)
    v_add_f32 v182, v182, v183
    v_add_f32 v180, v180, v182
    v_and_b32 v181, s60, v180
    v_sub_f32 v181, v180, v181
    v_and_b32 v182, s60, v181
    v_sub_f32 v182, v181, v182
    v_perm_b32 v108, v181, v180, s55
    v_lshrrev_b32 v109, 16, v182
    v_mov_b32 v110, 0
    v_mov_b32 v111, 0
    s_nop 1
    v_mfma_f32_32x32x16_bf16 v[52:67], v[108:111], v[100:103], v[52:67]
    s_waitcnt lgkmcnt(6)
    v_add_f32 v184, v184, v185
    s_waitcnt lgkmcnt(4)
    v_add_f32 v186, v186, v187
    v_add_f32 v184, v184, v186
    v_and_b32 v185, s60, v184
    v_sub_f32 v185, v184, v185
    v_and_b32 v186, s60, v185
    v_sub_f32 v186, v185, v186
    v_perm_b32 v112, v185, v184, s55
    v_lshrrev_b32 v113, 16, v186
    v_mov_b32 v114, 0
    v_mov_b32 v115, 0
    s_nop 1
    v_mfma_f32_32x32x16_bf16 v[68:83], v[112:115], v[100:103], v[68:83]
    s_waitcnt lgkmcnt(2)
    v_add_f32 v188, v188, v189
    s_waitcnt lgkmcnt(0)
    v_add_f32 v190, v190, v191
    v_add_f32 v188, v188, v190
    v_and_b32 v189, s60, v188
    v_sub_f32 v189, v188, v189
    v_and_b32 v190, s60, v189
    v_sub_f32 v190, v189, v190
    v_perm_b32 v116, v189, v188, s55
    v_lshrrev_b32 v117, 16, v190
    v_mov_b32 v118, 0
    v_mov_b32 v119, 0
    s_nop 1
    v_mfma_f32_32x32x16_bf16 v[84:99], v[116:119], v[100:103], v[84:99]
    v_mul_f32 v196, 0xbfb8aa3b, v198
    v_xor_b32 v44, v42, v44
    v_xor_b32 v45, v42, v45
    v_xor_b32 v46, v42, v46
    v_xor_b32 v47, v42, v47
    v_xor_b32 v48, v42, v48
    v_xor_b32 v49, v42, v49
    v_xor_b32 v50, v42, v50
    v_xor_b32 v51, v42, v51
    v_pk_mul_f32 v[52:53], v[198:199], v[52:53] op_sel_hi:[0,1]
    v_pk_mul_f32 v[54:55], v[198:199], v[54:55] op_sel_hi:[0,1]
    v_pk_mul_f32 v[56:57], v[198:199], v[56:57] op_sel_hi:[0,1]
    v_pk_mul_f32 v[58:59], v[198:199], v[58:59] op_sel_hi:[0,1]
    v_pk_mul_f32 v[60:61], v[198:199], v[60:61] op_sel_hi:[0,1]
    v_pk_mul_f32 v[62:63], v[198:199], v[62:63] op_sel_hi:[0,1]
    v_pk_mul_f32 v[64:65], v[198:199], v[64:65] op_sel_hi:[0,1]
    v_pk_mul_f32 v[66:67], v[198:199], v[66:67] op_sel_hi:[0,1]
    s_lshl_b32 s52, s47, 2
    s_add_u32 s52, s52, s45
    s_lshl_b32 s54, s52, 5
    s_lshl_b32 s53, s48, 2
    s_add_u32 s53, s53, 2
    s_add_u32 s54, s54, s53
    s_lshl_b32 s68, s54, 10
    s_add_u32 s68, s68, 0x700000
    s_lshl_b32 s53, s53, 10
    s_add_u32 s53, s53, 0x900000
    v_cvt_pk_bf16_f32 v200, v52, v53
    v_cvt_pk_bf16_f32 v201, v54, v55
    v_cvt_pk_bf16_f32 v202, v56, v57
    v_cvt_pk_bf16_f32 v203, v58, v59
    v_cvt_pk_bf16_f32 v204, v60, v61
    v_cvt_pk_bf16_f32 v205, v62, v63
    v_cvt_pk_bf16_f32 v206, v64, v65
    v_cvt_pk_bf16_f32 v207, v66, v67
    buffer_store_dwordx4 v[200:203], v28, s[28:31], s68 offen sc0 sc1
    buffer_store_dwordx4 v[204:207], v28, s[28:31], s68 offen offset:1024 sc0 sc1
    s_cmp_lg_u32 s52, 0
    s_cbranch_scc1 hh_k1_noph1
    buffer_store_dwordx4 v[44:47], v28, s[28:31], s53 offen sc0 sc1
    buffer_store_dwordx4 v[48:51], v28, s[28:31], s53 offen offset:1024 sc0 sc1
hh_k1_noph1:
    v_pk_mul_f32 v[84:85], v[198:199], v[84:85] op_sel_hi:[0,1]
    v_pk_mul_f32 v[86:87], v[198:199], v[86:87] op_sel_hi:[0,1]
    v_pk_mul_f32 v[88:89], v[198:199], v[88:89] op_sel_hi:[0,1]
    v_pk_mul_f32 v[90:91], v[198:199], v[90:91] op_sel_hi:[0,1]
    v_pk_mul_f32 v[92:93], v[198:199], v[92:93] op_sel_hi:[0,1]
    v_pk_mul_f32 v[94:95], v[198:199], v[94:95] op_sel_hi:[0,1]
    v_pk_mul_f32 v[96:97], v[198:199], v[96:97] op_sel_hi:[0,1]
    v_pk_mul_f32 v[98:99], v[198:199], v[98:99] op_sel_hi:[0,1]
    v_pk_mul_f32 v[68:69], v[198:199], v[68:69] op_sel_hi:[0,1]
    v_pk_mul_f32 v[70:71], v[198:199], v[70:71] op_sel_hi:[0,1]
    v_pk_mul_f32 v[72:73], v[198:199], v[72:73] op_sel_hi:[0,1]
    v_pk_mul_f32 v[74:75], v[198:199], v[74:75] op_sel_hi:[0,1]
    v_pk_mul_f32 v[76:77], v[198:199], v[76:77] op_sel_hi:[0,1]
    v_pk_mul_f32 v[78:79], v[198:199], v[78:79] op_sel_hi:[0,1]
    v_pk_mul_f32 v[80:81], v[198:199], v[80:81] op_sel_hi:[0,1]
    v_pk_mul_f32 v[82:83], v[198:199], v[82:83] op_sel_hi:[0,1]
    v_and_b32 v11, 31, v1
    s_lshl_b32 s52, s45, 5
    v_add_u32 v11, s52, v11
    v_lshlrev_b32 v11, 6, v11
    v_lshrrev_b32 v12, 5, v1
    v_bfe_u32 v13, v1, 2, 3
    v_xor_b32 v12, v12, v13
    v_lshl_add_u32 v212, v12, 3, v11
    v_xor_b32 v213, 16, v212
    v_xor_b32 v214, 32, v212
    v_xor_b32 v215, 48, v212
    v_mov_b32 v220, 0x3fb8aa3b
    v_cvt_pk_bf16_f32 v124, v84, v85
    v_cvt_pk_bf16_f32 v125, v86, v87
    v_cvt_pk_bf16_f32 v126, v88, v89
    v_cvt_pk_bf16_f32 v127, v90, v91
    v_cvt_pk_bf16_f32 v128, v92, v93
    v_cvt_pk_bf16_f32 v129, v94, v95
    v_cvt_pk_bf16_f32 v130, v96, v97
    v_cvt_pk_bf16_f32 v131, v98, v99
    ds_write_b64 v212, v[124:125] offset:40960
    ds_write_b64 v213, v[126:127] offset:40960
    ds_write_b64 v214, v[128:129] offset:40960
    ds_write_b64 v215, v[130:131] offset:40960
    s_mov_b32 s55, 0x3fb8aa3b
    v_cvt_pk_bf16_f32 v100, v68, v69
    v_cvt_pk_bf16_f32 v101, v70, v71
    v_cvt_pk_bf16_f32 v102, v72, v73
    v_cvt_pk_bf16_f32 v103, v74, v75
    v_cvt_pk_bf16_f32 v104, v76, v77
    v_cvt_pk_bf16_f32 v105, v78, v79
    v_cvt_pk_bf16_f32 v106, v80, v81
    v_cvt_pk_bf16_f32 v107, v82, v83
    v_mfma_f32_32x32x16_bf16 v[164:179], v[44:47], v[100:103], 0
    s_nop 0
    v_mfma_f32_32x32x16_bf16 v[180:195], v[48:51], v[104:107], 0
    s_nop 9
    v_max3_f32 v216, v164, v165, v166
    v_max3_f32 v216, v216, v167, v168
    v_max3_f32 v216, v216, v169, v170
    v_max3_f32 v216, v216, v171, v172
    v_max3_f32 v216, v216, v173, v174
    v_max3_f32 v216, v216, v175, v176
    v_max3_f32 v216, v216, v177, v178
    v_max_f32 v216, v216, v179
    v_mul_f32 v216, 0xbfb8aa3b, v216
    v_pk_fma_f32 v[164:165], v[164:165], v[220:221], v[216:217] op_sel_hi:[1,0,0]
    v_pk_fma_f32 v[166:167], v[166:167], v[220:221], v[216:217] op_sel_hi:[1,0,0]
    v_pk_fma_f32 v[168:169], v[168:169], v[220:221], v[216:217] op_sel_hi:[1,0,0]
    v_pk_fma_f32 v[170:171], v[170:171], v[220:221], v[216:217] op_sel_hi:[1,0,0]
    v_pk_fma_f32 v[172:173], v[172:173], v[220:221], v[216:217] op_sel_hi:[1,0,0]
    v_pk_fma_f32 v[174:175], v[174:175], v[220:221], v[216:217] op_sel_hi:[1,0,0]
    v_pk_fma_f32 v[176:177], v[176:177], v[220:221], v[216:217] op_sel_hi:[1,0,0]
    v_pk_fma_f32 v[178:179], v[178:179], v[220:221], v[216:217] op_sel_hi:[1,0,0]
    v_exp_f32 v164, v164
    v_exp_f32 v165, v165
    v_exp_f32 v166, v166
    v_exp_f32 v167, v167
    v_exp_f32 v168, v168
    v_exp_f32 v169, v169
    v_exp_f32 v170, v170
    v_exp_f32 v171, v171
    v_exp_f32 v172, v172
    v_pk_add_f32 v[218:219], v[164:165], v[166:167]
    v_exp_f32 v173, v173
    v_pk_add_f32 v[218:219], v[218:219], v[168:169]
    v_exp_f32 v174, v174
    v_pk_add_f32 v[218:219], v[218:219], v[170:171]
    v_exp_f32 v175, v175
    v_exp_f32 v176, v176
    v_exp_f32 v177, v177
    v_exp_f32 v178, v178
    v_exp_f32 v179, v179
    v_pk_add_f32 v[218:219], v[218:219], v[172:173]
    v_pk_add_f32 v[218:219], v[218:219], v[174:175]
    v_pk_add_f32 v[218:219], v[218:219], v[176:177]
    v_pk_add_f32 v[218:219], v[218:219], v[178:179]
    v_add_f32 v218, v218, v219
    v_rcp_f32 v218, v218
    s_nop 0
    v_pk_mul_f32 v[164:165], v[218:219], v[164:165] op_sel_hi:[0,1]
    v_pk_mul_f32 v[166:167], v[218:219], v[166:167] op_sel_hi:[0,1]
    v_pk_mul_f32 v[168:169], v[218:219], v[168:169] op_sel_hi:[0,1]
    v_pk_mul_f32 v[170:171], v[218:219], v[170:171] op_sel_hi:[0,1]
    v_pk_mul_f32 v[172:173], v[218:219], v[172:173] op_sel_hi:[0,1]
    v_pk_mul_f32 v[174:175], v[218:219], v[174:175] op_sel_hi:[0,1]
    v_pk_mul_f32 v[176:177], v[218:219], v[176:177] op_sel_hi:[0,1]
    v_pk_mul_f32 v[178:179], v[218:219], v[178:179] op_sel_hi:[0,1]
    v_cvt_pk_bf16_f32 v124, v164, v165
    v_cvt_pk_bf16_f32 v125, v166, v167
    v_cvt_pk_bf16_f32 v126, v168, v169
    v_cvt_pk_bf16_f32 v127, v170, v171
    v_cvt_pk_bf16_f32 v128, v172, v173
    v_cvt_pk_bf16_f32 v129, v174, v175
    v_cvt_pk_bf16_f32 v130, v176, v177
    v_cvt_pk_bf16_f32 v131, v178, v179
    ds_write_b64 v212, v[124:125] offset:16384
    ds_write_b64 v213, v[126:127] offset:16384
    ds_write_b64 v214, v[128:129] offset:16384
    ds_write_b64 v215, v[130:131] offset:16384
    v_max3_f32 v216, v180, v181, v182
    v_max3_f32 v216, v216, v183, v184
    v_max3_f32 v216, v216, v185, v186
    v_max3_f32 v216, v216, v187, v188
    v_max3_f32 v216, v216, v189, v190
    v_max3_f32 v216, v216, v191, v192
    v_max3_f32 v216, v216, v193, v194
    v_max_f32 v216, v216, v195
    v_mul_f32 v216, 0xbfb8aa3b, v216
    v_pk_fma_f32 v[180:181], v[180:181], v[220:221], v[216:217] op_sel_hi:[1,0,0]
    v_pk_fma_f32 v[182:183], v[182:183], v[220:221], v[216:217] op_sel_hi:[1,0,0]
    v_pk_fma_f32 v[184:185], v[184:185], v[220:221], v[216:217] op_sel_hi:[1,0,0]
    v_pk_fma_f32 v[186:187], v[186:187], v[220:221], v[216:217] op_sel_hi:[1,0,0]
    v_pk_fma_f32 v[188:189], v[188:189], v[220:221], v[216:217] op_sel_hi:[1,0,0]
    v_pk_fma_f32 v[190:191], v[190:191], v[220:221], v[216:217] op_sel_hi:[1,0,0]
    v_pk_fma_f32 v[192:193], v[192:193], v[220:221], v[216:217] op_sel_hi:[1,0,0]
    v_pk_fma_f32 v[194:195], v[194:195], v[220:221], v[216:217] op_sel_hi:[1,0,0]
    v_exp_f32 v180, v180
    v_exp_f32 v181, v181
    v_exp_f32 v182, v182
    v_exp_f32 v183, v183
    v_exp_f32 v184, v184
    v_exp_f32 v185, v185
    v_exp_f32 v186, v186
    v_exp_f32 v187, v187
    v_exp_f32 v188, v188
    v_pk_add_f32 v[218:219], v[180:181], v[182:183]
    v_exp_f32 v189, v189
    v_pk_add_f32 v[218:219], v[218:219], v[184:185]
    v_exp_f32 v190, v190
    v_pk_add_f32 v[218:219], v[218:219], v[186:187]
    v_exp_f32 v191, v191
    v_exp_f32 v192, v192
    v_exp_f32 v193, v193
    v_exp_f32 v194, v194
    v_exp_f32 v195, v195
    v_pk_add_f32 v[218:219], v[218:219], v[188:189]
    v_pk_add_f32 v[218:219], v[218:219], v[190:191]
    v_pk_add_f32 v[218:219], v[218:219], v[192:193]
    v_pk_add_f32 v[218:219], v[218:219], v[194:195]
    v_add_f32 v218, v218, v219
    v_rcp_f32 v218, v218
    s_nop 0
    v_pk_mul_f32 v[180:181], v[218:219], v[180:181] op_sel_hi:[0,1]
    v_pk_mul_f32 v[182:183], v[218:219], v[182:183] op_sel_hi:[0,1]
    v_pk_mul_f32 v[184:185], v[218:219], v[184:185] op_sel_hi:[0,1]
    v_pk_mul_f32 v[186:187], v[218:219], v[186:187] op_sel_hi:[0,1]
    v_pk_mul_f32 v[188:189], v[218:219], v[188:189] op_sel_hi:[0,1]
    v_pk_mul_f32 v[190:191], v[218:219], v[190:191] op_sel_hi:[0,1]
    v_pk_mul_f32 v[192:193], v[218:219], v[192:193] op_sel_hi:[0,1]
    v_pk_mul_f32 v[194:195], v[218:219], v[194:195] op_sel_hi:[0,1]
    v_cvt_pk_bf16_f32 v124, v180, v181
    v_cvt_pk_bf16_f32 v125, v182, v183
    v_cvt_pk_bf16_f32 v126, v184, v185
    v_cvt_pk_bf16_f32 v127, v186, v187
    v_cvt_pk_bf16_f32 v128, v188, v189
    v_cvt_pk_bf16_f32 v129, v190, v191
    v_cvt_pk_bf16_f32 v130, v192, v193
    v_cvt_pk_bf16_f32 v131, v194, v195
    ds_write_b64 v212, v[124:125] offset:24576
    ds_write_b64 v213, v[126:127] offset:24576
    ds_write_b64 v214, v[128:129] offset:24576
    ds_write_b64 v215, v[130:131] offset:24576
    s_waitcnt lgkmcnt(0)
    s_barrier
    v_mov_b32 v200, -1
    v_mov_b32 v201, -1
    v_mov_b32 v202, -1
    v_mov_b32 v203, -1
    s_and_b32 s52, s2, 0x7f
    s_lshl_b32 s52, s52, 2
    s_add_u32 s52, s52, s45
    s_lshl_b32 s52, s52, 12
    s_add_u32 s52, s52, 0x1400000
    buffer_store_dwordx4 v[200:203], v28, s[28:31], s52 offen sc0 sc1
    buffer_store_dwordx4 v[200:203], v28, s[28:31], s52 offen offset:1024 sc0 sc1
    buffer_store_dwordx4 v[200:203], v28, s[28:31], s52 offen offset:2048 sc0 sc1
    buffer_store_dwordx4 v[200:203], v28, s[28:31], s52 offen offset:3072 sc0 sc1
    s_waitcnt vmcnt(0)
    s_endpgm
hh_k1_r2:
    v_lshrrev_b32 v10, 3, v1
    v_lshrrev_b32 v11, 4, v1
    v_and_b32 v12, 7, v1
    s_lshl_b32 s52, s44, 4
    v_add_u32 v13, s52, v10
    v_lshlrev_b32 v5, 10, v13
    v_xor_b32 v13, v12, v11
    v_lshl_add_u32 v5, v13, 4, v5
    v_add_u32 v13, s52, v10
    v_add_u32 v13, 8, v13
    v_lshlrev_b32 v6, 10, v13
    v_xor_b32 v13, v12, v11
    v_xor_b32 v13, 4, v13
    v_lshl_add_u32 v6, v13, 4, v6
    s_add_u32 s53, s44, 4
    s_and_b32 s53, s53, 7
    s_lshl_b32 s59, s53, 10
    s_add_u32 s59, s59, 0xc000
    s_lshl_b32 s58, s44, 11
    s_lshl_b32 s53, s53, 6
    v_add_u32 v10, s53, v1
    v_mul_u32_u24 v11, 0x925, v10
    v_lshrrev_b32 v11, 16, v11
    v_mul_u32_u24 v12, 28, v11
    v_sub_u32 v12, v10, v12
    v_mul_u32_u24 v7, 0xe00, v11
    v_lshl_add_u32 v7, v12, 4, v7
    v_add_u32 v10, s53, v1
    v_add_u32 v10, 0x200, v10
    v_mul_u32_u24 v11, 0x925, v10
    v_lshrrev_b32 v11, 16, v11
    v_mul_u32_u24 v12, 28, v11
    v_sub_u32 v12, v10, v12
    v_mul_u32_u24 v8, 0xe00, v11
    v_lshl_add_u32 v8, v12, 4, v8
    v_add_u32 v10, s53, v1
    v_add_u32 v10, 0x400, v10
    v_mul_u32_u24 v11, 0x925, v10
    v_lshrrev_b32 v11, 16, v11
    v_mul_u32_u24 v12, 28, v11
    v_sub_u32 v12, v10, v12
    v_mul_u32_u24 v9, 0xe00, v11
    v_lshl_add_u32 v9, v12, 4, v9
    s_mov_b32 s56, 0
    s_mov_b32 s57, 0
    s_waitcnt lgkmcnt(0)
    s_lshl_b32 s52, s47, 17
    s_add_u32 s20, s4, s52
    s_addc_u32 s21, s5, 0
    s_mov_b32 s22, 0x20000
    s_mov_b32 s23, 0x20000
    s_mul_i32 s52, s48, 0x1c0
    s_add_u32 s24, s12, s52
    s_addc_u32 s25, s13, 0
    s_mov_b32 s26, 0x1bf3c0
    s_mov_b32 s27, 0x20000
    s_mov_b32 s28, s16
    s_mov_b32 s29, s17
    s_mov_b32 s30, 0x1600000
    s_mov_b32 s31, 0x20000
    s_mov_b32 s56, 0
    s_add_u32 m0, s58, 0
    s_nop 0
    buffer_load_dwordx4 v5, s[20:23], s56 offen lds
    s_mov_b32 s56, 0
    s_add_u32 m0, s58, 0x400
    s_nop 0
    buffer_load_dwordx4 v6, s[20:23], s56 offen lds
    s_mov_b32 s57, 0
    s_add_u32 m0, s59, 0
    s_nop 0
    buffer_load_dwordx4 v7, s[24:27], s57 offen lds
    s_mov_b32 s57, 0
    s_add_u32 m0, s59, 0x2000
    s_nop 0
    buffer_load_dwordx4 v8, s[24:27], s57 offen lds
    s_mov_b32 s57, 0
    s_add_u32 m0, s59, 0x4000
    s_nop 0
    buffer_load_dwordx4 v9, s[24:27], s57 offen lds
    s_barrier
    v_and_b32 v10, 31, v1
    s_lshl_b32 s52, s45, 5
    v_add_u32 v10, s52, v10
    v_lshlrev_b32 v10, 7, v10
    v_lshrrev_b32 v11, 5, v1
    v_bfe_u32 v12, v1, 1, 3
    v_xor_b32 v11, v11, v12
    v_lshl_add_u32 v10, v11, 4, v10
    v_lshrrev_b32 v11, 5, v1
    v_bfe_u32 v12, v1, 2, 2
    v_lshl_add_u32 v11, v11, 3, v12
    v_mul_u32_u24 v11, 0x1c0, v11
    v_bfe_u32 v12, v1, 4, 1
    v_lshl_add_u32 v11, v12, 5, v11
    v_and_b32 v12, 3, v1
    v_lshl_add_u32 v11, v12, 3, v11
    v_add_u32 v11, 0xc000, v11
    s_add_u32 s52, s45, 0
    s_and_b32 s52, s52, 3
    s_lshl_b32 s53, s52, 5
    v_xor_b32 v14, s53, v10
    s_mul_i32 s53, s52, 0x1c00
    v_add_u32 v18, s53, v11
    v_add_u32 v22, 0xe000, v18
    s_add_u32 s52, s45, 1
    s_and_b32 s52, s52, 3
    s_lshl_b32 s53, s52, 5
    v_xor_b32 v15, s53, v10
    s_mul_i32 s53, s52, 0x1c00
    v_add_u32 v19, s53, v11
    v_add_u32 v23, 0xe000, v19
    s_add_u32 s52, s45, 2
    s_and_b32 s52, s52, 3
    s_lshl_b32 s53, s52, 5
    v_xor_b32 v16, s53, v10
    s_mul_i32 s53, s52, 0x1c00
    v_add_u32 v20, s53, v11
    v_add_u32 v24, 0xe000, v20
    s_add_u32 s52, s45, 3
    s_and_b32 s52, s52, 3
    s_lshl_b32 s53, s52, 5
    v_xor_b32 v17, s53, v10
    s_mul_i32 s53, s52, 0x1c00
    v_add_u32 v21, s53, v11
    v_add_u32 v25, 0xe000, v21
    s_mov_b32 s56, 0x80
    s_add_u32 m0, s58, 0x4000
    s_nop 0
    buffer_load_dwordx4 v5, s[20:23], s56 offen lds
    s_mov_b32 s56, 0x80
    s_add_u32 m0, s58, 0x4400
    s_nop 0
    buffer_load_dwordx4 v6, s[20:23], s56 offen lds
    s_mov_b32 s57, 0x38000
    s_add_u32 m0, s59, 0x7000
    s_nop 0
    buffer_load_dwordx4 v7, s[24:27], s57 offen lds
    s_mov_b32 s57, 0x38000
    s_add_u32 m0, s59, 0x9000
    s_nop 0
    buffer_load_dwordx4 v8, s[24:27], s57 offen lds
    s_mov_b32 s57, 0x38000
    s_add_u32 m0, s59, 0xb000
    s_nop 0
    buffer_load_dwordx4 v9, s[24:27], s57 offen lds
    s_mov_b32 s96, s4
    s_mov_b32 s97, s5
    s_mov_b32 s98, 0
    s_mov_b32 s99, 0x20000
    s_mov_b32 s19, 0
    s_mov_b32 s52, 0
    s_mov_b32 s53, 0
    s_mov_b32 s54, 7
    s_cmp_eq_u32 s45, 0
    s_cselect_b32 s54, 10, s54
    s_cselect_b32 s98, 0x200000, s98
    s_cselect_b32 s19, 0x80, s19
    s_cselect_b32 s52, 8, s52
    s_cselect_b32 s53, 0x2000, s53
    s_cmp_eq_u32 s45, 1
    s_cselect_b32 s96, s6, s96
    s_cselect_b32 s97, s7, s97
    s_cselect_b32 s98, 0x180000, s98
    s_cselect_b32 s19, 0x30000, s19
    s_cselect_b32 s52, 6, s52
    s_cselect_b32 s53, 0x300, s53
    s_cmp_eq_u32 s45, 2
    s_cselect_b32 s96, s12, s96
    s_cselect_b32 s97, s13, s97
    s_cselect_b32 s98, 0x1c0000, s98
    s_cselect_b32 s19, 0x38000, s19
    s_cselect_b32 s52, 7, s52
    s_cselect_b32 s53, 0x380, s53
    s_mul_i32 s53, s53, s2
    v_lshlrev_b32 v26, s54, v1
    v_add_u32 v26, s53, v26
    v_cmp_le_u32 vcc, s52, v1
    v_mov_b32 v11, 0x80000000
    s_nop 0
    v_cndmask_b32 v26, v26, v11, vcc
    v_lshrrev_b32 v11, 2, v1
    v_and_b32 v12, 3, v1
    v_lshlrev_b32 v12, 4, v12
    v_lshl_add_u32 v27, v11, 10, v12
    v_lshlrev_b32 v28, 4, v1
    s_lshl_b32 s18, s44, 10
    s_add_u32 s18, s18, 0x21000
    v_lshrrev_b32 v11, 5, v1
    v_bfe_u32 v12, v1, 2, 2
    v_lshl_add_u32 v11, v11, 2, v12
    v_bfe_u32 v12, v1, 4, 1
    v_and_b32 v13, 3, v1
    v_lshl_add_u32 v40, v12, 2, v13
    v_lshlrev_b32 v40, 3, v40
    v_lshl_add_u32 v40, v11, 6, v40
    v_add_u32 v40, s18, v40
    v_lshrrev_b32 v11, 4, v1
    v_xor_b32 v11, v11, v1
    v_and_b32 v11, 1, v11
    v_cmp_eq_u32 vcc, 0, v11
    v_mov_b32 v11, 0
    v_mov_b32 v12, 0x3f803f80
    v_cndmask_b32 v168, v11, v12, vcc
    v_cndmask_b32 v169, v11, v12, vcc
    v_cndmask_b32 v170, v11, v12, vcc
    v_cndmask_b32 v171, v11, v12, vcc
    s_mov_b32 s60, 0xffff0000
    v_mov_b32 v148, 0
    v_mov_b32 v149, 0
    v_mov_b32 v150, 0
    v_mov_b32 v151, 0
    s_mul_i32 s54, s19, 3
    buffer_load_dword v4, v26, s[96:99], s54 offen
    s_waitcnt vmcnt(6)
    s_barrier
    ds_read_b128 v[108:111], v14
    ds_read_b64_tr_b16 v[116:117], v18
    ds_read_b64_tr_b16 v[118:119], v18 offset:1792
    ds_read_b64_tr_b16 v[120:121], v18 offset:128
    ds_read_b64_tr_b16 v[122:123], v18 offset:1920
    ds_read_b64_tr_b16 v[124:125], v18 offset:256
    ds_read_b64_tr_b16 v[126:127], v18 offset:2048
    ds_read_b64_tr_b16 v[128:129], v18 offset:384
    ds_read_b64_tr_b16 v[130:131], v18 offset:2176
    s_waitcnt lgkmcnt(6)
    v_mfma_f32_32x32x16_bf16 v[44:59], v[116:119], v[108:111], 0
    ds_read_b128 v[112:115], v15
    ds_read_b64_tr_b16 v[132:133], v19
    ds_read_b64_tr_b16 v[134:135], v19 offset:1792
    v_mfma_f32_16x16x32_bf16 v[152:155], v[116:119], v[168:171], 0
    v_lshlrev_b32 v172, 16, v108
    v_and_b32 v173, s60, v108
    v_add_f32 v148, v148, v172
    s_waitcnt lgkmcnt(7)
    v_mfma_f32_32x32x16_bf16 v[60:75], v[120:123], v[108:111], 0
    ds_read_b64_tr_b16 v[136:137], v19 offset:128
    ds_read_b64_tr_b16 v[138:139], v19 offset:1920
    v_add_f32 v150, v150, v173
    v_fma_f32 v149, v172, v172, v149
    v_fma_f32 v151, v173, v173, v151
    s_waitcnt lgkmcnt(7)
    v_mfma_f32_32x32x16_bf16 v[76:91], v[124:127], v[108:111], 0
    ds_read_b64_tr_b16 v[140:141], v19 offset:256
    ds_read_b64_tr_b16 v[142:143], v19 offset:2048
    s_mov_b32 s56, 0x100
    s_add_u32 m0, s58, 0x8000
    s_nop 0
    buffer_load_dwordx4 v5, s[20:23], s56 offen lds
    v_lshlrev_b32 v174, 16, v109
    v_and_b32 v175, s60, v109
    v_add_f32 v148, v148, v174
    s_waitcnt lgkmcnt(7)
    v_mfma_f32_32x32x16_bf16 v[92:107], v[128:131], v[108:111], 0
    ds_read_b64_tr_b16 v[144:145], v19 offset:384
    ds_read_b64_tr_b16 v[146:147], v19 offset:2176
    v_add_f32 v150, v150, v175
    v_fma_f32 v149, v174, v174, v149
    v_fma_f32 v151, v175, v175, v151
    s_waitcnt lgkmcnt(6)
    v_mfma_f32_32x32x16_bf16 v[44:59], v[132:135], v[112:115], v[44:59]
    ds_read_b128 v[108:111], v16
    ds_read_b64_tr_b16 v[116:117], v20
    ds_read_b64_tr_b16 v[118:119], v20 offset:1792
    s_mov_b32 s56, 0x100
    s_add_u32 m0, s58, 0x8400
    s_nop 0
    buffer_load_dwordx4 v6, s[20:23], s56 offen lds
    s_mul_i32 s54, s19, 4
    buffer_load_dword v4, v26, s[96:99], s54 offen
    v_lshlrev_b32 v172, 16, v112
    v_and_b32 v173, s60, v112
    v_add_f32 v148, v148, v172
    s_waitcnt lgkmcnt(7)
    v_mfma_f32_32x32x16_bf16 v[60:75], v[136:139], v[112:115], v[60:75]
    ds_read_b64_tr_b16 v[120:121], v20 offset:128
    ds_read_b64_tr_b16 v[122:123], v20 offset:1920
    v_mfma_f32_16x16x32_bf16 v[156:159], v[136:139], v[168:171], 0
    v_add_f32 v150, v150, v173
    v_fma_f32 v149, v172, v172, v149
    v_fma_f32 v151, v173, v173, v151
    s_waitcnt lgkmcnt(7)
    v_mfma_f32_32x32x16_bf16 v[76:91], v[140:143], v[112:115], v[76:91]
    ds_read_b64_tr_b16 v[124:125], v20 offset:256
    ds_read_b64_tr_b16 v[126:127], v20 offset:2048
    v_lshlrev_b32 v174, 16, v113
    v_and_b32 v175, s60, v113
    v_add_f32 v148, v148, v174
    s_waitcnt lgkmcnt(7)
    v_mfma_f32_32x32x16_bf16 v[92:107], v[144:147], v[112:115], v[92:107]
    ds_read_b64_tr_b16 v[128:129], v20 offset:384
    ds_read_b64_tr_b16 v[130:131], v20 offset:2176
    s_mov_b32 s57, 0x70000
    s_add_u32 m0, s59, 0xe000
    s_nop 0
    buffer_load_dwordx4 v7, s[24:27], s57 offen lds
    v_add_f32 v150, v150, v175
    v_fma_f32 v149, v174, v174, v149
    v_fma_f32 v151, v175, v175, v151
    s_waitcnt lgkmcnt(6)
    v_mfma_f32_32x32x16_bf16 v[44:59], v[116:119], v[108:111], v[44:59]
    ds_read_b128 v[112:115], v17
    ds_read_b64_tr_b16 v[132:133], v21
    ds_read_b64_tr_b16 v[134:135], v21 offset:1792
    v_lshlrev_b32 v172, 16, v108
    v_and_b32 v173, s60, v108
    v_add_f32 v148, v148, v172
    s_waitcnt lgkmcnt(7)
    v_mfma_f32_32x32x16_bf16 v[60:75], v[120:123], v[108:111], v[60:75]
    ds_read_b64_tr_b16 v[136:137], v21 offset:128
    ds_read_b64_tr_b16 v[138:139], v21 offset:1920
    s_mov_b32 s57, 0x70000
    s_add_u32 m0, s59, 0x10000
    s_nop 0
    buffer_load_dwordx4 v8, s[24:27], s57 offen lds
    v_add_f32 v150, v150, v173
    v_fma_f32 v149, v172, v172, v149
    v_fma_f32 v151, v173, v173, v151
    s_waitcnt lgkmcnt(7)
    v_mfma_f32_32x32x16_bf16 v[76:91], v[124:127], v[108:111], v[76:91]
    ds_read_b64_tr_b16 v[140:141], v21 offset:256
    ds_read_b64_tr_b16 v[142:143], v21 offset:2048
    v_mfma_f32_16x16x32_bf16 v[160:163], v[124:127], v[168:171], 0
    v_lshlrev_b32 v174, 16, v109
    v_and_b32 v175, s60, v109
    v_add_f32 v148, v148, v174
    s_waitcnt lgkmcnt(7)
    v_mfma_f32_32x32x16_bf16 v[92:107], v[128:131], v[108:111], v[92:107]
    ds_read_b64_tr_b16 v[144:145], v21 offset:384
    ds_read_b64_tr_b16 v[146:147], v21 offset:2176
    s_mov_b32 s57, 0x70000
    s_add_u32 m0, s59, 0x12000
    s_nop 0
    buffer_load_dwordx4 v9, s[24:27], s57 offen lds
    v_add_f32 v150, v150, v175
    v_fma_f32 v149, v174, v174, v149
    v_fma_f32 v151, v175, v175, v151
    s_waitcnt lgkmcnt(6)
    v_mfma_f32_32x32x16_bf16 v[44:59], v[132:135], v[112:115], v[44:59]
    v_lshlrev_b32 v172, 16, v112
    v_and_b32 v173, s60, v112
    v_add_f32 v148, v148, v172
    s_waitcnt lgkmcnt(4)
    v_mfma_f32_32x32x16_bf16 v[60:75], v[136:139], v[112:115], v[60:75]
    s_waitcnt lgkmcnt(0)
    s_waitcnt vmcnt(7)
    s_barrier
    ds_read_b128 v[108:111], v14 offset:16384
    ds_read_b64_tr_b16 v[116:117], v18 offset:28672
    ds_read_b64_tr_b16 v[118:119], v18 offset:30464
    ds_read_b64_tr_b16 v[120:121], v18 offset:28800
    ds_read_b64_tr_b16 v[122:123], v18 offset:30592
    ds_read_b64_tr_b16 v[124:125], v18 offset:28928
    ds_read_b64_tr_b16 v[126:127], v18 offset:30720
    ds_read_b64_tr_b16 v[128:129], v18 offset:29056
    ds_read_b64_tr_b16 v[130:131], v18 offset:30848
    v_add_f32 v150, v150, v173
    v_fma_f32 v149, v172, v172, v149
    v_fma_f32 v151, v173, v173, v151
    v_mfma_f32_32x32x16_bf16 v[76:91], v[140:143], v[112:115], v[76:91]
    v_lshlrev_b32 v174, 16, v113
    v_and_b32 v175, s60, v113
    v_add_f32 v148, v148, v174
    v_mfma_f32_32x32x16_bf16 v[92:107], v[144:147], v[112:115], v[92:107]
    v_mfma_f32_16x16x32_bf16 v[164:167], v[144:147], v[168:171], 0
    v_add_f32 v150, v150, v175
    v_fma_f32 v149, v174, v174, v149
    v_fma_f32 v151, v175, v175, v151
    s_waitcnt lgkmcnt(6)
    v_mfma_f32_32x32x16_bf16 v[44:59], v[116:119], v[108:111], v[44:59]
    ds_read_b128 v[112:115], v15 offset:16384
    ds_read_b64_tr_b16 v[132:133], v19 offset:28672
    ds_read_b64_tr_b16 v[134:135], v19 offset:30464
    s_mov_b32 s56, 0x180
    s_add_u32 m0, s58, 0
    s_nop 0
    buffer_load_dwordx4 v5, s[20:23], s56 offen lds
    s_mul_i32 s54, s19, 5
    buffer_load_dword v4, v26, s[96:99], s54 offen
    v_mfma_f32_16x16x32_bf16 v[152:155], v[116:119], v[168:171], v[152:155]
    v_lshlrev_b32 v172, 16, v108
    v_and_b32 v173, s60, v108
    v_add_f32 v148, v148, v172
    s_waitcnt lgkmcnt(7)
    v_mfma_f32_32x32x16_bf16 v[60:75], v[120:123], v[108:111], v[60:75]
    ds_read_b64_tr_b16 v[136:137], v19 offset:28800
    ds_read_b64_tr_b16 v[138:139], v19 offset:30592
    v_add_f32 v150, v150, v173
    v_fma_f32 v149, v172, v172, v149
    v_fma_f32 v151, v173, v173, v151
    s_waitcnt lgkmcnt(7)
    v_mfma_f32_32x32x16_bf16 v[76:91], v[124:127], v[108:111], v[76:91]
    ds_read_b64_tr_b16 v[140:141], v19 offset:28928
    ds_read_b64_tr_b16 v[142:143], v19 offset:30720
    v_lshlrev_b32 v174, 16, v109
    v_and_b32 v175, s60, v109
    v_add_f32 v148, v148, v174
    s_waitcnt lgkmcnt(7)
    v_mfma_f32_32x32x16_bf16 v[92:107], v[128:131], v[108:111], v[92:107]
    ds_read_b64_tr_b16 v[144:145], v19 offset:29056
    ds_read_b64_tr_b16 v[146:147], v19 offset:30848
    s_mov_b32 s56, 0x180
    s_add_u32 m0, s58, 0x400
    s_nop 0
    buffer_load_dwordx4 v6, s[20:23], s56 offen lds
    v_add_f32 v150, v150, v175
    v_fma_f32 v149, v174, v174, v149
    v_fma_f32 v151, v175, v175, v151
    s_waitcnt lgkmcnt(6)
    v_mfma_f32_32x32x16_bf16 v[44:59], v[132:135], v[112:115], v[44:59]
    ds_read_b128 v[108:111], v16 offset:16384
    ds_read_b64_tr_b16 v[116:117], v20 offset:28672
    ds_read_b64_tr_b16 v[118:119], v20 offset:30464
    v_lshlrev_b32 v172, 16, v112
    v_and_b32 v173, s60, v112
    v_add_f32 v148, v148, v172
    s_waitcnt lgkmcnt(7)
    v_mfma_f32_32x32x16_bf16 v[60:75], v[136:139], v[112:115], v[60:75]
    ds_read_b64_tr_b16 v[120:121], v20 offset:28800
    ds_read_b64_tr_b16 v[122:123], v20 offset:30592
    v_mfma_f32_16x16x32_bf16 v[156:159], v[136:139], v[168:171], v[156:159]
    v_add_f32 v150, v150, v173
    v_fma_f32 v149, v172, v172, v149
    v_fma_f32 v151, v173, v173, v151
    s_waitcnt lgkmcnt(7)
    v_mfma_f32_32x32x16_bf16 v[76:91], v[140:143], v[112:115], v[76:91]
    ds_read_b64_tr_b16 v[124:125], v20 offset:28928
    ds_read_b64_tr_b16 v[126:127], v20 offset:30720
    s_mov_b32 s57, 0xa8000
    s_add_u32 m0, s59, 0
    s_nop 0
    buffer_load_dwordx4 v7, s[24:27], s57 offen lds
    v_lshlrev_b32 v174, 16, v113
    v_and_b32 v175, s60, v113
    v_add_f32 v148, v148, v174
    s_waitcnt lgkmcnt(7)
    v_mfma_f32_32x32x16_bf16 v[92:107], v[144:147], v[112:115], v[92:107]
    ds_read_b64_tr_b16 v[128:129], v20 offset:29056
    ds_read_b64_tr_b16 v[130:131], v20 offset:30848
    v_add_f32 v150, v150, v175
    v_fma_f32 v149, v174, v174, v149
    v_fma_f32 v151, v175, v175, v151
    s_waitcnt lgkmcnt(6)
    v_mfma_f32_32x32x16_bf16 v[44:59], v[116:119], v[108:111], v[44:59]
    ds_read_b128 v[112:115], v17 offset:16384
    ds_read_b64_tr_b16 v[132:133], v21 offset:28672
    ds_read_b64_tr_b16 v[134:135], v21 offset:30464
    v_lshlrev_b32 v172, 16, v108
    v_and_b32 v173, s60, v108
    v_add_f32 v148, v148, v172
    s_waitcnt lgkmcnt(7)
    v_mfma_f32_32x32x16_bf16 v[60:75], v[120:123], v[108:111], v[60:75]
    ds_read_b64_tr_b16 v[136:137], v21 offset:28800
    ds_read_b64_tr_b16 v[138:139], v21 offset:30592
    s_mov_b32 s57, 0xa8000
    s_add_u32 m0, s59, 0x2000
    s_nop 0
    buffer_load_dwordx4 v8, s[24:27], s57 offen lds
    v_add_f32 v150, v150, v173
    v_fma_f32 v149, v172, v172, v149
    v_fma_f32 v151, v173, v173, v151
    s_waitcnt lgkmcnt(7)
    v_mfma_f32_32x32x16_bf16 v[76:91], v[124:127], v[108:111], v[76:91]
    ds_read_b64_tr_b16 v[140:141], v21 offset:28928
    ds_read_b64_tr_b16 v[142:143], v21 offset:30720
    v_mfma_f32_16x16x32_bf16 v[160:163], v[124:127], v[168:171], v[160:163]
    v_lshlrev_b32 v174, 16, v109
    v_and_b32 v175, s60, v109
    v_add_f32 v148, v148, v174
    s_waitcnt lgkmcnt(7)
    v_mfma_f32_32x32x16_bf16 v[92:107], v[128:131], v[108:111], v[92:107]
    ds_read_b64_tr_b16 v[144:145], v21 offset:29056
    ds_read_b64_tr_b16 v[146:147], v21 offset:30848
    s_mov_b32 s57, 0xa8000
    s_add_u32 m0, s59, 0x4000
    s_nop 0
    buffer_load_dwordx4 v9, s[24:27], s57 offen lds
    v_add_f32 v150, v150, v175
    v_fma_f32 v149, v174, v174, v149
    v_fma_f32 v151, v175, v175, v151
    s_waitcnt lgkmcnt(6)
    v_mfma_f32_32x32x16_bf16 v[44:59], v[132:135], v[112:115], v[44:59]
    v_lshlrev_b32 v172, 16, v112
    v_and_b32 v173, s60, v112
    v_add_f32 v148, v148, v172
    s_waitcnt lgkmcnt(4)
    v_mfma_f32_32x32x16_bf16 v[60:75], v[136:139], v[112:115], v[60:75]
    s_waitcnt lgkmcnt(0)
    s_waitcnt vmcnt(6)
    s_barrier
    ds_read_b128 v[108:111], v14 offset:32768
    ds_read_b64_tr_b16 v[116:117], v22
    ds_read_b64_tr_b16 v[118:119], v22 offset:1792
    ds_read_b64_tr_b16 v[120:121], v22 offset:128
    ds_read_b64_tr_b16 v[122:123], v22 offset:1920
    ds_read_b64_tr_b16 v[124:125], v22 offset:256
    ds_read_b64_tr_b16 v[126:127], v22 offset:2048
    ds_read_b64_tr_b16 v[128:129], v22 offset:384
    ds_read_b64_tr_b16 v[130:131], v22 offset:2176
    v_add_f32 v150, v150, v173
    v_fma_f32 v149, v172, v172, v149
    v_fma_f32 v151, v173, v173, v151
    v_mfma_f32_32x32x16_bf16 v[76:91], v[140:143], v[112:115], v[76:91]
    v_lshlrev_b32 v174, 16, v113
    v_and_b32 v175, s60, v113
    v_add_f32 v148, v148, v174
    v_mfma_f32_32x32x16_bf16 v[92:107], v[144:147], v[112:115], v[92:107]
    v_mfma_f32_16x16x32_bf16 v[164:167], v[144:147], v[168:171], v[164:167]
    v_add_f32 v150, v150, v175
    v_fma_f32 v149, v174, v174, v149
    v_fma_f32 v151, v175, v175, v151
    s_waitcnt lgkmcnt(6)
    v_mfma_f32_32x32x16_bf16 v[44:59], v[116:119], v[108:111], v[44:59]
    ds_read_b128 v[112:115], v15 offset:32768
    ds_read_b64_tr_b16 v[132:133], v23
    ds_read_b64_tr_b16 v[134:135], v23 offset:1792
    s_mov_b32 s56, 0x200
    s_add_u32 m0, s58, 0x4000
    s_nop 0
    buffer_load_dwordx4 v5, s[20:23], s56 offen lds
    s_mul_i32 s54, s19, 6
    buffer_load_dword v4, v26, s[96:99], s54 offen
    v_mfma_f32_16x16x32_bf16 v[152:155], v[116:119], v[168:171], v[152:155]
    v_lshlrev_b32 v172, 16, v108
    v_and_b32 v173, s60, v108
    v_add_f32 v148, v148, v172
    s_waitcnt lgkmcnt(7)
    v_mfma_f32_32x32x16_bf16 v[60:75], v[120:123], v[108:111], v[60:75]
    ds_read_b64_tr_b16 v[136:137], v23 offset:128
    ds_read_b64_tr_b16 v[138:139], v23 offset:1920
    v_add_f32 v150, v150, v173
    v_fma_f32 v149, v172, v172, v149
    v_fma_f32 v151, v173, v173, v151
    s_waitcnt lgkmcnt(7)
    v_mfma_f32_32x32x16_bf16 v[76:91], v[124:127], v[108:111], v[76:91]
    ds_read_b64_tr_b16 v[140:141], v23 offset:256
    ds_read_b64_tr_b16 v[142:143], v23 offset:2048
    v_lshlrev_b32 v174, 16, v109
    v_and_b32 v175, s60, v109
    v_add_f32 v148, v148, v174
    s_waitcnt lgkmcnt(7)
    v_mfma_f32_32x32x16_bf16 v[92:107], v[128:131], v[108:111], v[92:107]
    ds_read_b64_tr_b16 v[144:145], v23 offset:384
    ds_read_b64_tr_b16 v[146:147], v23 offset:2176
    s_mov_b32 s56, 0x200
    s_add_u32 m0, s58, 0x4400
    s_nop 0
    buffer_load_dwordx4 v6, s[20:23], s56 offen lds
    v_add_f32 v150, v150, v175
    v_fma_f32 v149, v174, v174, v149
    v_fma_f32 v151, v175, v175, v151
    s_waitcnt lgkmcnt(6)
    v_mfma_f32_32x32x16_bf16 v[44:59], v[132:135], v[112:115], v[44:59]
    ds_read_b128 v[108:111], v16 offset:32768
    ds_read_b64_tr_b16 v[116:117], v24
    ds_read_b64_tr_b16 v[118:119], v24 offset:1792
    v_lshlrev_b32 v172, 16, v112
    v_and_b32 v173, s60, v112
    v_add_f32 v148, v148, v172
    s_waitcnt lgkmcnt(7)
    v_mfma_f32_32x32x16_bf16 v[60:75], v[136:139], v[112:115], v[60:75]
    ds_read_b64_tr_b16 v[120:121], v24 offset:128
    ds_read_b64_tr_b16 v[122:123], v24 offset:1920
    v_mfma_f32_16x16x32_bf16 v[156:159], v[136:139], v[168:171], v[156:159]
    v_add_f32 v150, v150, v173
    v_fma_f32 v149, v172, v172, v149
    v_fma_f32 v151, v173, v173, v151
    s_waitcnt lgkmcnt(7)
    v_mfma_f32_32x32x16_bf16 v[76:91], v[140:143], v[112:115], v[76:91]
    ds_read_b64_tr_b16 v[124:125], v24 offset:256
    ds_read_b64_tr_b16 v[126:127], v24 offset:2048
    s_mov_b32 s57, 0xe0000
    s_add_u32 m0, s59, 0x7000
    s_nop 0
    buffer_load_dwordx4 v7, s[24:27], s57 offen lds
    v_lshlrev_b32 v174, 16, v113
    v_and_b32 v175, s60, v113
    v_add_f32 v148, v148, v174
    s_waitcnt lgkmcnt(7)
    v_mfma_f32_32x32x16_bf16 v[92:107], v[144:147], v[112:115], v[92:107]
    ds_read_b64_tr_b16 v[128:129], v24 offset:384
    ds_read_b64_tr_b16 v[130:131], v24 offset:2176
    v_add_f32 v150, v150, v175
    v_fma_f32 v149, v174, v174, v149
    v_fma_f32 v151, v175, v175, v151
    s_waitcnt lgkmcnt(6)
    v_mfma_f32_32x32x16_bf16 v[44:59], v[116:119], v[108:111], v[44:59]
    ds_read_b128 v[112:115], v17 offset:32768
    ds_read_b64_tr_b16 v[132:133], v25
    ds_read_b64_tr_b16 v[134:135], v25 offset:1792
    v_lshlrev_b32 v172, 16, v108
    v_and_b32 v173, s60, v108
    v_add_f32 v148, v148, v172
    s_waitcnt lgkmcnt(7)
    v_mfma_f32_32x32x16_bf16 v[60:75], v[120:123], v[108:111], v[60:75]
    ds_read_b64_tr_b16 v[136:137], v25 offset:128
    ds_read_b64_tr_b16 v[138:139], v25 offset:1920
    s_mov_b32 s57, 0xe0000
    s_add_u32 m0, s59, 0x9000
    s_nop 0
    buffer_load_dwordx4 v8, s[24:27], s57 offen lds
    v_add_f32 v150, v150, v173
    v_fma_f32 v149, v172, v172, v149
    v_fma_f32 v151, v173, v173, v151
    s_waitcnt lgkmcnt(7)
    v_mfma_f32_32x32x16_bf16 v[76:91], v[124:127], v[108:111], v[76:91]
    ds_read_b64_tr_b16 v[140:141], v25 offset:256
    ds_read_b64_tr_b16 v[142:143], v25 offset:2048
    v_mfma_f32_16x16x32_bf16 v[160:163], v[124:127], v[168:171], v[160:163]
    v_lshlrev_b32 v174, 16, v109
    v_and_b32 v175, s60, v109
    v_add_f32 v148, v148, v174
    s_waitcnt lgkmcnt(7)
    v_mfma_f32_32x32x16_bf16 v[92:107], v[128:131], v[108:111], v[92:107]
    ds_read_b64_tr_b16 v[144:145], v25 offset:384
    ds_read_b64_tr_b16 v[146:147], v25 offset:2176
    s_mov_b32 s57, 0xe0000
    s_add_u32 m0, s59, 0xb000
    s_nop 0
    buffer_load_dwordx4 v9, s[24:27], s57 offen lds
    v_add_f32 v150, v150, v175
    v_fma_f32 v149, v174, v174, v149
    v_fma_f32 v151, v175, v175, v151
    s_waitcnt lgkmcnt(6)
    v_mfma_f32_32x32x16_bf16 v[44:59], v[132:135], v[112:115], v[44:59]
    v_lshlrev_b32 v172, 16, v112
    v_and_b32 v173, s60, v112
    v_add_f32 v148, v148, v172
    s_waitcnt lgkmcnt(4)
    v_mfma_f32_32x32x16_bf16 v[60:75], v[136:139], v[112:115], v[60:75]
    s_waitcnt lgkmcnt(0)
    s_waitcnt vmcnt(6)
    s_barrier
    ds_read_b128 v[108:111], v14
    ds_read_b64_tr_b16 v[116:117], v18
    ds_read_b64_tr_b16 v[118:119], v18 offset:1792
    ds_read_b64_tr_b16 v[120:121], v18 offset:128
    ds_read_b64_tr_b16 v[122:123], v18 offset:1920
    ds_read_b64_tr_b16 v[124:125], v18 offset:256
    ds_read_b64_tr_b16 v[126:127], v18 offset:2048
    ds_read_b64_tr_b16 v[128:129], v18 offset:384
    ds_read_b64_tr_b16 v[130:131], v18 offset:2176
    v_add_f32 v150, v150, v173
    v_fma_f32 v149, v172, v172, v149
    v_fma_f32 v151, v173, v173, v151
    v_mfma_f32_32x32x16_bf16 v[76:91], v[140:143], v[112:115], v[76:91]
    v_lshlrev_b32 v174, 16, v113
    v_and_b32 v175, s60, v113
    v_add_f32 v148, v148, v174
    v_mfma_f32_32x32x16_bf16 v[92:107], v[144:147], v[112:115], v[92:107]
    v_mfma_f32_16x16x32_bf16 v[164:167], v[144:147], v[168:171], v[164:167]
    v_add_f32 v150, v150, v175
    v_fma_f32 v149, v174, v174, v149
    v_fma_f32 v151, v175, v175, v151
    s_waitcnt lgkmcnt(6)
    v_mfma_f32_32x32x16_bf16 v[44:59], v[116:119], v[108:111], v[44:59]
    ds_read_b128 v[112:115], v15
    ds_read_b64_tr_b16 v[132:133], v19
    ds_read_b64_tr_b16 v[134:135], v19 offset:1792
    s_mov_b32 s56, 0x280
    s_add_u32 m0, s58, 0x8000
    s_nop 0
    buffer_load_dwordx4 v5, s[20:23], s56 offen lds
    s_mul_i32 s54, s19, 7
    buffer_load_dword v4, v26, s[96:99], s54 offen
    v_mfma_f32_16x16x32_bf16 v[152:155], v[116:119], v[168:171], v[152:155]
    v_lshlrev_b32 v172, 16, v108
    v_and_b32 v173, s60, v108
    v_add_f32 v148, v148, v172
    s_waitcnt lgkmcnt(7)
    v_mfma_f32_32x32x16_bf16 v[60:75], v[120:123], v[108:111], v[60:75]
    ds_read_b64_tr_b16 v[136:137], v19 offset:128
    ds_read_b64_tr_b16 v[138:139], v19 offset:1920
    v_add_f32 v150, v150, v173
    v_fma_f32 v149, v172, v172, v149
    v_fma_f32 v151, v173, v173, v151
    s_waitcnt lgkmcnt(7)
    v_mfma_f32_32x32x16_bf16 v[76:91], v[124:127], v[108:111], v[76:91]
    ds_read_b64_tr_b16 v[140:141], v19 offset:256
    ds_read_b64_tr_b16 v[142:143], v19 offset:2048
    v_lshlrev_b32 v174, 16, v109
    v_and_b32 v175, s60, v109
    v_add_f32 v148, v148, v174
    s_waitcnt lgkmcnt(7)
    v_mfma_f32_32x32x16_bf16 v[92:107], v[128:131], v[108:111], v[92:107]
    ds_read_b64_tr_b16 v[144:145], v19 offset:384
    ds_read_b64_tr_b16 v[146:147], v19 offset:2176
    s_mov_b32 s56, 0x280
    s_add_u32 m0, s58, 0x8400
    s_nop 0
    buffer_load_dwordx4 v6, s[20:23], s56 offen lds
    v_add_f32 v150, v150, v175
    v_fma_f32 v149, v174, v174, v149
    v_fma_f32 v151, v175, v175, v151
    s_waitcnt lgkmcnt(6)
    v_mfma_f32_32x32x16_bf16 v[44:59], v[132:135], v[112:115], v[44:59]
    ds_read_b128 v[108:111], v16
    ds_read_b64_tr_b16 v[116:117], v20
    ds_read_b64_tr_b16 v[118:119], v20 offset:1792
    v_lshlrev_b32 v172, 16, v112
    v_and_b32 v173, s60, v112
    v_add_f32 v148, v148, v172
    s_waitcnt lgkmcnt(7)
    v_mfma_f32_32x32x16_bf16 v[60:75], v[136:139], v[112:115], v[60:75]
    ds_read_b64_tr_b16 v[120:121], v20 offset:128
    ds_read_b64_tr_b16 v[122:123], v20 offset:1920
    v_mfma_f32_16x16x32_bf16 v[156:159], v[136:139], v[168:171], v[156:159]
    v_add_f32 v150, v150, v173
    v_fma_f32 v149, v172, v172, v149
    v_fma_f32 v151, v173, v173, v151
    s_waitcnt lgkmcnt(7)
    v_mfma_f32_32x32x16_bf16 v[76:91], v[140:143], v[112:115], v[76:91]
    ds_read_b64_tr_b16 v[124:125], v20 offset:256
    ds_read_b64_tr_b16 v[126:127], v20 offset:2048
    s_mov_b32 s57, 0x118000
    s_add_u32 m0, s59, 0xe000
    s_nop 0
    buffer_load_dwordx4 v7, s[24:27], s57 offen lds
    v_lshlrev_b32 v174, 16, v113
    v_and_b32 v175, s60, v113
    v_add_f32 v148, v148, v174
    s_waitcnt lgkmcnt(7)
    v_mfma_f32_32x32x16_bf16 v[92:107], v[144:147], v[112:115], v[92:107]
    ds_read_b64_tr_b16 v[128:129], v20 offset:384
    ds_read_b64_tr_b16 v[130:131], v20 offset:2176
    v_add_f32 v150, v150, v175
    v_fma_f32 v149, v174, v174, v149
    v_fma_f32 v151, v175, v175, v151
    s_waitcnt lgkmcnt(6)
    v_mfma_f32_32x32x16_bf16 v[44:59], v[116:119], v[108:111], v[44:59]
    ds_read_b128 v[112:115], v17
    ds_read_b64_tr_b16 v[132:133], v21
    ds_read_b64_tr_b16 v[134:135], v21 offset:1792
    v_lshlrev_b32 v172, 16, v108
    v_and_b32 v173, s60, v108
    v_add_f32 v148, v148, v172
    s_waitcnt lgkmcnt(7)
    v_mfma_f32_32x32x16_bf16 v[60:75], v[120:123], v[108:111], v[60:75]
    ds_read_b64_tr_b16 v[136:137], v21 offset:128
    ds_read_b64_tr_b16 v[138:139], v21 offset:1920
    s_mov_b32 s57, 0x118000
    s_add_u32 m0, s59, 0x10000
    s_nop 0
    buffer_load_dwordx4 v8, s[24:27], s57 offen lds
    v_add_f32 v150, v150, v173
    v_fma_f32 v149, v172, v172, v149
    v_fma_f32 v151, v173, v173, v151
    s_waitcnt lgkmcnt(7)
    v_mfma_f32_32x32x16_bf16 v[76:91], v[124:127], v[108:111], v[76:91]
    ds_read_b64_tr_b16 v[140:141], v21 offset:256
    ds_read_b64_tr_b16 v[142:143], v21 offset:2048
    v_mfma_f32_16x16x32_bf16 v[160:163], v[124:127], v[168:171], v[160:163]
    v_lshlrev_b32 v174, 16, v109
    v_and_b32 v175, s60, v109
    v_add_f32 v148, v148, v174
    s_waitcnt lgkmcnt(7)
    v_mfma_f32_32x32x16_bf16 v[92:107], v[128:131], v[108:111], v[92:107]
    ds_read_b64_tr_b16 v[144:145], v21 offset:384
    ds_read_b64_tr_b16 v[146:147], v21 offset:2176
    s_mov_b32 s57, 0x118000
    s_add_u32 m0, s59, 0x12000
    s_nop 0
    buffer_load_dwordx4 v9, s[24:27], s57 offen lds
    v_add_f32 v150, v150, v175
    v_fma_f32 v149, v174, v174, v149
    v_fma_f32 v151, v175, v175, v151
    s_waitcnt lgkmcnt(6)
    v_mfma_f32_32x32x16_bf16 v[44:59], v[132:135], v[112:115], v[44:59]
    v_lshlrev_b32 v172, 16, v112
    v_and_b32 v173, s60, v112
    v_add_f32 v148, v148, v172
    s_waitcnt lgkmcnt(4)
    v_mfma_f32_32x32x16_bf16 v[60:75], v[136:139], v[112:115], v[60:75]
    s_waitcnt lgkmcnt(0)
    s_waitcnt vmcnt(6)
    s_barrier
    ds_read_b128 v[108:111], v14 offset:16384
    ds_read_b64_tr_b16 v[116:117], v18 offset:28672
    ds_read_b64_tr_b16 v[118:119], v18 offset:30464
    ds_read_b64_tr_b16 v[120:121], v18 offset:28800
    ds_read_b64_tr_b16 v[122:123], v18 offset:30592
    ds_read_b64_tr_b16 v[124:125], v18 offset:28928
    ds_read_b64_tr_b16 v[126:127], v18 offset:30720
    ds_read_b64_tr_b16 v[128:129], v18 offset:29056
    ds_read_b64_tr_b16 v[130:131], v18 offset:30848
    v_add_f32 v150, v150, v173
    v_fma_f32 v149, v172, v172, v149
    v_fma_f32 v151, v173, v173, v151
    v_mfma_f32_32x32x16_bf16 v[76:91], v[140:143], v[112:115], v[76:91]
    v_lshlrev_b32 v174, 16, v113
    v_and_b32 v175, s60, v113
    v_add_f32 v148, v148, v174
    v_mfma_f32_32x32x16_bf16 v[92:107], v[144:147], v[112:115], v[92:107]
    v_mfma_f32_16x16x32_bf16 v[164:167], v[144:147], v[168:171], v[164:167]
    v_add_f32 v150, v150, v175
    v_fma_f32 v149, v174, v174, v149
    v_fma_f32 v151, v175, v175, v151
    s_waitcnt lgkmcnt(6)
    v_mfma_f32_32x32x16_bf16 v[44:59], v[116:119], v[108:111], v[44:59]
    ds_read_b128 v[112:115], v15 offset:16384
    ds_read_b64_tr_b16 v[132:133], v19 offset:28672
    ds_read_b64_tr_b16 v[134:135], v19 offset:30464
    s_mov_b32 s56, 0x300
    s_add_u32 m0, s58, 0
    s_nop 0
    buffer_load_dwordx4 v5, s[20:23], s56 offen lds
    v_mfma_f32_16x16x32_bf16 v[152:155], v[116:119], v[168:171], v[152:155]
    v_lshlrev_b32 v172, 16, v108
    v_and_b32 v173, s60, v108
    v_add_f32 v148, v148, v172
    s_waitcnt lgkmcnt(7)
    v_mfma_f32_32x32x16_bf16 v[60:75], v[120:123], v[108:111], v[60:75]
    ds_read_b64_tr_b16 v[136:137], v19 offset:28800
    ds_read_b64_tr_b16 v[138:139], v19 offset:30592
    v_add_f32 v150, v150, v173
    v_fma_f32 v149, v172, v172, v149
    v_fma_f32 v151, v173, v173, v151
    s_waitcnt lgkmcnt(7)
    v_mfma_f32_32x32x16_bf16 v[76:91], v[124:127], v[108:111], v[76:91]
    ds_read_b64_tr_b16 v[140:141], v19 offset:28928
    ds_read_b64_tr_b16 v[142:143], v19 offset:30720
    v_lshlrev_b32 v174, 16, v109
    v_and_b32 v175, s60, v109
    v_add_f32 v148, v148, v174
    s_waitcnt lgkmcnt(7)
    v_mfma_f32_32x32x16_bf16 v[92:107], v[128:131], v[108:111], v[92:107]
    ds_read_b64_tr_b16 v[144:145], v19 offset:29056
    ds_read_b64_tr_b16 v[146:147], v19 offset:30848
    s_mov_b32 s56, 0x300
    s_add_u32 m0, s58, 0x400
    s_nop 0
    buffer_load_dwordx4 v6, s[20:23], s56 offen lds
    v_add_f32 v150, v150, v175
    v_fma_f32 v149, v174, v174, v149
    v_fma_f32 v151, v175, v175, v151
    s_waitcnt lgkmcnt(6)
    v_mfma_f32_32x32x16_bf16 v[44:59], v[132:135], v[112:115], v[44:59]
    ds_read_b128 v[108:111], v16 offset:16384
    ds_read_b64_tr_b16 v[116:117], v20 offset:28672
    ds_read_b64_tr_b16 v[118:119], v20 offset:30464
    v_lshlrev_b32 v172, 16, v112
    v_and_b32 v173, s60, v112
    v_add_f32 v148, v148, v172
    s_waitcnt lgkmcnt(7)
    v_mfma_f32_32x32x16_bf16 v[60:75], v[136:139], v[112:115], v[60:75]
    ds_read_b64_tr_b16 v[120:121], v20 offset:28800
    ds_read_b64_tr_b16 v[122:123], v20 offset:30592
    v_mfma_f32_16x16x32_bf16 v[156:159], v[136:139], v[168:171], v[156:159]
    v_add_f32 v150, v150, v173
    v_fma_f32 v149, v172, v172, v149
    v_fma_f32 v151, v173, v173, v151
    s_waitcnt lgkmcnt(7)
    v_mfma_f32_32x32x16_bf16 v[76:91], v[140:143], v[112:115], v[76:91]
    ds_read_b64_tr_b16 v[124:125], v20 offset:28928
    ds_read_b64_tr_b16 v[126:127], v20 offset:30720
    s_mov_b32 s57, 0x150000
    s_add_u32 m0, s59, 0
    s_nop 0
    buffer_load_dwordx4 v7, s[24:27], s57 offen lds
    v_lshlrev_b32 v174, 16, v113
    v_and_b32 v175, s60, v113
    v_add_f32 v148, v148, v174
    s_waitcnt lgkmcnt(7)
    v_mfma_f32_32x32x16_bf16 v[92:107], v[144:147], v[112:115], v[92:107]
    ds_read_b64_tr_b16 v[128:129], v20 offset:29056
    ds_read_b64_tr_b16 v[130:131], v20 offset:30848
    v_add_f32 v150, v150, v175
    v_fma_f32 v149, v174, v174, v149
    v_fma_f32 v151, v175, v175, v151
    s_waitcnt lgkmcnt(6)
    v_mfma_f32_32x32x16_bf16 v[44:59], v[116:119], v[108:111], v[44:59]
    ds_read_b128 v[112:115], v17 offset:16384
    ds_read_b64_tr_b16 v[132:133], v21 offset:28672
    ds_read_b64_tr_b16 v[134:135], v21 offset:30464
    v_lshlrev_b32 v172, 16, v108
    v_and_b32 v173, s60, v108
    v_add_f32 v148, v148, v172
    s_waitcnt lgkmcnt(7)
    v_mfma_f32_32x32x16_bf16 v[60:75], v[120:123], v[108:111], v[60:75]
    ds_read_b64_tr_b16 v[136:137], v21 offset:28800
    ds_read_b64_tr_b16 v[138:139], v21 offset:30592
    s_mov_b32 s57, 0x150000
    s_add_u32 m0, s59, 0x2000
    s_nop 0
    buffer_load_dwordx4 v8, s[24:27], s57 offen lds
    v_add_f32 v150, v150, v173
    v_fma_f32 v149, v172, v172, v149
    v_fma_f32 v151, v173, v173, v151
    s_waitcnt lgkmcnt(7)
    v_mfma_f32_32x32x16_bf16 v[76:91], v[124:127], v[108:111], v[76:91]
    ds_read_b64_tr_b16 v[140:141], v21 offset:28928
    ds_read_b64_tr_b16 v[142:143], v21 offset:30720
    v_mfma_f32_16x16x32_bf16 v[160:163], v[124:127], v[168:171], v[160:163]
    v_lshlrev_b32 v174, 16, v109
    v_and_b32 v175, s60, v109
    v_add_f32 v148, v148, v174
    s_waitcnt lgkmcnt(7)
    v_mfma_f32_32x32x16_bf16 v[92:107], v[128:131], v[108:111], v[92:107]
    ds_read_b64_tr_b16 v[144:145], v21 offset:29056
    ds_read_b64_tr_b16 v[146:147], v21 offset:30848
    s_mov_b32 s57, 0x150000
    s_add_u32 m0, s59, 0x4000
    s_nop 0
    buffer_load_dwordx4 v9, s[24:27], s57 offen lds
    v_add_f32 v150, v150, v175
    v_fma_f32 v149, v174, v174, v149
    v_fma_f32 v151, v175, v175, v151
    s_waitcnt lgkmcnt(6)
    v_mfma_f32_32x32x16_bf16 v[44:59], v[132:135], v[112:115], v[44:59]
    v_lshlrev_b32 v172, 16, v112
    v_and_b32 v173, s60, v112
    v_add_f32 v148, v148, v172
    s_waitcnt lgkmcnt(4)
    v_mfma_f32_32x32x16_bf16 v[60:75], v[136:139], v[112:115], v[60:75]
    s_waitcnt lgkmcnt(0)
    s_waitcnt vmcnt(5)
    s_barrier
    ds_read_b128 v[108:111], v14 offset:32768
    ds_read_b64_tr_b16 v[116:117], v22
    ds_read_b64_tr_b16 v[118:119], v22 offset:1792
    ds_read_b64_tr_b16 v[120:121], v22 offset:128
    ds_read_b64_tr_b16 v[122:123], v22 offset:1920
    ds_read_b64_tr_b16 v[124:125], v22 offset:256
    ds_read_b64_tr_b16 v[126:127], v22 offset:2048
    ds_read_b64_tr_b16 v[128:129], v22 offset:384
    ds_read_b64_tr_b16 v[130:131], v22 offset:2176
    v_add_f32 v150, v150, v173
    v_fma_f32 v149, v172, v172, v149
    v_fma_f32 v151, v173, v173, v151
    v_mfma_f32_32x32x16_bf16 v[76:91], v[140:143], v[112:115], v[76:91]
    v_lshlrev_b32 v174, 16, v113
    v_and_b32 v175, s60, v113
    v_add_f32 v148, v148, v174
    v_mfma_f32_32x32x16_bf16 v[92:107], v[144:147], v[112:115], v[92:107]
    v_mfma_f32_16x16x32_bf16 v[164:167], v[144:147], v[168:171], v[164:167]
    v_add_f32 v150, v150, v175
    v_fma_f32 v149, v174, v174, v149
    v_fma_f32 v151, v175, v175, v151
    s_waitcnt lgkmcnt(6)
    v_mfma_f32_32x32x16_bf16 v[44:59], v[116:119], v[108:111], v[44:59]
    ds_read_b128 v[112:115], v15 offset:32768
    ds_read_b64_tr_b16 v[132:133], v23
    ds_read_b64_tr_b16 v[134:135], v23 offset:1792
    s_mov_b32 s56, 0x380
    s_add_u32 m0, s58, 0x4000
    s_nop 0
    buffer_load_dwordx4 v5, s[20:23], s56 offen lds
    v_mfma_f32_16x16x32_bf16 v[152:155], v[116:119], v[168:171], v[152:155]
    v_lshlrev_b32 v172, 16, v108
    v_and_b32 v173, s60, v108
    v_add_f32 v148, v148, v172
    s_waitcnt lgkmcnt(7)
    v_mfma_f32_32x32x16_bf16 v[60:75], v[120:123], v[108:111], v[60:75]
    ds_read_b64_tr_b16 v[136:137], v23 offset:128
    ds_read_b64_tr_b16 v[138:139], v23 offset:1920
    v_add_f32 v150, v150, v173
    v_fma_f32 v149, v172, v172, v149
    v_fma_f32 v151, v173, v173, v151
    s_waitcnt lgkmcnt(7)
    v_mfma_f32_32x32x16_bf16 v[76:91], v[124:127], v[108:111], v[76:91]
    ds_read_b64_tr_b16 v[140:141], v23 offset:256
    ds_read_b64_tr_b16 v[142:143], v23 offset:2048
    v_lshlrev_b32 v174, 16, v109
    v_and_b32 v175, s60, v109
    v_add_f32 v148, v148, v174
    s_waitcnt lgkmcnt(7)
    v_mfma_f32_32x32x16_bf16 v[92:107], v[128:131], v[108:111], v[92:107]
    ds_read_b64_tr_b16 v[144:145], v23 offset:384
    ds_read_b64_tr_b16 v[146:147], v23 offset:2176
    s_mov_b32 s56, 0x380
    s_add_u32 m0, s58, 0x4400
    s_nop 0
    buffer_load_dwordx4 v6, s[20:23], s56 offen lds
    v_add_f32 v150, v150, v175
    v_fma_f32 v149, v174, v174, v149
    v_fma_f32 v151, v175, v175, v151
    s_waitcnt lgkmcnt(6)
    v_mfma_f32_32x32x16_bf16 v[44:59], v[132:135], v[112:115], v[44:59]
    ds_read_b128 v[108:111], v16 offset:32768
    ds_read_b64_tr_b16 v[116:117], v24
    ds_read_b64_tr_b16 v[118:119], v24 offset:1792
    v_lshlrev_b32 v172, 16, v112
    v_and_b32 v173, s60, v112
    v_add_f32 v148, v148, v172
    s_waitcnt lgkmcnt(7)
    v_mfma_f32_32x32x16_bf16 v[60:75], v[136:139], v[112:115], v[60:75]
    ds_read_b64_tr_b16 v[120:121], v24 offset:128
    ds_read_b64_tr_b16 v[122:123], v24 offset:1920
    v_mfma_f32_16x16x32_bf16 v[156:159], v[136:139], v[168:171], v[156:159]
    v_add_f32 v150, v150, v173
    v_fma_f32 v149, v172, v172, v149
    v_fma_f32 v151, v173, v173, v151
    s_waitcnt lgkmcnt(7)
    v_mfma_f32_32x32x16_bf16 v[76:91], v[140:143], v[112:115], v[76:91]
    ds_read_b64_tr_b16 v[124:125], v24 offset:256
    ds_read_b64_tr_b16 v[126:127], v24 offset:2048
    s_mov_b32 s57, 0x188000
    s_add_u32 m0, s59, 0x7000
    s_nop 0
    buffer_load_dwordx4 v7, s[24:27], s57 offen lds
    v_lshlrev_b32 v174, 16, v113
    v_and_b32 v175, s60, v113
    v_add_f32 v148, v148, v174
    s_waitcnt lgkmcnt(7)
    v_mfma_f32_32x32x16_bf16 v[92:107], v[144:147], v[112:115], v[92:107]
    ds_read_b64_tr_b16 v[128:129], v24 offset:384
    ds_read_b64_tr_b16 v[130:131], v24 offset:2176
    v_add_f32 v150, v150, v175
    v_fma_f32 v149, v174, v174, v149
    v_fma_f32 v151, v175, v175, v151
    s_waitcnt lgkmcnt(6)
    v_mfma_f32_32x32x16_bf16 v[44:59], v[116:119], v[108:111], v[44:59]
    ds_read_b128 v[112:115], v17 offset:32768
    ds_read_b64_tr_b16 v[132:133], v25
    ds_read_b64_tr_b16 v[134:135], v25 offset:1792
    v_lshlrev_b32 v172, 16, v108
    v_and_b32 v173, s60, v108
    v_add_f32 v148, v148, v172
    s_waitcnt lgkmcnt(7)
    v_mfma_f32_32x32x16_bf16 v[60:75], v[120:123], v[108:111], v[60:75]
    ds_read_b64_tr_b16 v[136:137], v25 offset:128
    ds_read_b64_tr_b16 v[138:139], v25 offset:1920
    s_mov_b32 s57, 0x188000
    s_add_u32 m0, s59, 0x9000
    s_nop 0
    buffer_load_dwordx4 v8, s[24:27], s57 offen lds
    v_add_f32 v150, v150, v173
    v_fma_f32 v149, v172, v172, v149
    v_fma_f32 v151, v173, v173, v151
    s_waitcnt lgkmcnt(7)
    v_mfma_f32_32x32x16_bf16 v[76:91], v[124:127], v[108:111], v[76:91]
    ds_read_b64_tr_b16 v[140:141], v25 offset:256
    ds_read_b64_tr_b16 v[142:143], v25 offset:2048
    v_mfma_f32_16x16x32_bf16 v[160:163], v[124:127], v[168:171], v[160:163]
    v_lshlrev_b32 v174, 16, v109
    v_and_b32 v175, s60, v109
    v_add_f32 v148, v148, v174
    s_waitcnt lgkmcnt(7)
    v_mfma_f32_32x32x16_bf16 v[92:107], v[128:131], v[108:111], v[92:107]
    ds_read_b64_tr_b16 v[144:145], v25 offset:384
    ds_read_b64_tr_b16 v[146:147], v25 offset:2176
    s_mov_b32 s57, 0x188000
    s_add_u32 m0, s59, 0xb000
    s_nop 0
    buffer_load_dwordx4 v9, s[24:27], s57 offen lds
    v_add_f32 v150, v150, v175
    v_fma_f32 v149, v174, v174, v149
    v_fma_f32 v151, v175, v175, v151
    s_waitcnt lgkmcnt(6)
    v_mfma_f32_32x32x16_bf16 v[44:59], v[132:135], v[112:115], v[44:59]
    v_lshlrev_b32 v172, 16, v112
    v_and_b32 v173, s60, v112
    v_add_f32 v148, v148, v172
    s_waitcnt lgkmcnt(4)
    v_mfma_f32_32x32x16_bf16 v[60:75], v[136:139], v[112:115], v[60:75]
    s_waitcnt lgkmcnt(0)
    s_waitcnt vmcnt(5)
    s_barrier
    ds_read_b128 v[108:111], v14
    ds_read_b64_tr_b16 v[116:117], v18
    ds_read_b64_tr_b16 v[118:119], v18 offset:1792
    ds_read_b64_tr_b16 v[120:121], v18 offset:128
    ds_read_b64_tr_b16 v[122:123], v18 offset:1920
    ds_read_b64_tr_b16 v[124:125], v18 offset:256
    ds_read_b64_tr_b16 v[126:127], v18 offset:2048
    ds_read_b64_tr_b16 v[128:129], v18 offset:384
    ds_read_b64_tr_b16 v[130:131], v18 offset:2176
    v_add_f32 v150, v150, v173
    v_fma_f32 v149, v172, v172, v149
    v_fma_f32 v151, v173, v173, v151
    v_mfma_f32_32x32x16_bf16 v[76:91], v[140:143], v[112:115], v[76:91]
    v_lshlrev_b32 v174, 16, v113
    v_and_b32 v175, s60, v113
    v_add_f32 v148, v148, v174
    v_mfma_f32_32x32x16_bf16 v[92:107], v[144:147], v[112:115], v[92:107]
    v_mfma_f32_16x16x32_bf16 v[164:167], v[144:147], v[168:171], v[164:167]
    v_add_f32 v150, v150, v175
    v_fma_f32 v149, v174, v174, v149
    v_fma_f32 v151, v175, v175, v151
    s_waitcnt lgkmcnt(6)
    v_mfma_f32_32x32x16_bf16 v[44:59], v[116:119], v[108:111], v[44:59]
    ds_read_b128 v[112:115], v15
    ds_read_b64_tr_b16 v[132:133], v19
    ds_read_b64_tr_b16 v[134:135], v19 offset:1792
    v_mfma_f32_16x16x32_bf16 v[152:155], v[116:119], v[168:171], v[152:155]
    v_lshlrev_b32 v172, 16, v108
    v_and_b32 v173, s60, v108
    v_add_f32 v148, v148, v172
    s_waitcnt lgkmcnt(7)
    v_mfma_f32_32x32x16_bf16 v[60:75], v[120:123], v[108:111], v[60:75]
    ds_read_b64_tr_b16 v[136:137], v19 offset:128
    ds_read_b64_tr_b16 v[138:139], v19 offset:1920
    v_add_f32 v150, v150, v173
    v_fma_f32 v149, v172, v172, v149
    v_fma_f32 v151, v173, v173, v151
    s_waitcnt lgkmcnt(7)
    v_mfma_f32_32x32x16_bf16 v[76:91], v[124:127], v[108:111], v[76:91]
    ds_read_b64_tr_b16 v[140:141], v19 offset:256
    ds_read_b64_tr_b16 v[142:143], v19 offset:2048
    v_lshlrev_b32 v174, 16, v109
    v_and_b32 v175, s60, v109
    v_add_f32 v148, v148, v174
    s_waitcnt lgkmcnt(7)
    v_mfma_f32_32x32x16_bf16 v[92:107], v[128:131], v[108:111], v[92:107]
    ds_read_b64_tr_b16 v[144:145], v19 offset:384
    ds_read_b64_tr_b16 v[146:147], v19 offset:2176
    v_add_f32 v150, v150, v175
    v_fma_f32 v149, v174, v174, v149
    v_fma_f32 v151, v175, v175, v151
    s_waitcnt lgkmcnt(6)
    v_mfma_f32_32x32x16_bf16 v[44:59], v[132:135], v[112:115], v[44:59]
    ds_read_b128 v[108:111], v16
    ds_read_b64_tr_b16 v[116:117], v20
    ds_read_b64_tr_b16 v[118:119], v20 offset:1792
    v_lshlrev_b32 v172, 16, v112
    v_and_b32 v173, s60, v112
    v_add_f32 v148, v148, v172
    s_waitcnt lgkmcnt(7)
    v_mfma_f32_32x32x16_bf16 v[60:75], v[136:139], v[112:115], v[60:75]
    ds_read_b64_tr_b16 v[120:121], v20 offset:128
    ds_read_b64_tr_b16 v[122:123], v20 offset:1920
    v_mfma_f32_16x16x32_bf16 v[156:159], v[136:139], v[168:171], v[156:159]
    v_add_f32 v150, v150, v173
    v_fma_f32 v149, v172, v172, v149
    v_fma_f32 v151, v173, v173, v151
    s_waitcnt lgkmcnt(7)
    v_mfma_f32_32x32x16_bf16 v[76:91], v[140:143], v[112:115], v[76:91]
    ds_read_b64_tr_b16 v[124:125], v20 offset:256
    ds_read_b64_tr_b16 v[126:127], v20 offset:2048
    v_lshlrev_b32 v174, 16, v113
    v_and_b32 v175, s60, v113
    v_add_f32 v148, v148, v174
    s_waitcnt lgkmcnt(7)
    v_mfma_f32_32x32x16_bf16 v[92:107], v[144:147], v[112:115], v[92:107]
    ds_read_b64_tr_b16 v[128:129], v20 offset:384
    ds_read_b64_tr_b16 v[130:131], v20 offset:2176
    v_add_f32 v150, v150, v175
    v_fma_f32 v149, v174, v174, v149
    v_fma_f32 v151, v175, v175, v151
    s_waitcnt lgkmcnt(6)
    v_mfma_f32_32x32x16_bf16 v[44:59], v[116:119], v[108:111], v[44:59]
    ds_read_b128 v[112:115], v17
    ds_read_b64_tr_b16 v[132:133], v21
    ds_read_b64_tr_b16 v[134:135], v21 offset:1792
    v_lshlrev_b32 v172, 16, v108
    v_and_b32 v173, s60, v108
    v_add_f32 v148, v148, v172
    s_waitcnt lgkmcnt(7)
    v_mfma_f32_32x32x16_bf16 v[60:75], v[120:123], v[108:111], v[60:75]
    ds_read_b64_tr_b16 v[136:137], v21 offset:128
    ds_read_b64_tr_b16 v[138:139], v21 offset:1920
    v_add_f32 v150, v150, v173
    v_fma_f32 v149, v172, v172, v149
    v_fma_f32 v151, v173, v173, v151
    s_waitcnt lgkmcnt(7)
    v_mfma_f32_32x32x16_bf16 v[76:91], v[124:127], v[108:111], v[76:91]
    ds_read_b64_tr_b16 v[140:141], v21 offset:256
    ds_read_b64_tr_b16 v[142:143], v21 offset:2048
    v_mfma_f32_16x16x32_bf16 v[160:163], v[124:127], v[168:171], v[160:163]
    v_lshlrev_b32 v174, 16, v109
    v_and_b32 v175, s60, v109
    v_add_f32 v148, v148, v174
    s_waitcnt lgkmcnt(7)
    v_mfma_f32_32x32x16_bf16 v[92:107], v[128:131], v[108:111], v[92:107]
    ds_read_b64_tr_b16 v[144:145], v21 offset:384
    ds_read_b64_tr_b16 v[146:147], v21 offset:2176
    v_add_f32 v150, v150, v175
    v_fma_f32 v149, v174, v174, v149
    v_fma_f32 v151, v175, v175, v151
    s_waitcnt lgkmcnt(6)
    v_mfma_f32_32x32x16_bf16 v[44:59], v[132:135], v[112:115], v[44:59]
    v_lshlrev_b32 v172, 16, v112
    v_and_b32 v173, s60, v112
    v_add_f32 v148, v148, v172
    s_waitcnt lgkmcnt(4)
    v_mfma_f32_32x32x16_bf16 v[60:75], v[136:139], v[112:115], v[60:75]
    s_waitcnt lgkmcnt(0)
    s_waitcnt vmcnt(0)
    s_barrier
    ds_read_b128 v[108:111], v14 offset:16384
    ds_read_b64_tr_b16 v[116:117], v18 offset:28672
    ds_read_b64_tr_b16 v[118:119], v18 offset:30464
    ds_read_b64_tr_b16 v[120:121], v18 offset:28800
    ds_read_b64_tr_b16 v[122:123], v18 offset:30592
    ds_read_b64_tr_b16 v[124:125], v18 offset:28928
    ds_read_b64_tr_b16 v[126:127], v18 offset:30720
    ds_read_b64_tr_b16 v[128:129], v18 offset:29056
    ds_read_b64_tr_b16 v[130:131], v18 offset:30848
    v_add_f32 v150, v150, v173
    v_fma_f32 v149, v172, v172, v149
    v_fma_f32 v151, v173, v173, v151
    v_mfma_f32_32x32x16_bf16 v[76:91], v[140:143], v[112:115], v[76:91]
    v_lshlrev_b32 v174, 16, v113
    v_and_b32 v175, s60, v113
    v_add_f32 v148, v148, v174
    v_mfma_f32_32x32x16_bf16 v[92:107], v[144:147], v[112:115], v[92:107]
    v_mfma_f32_16x16x32_bf16 v[164:167], v[144:147], v[168:171], v[164:167]
    v_add_f32 v150, v150, v175
    v_fma_f32 v149, v174, v174, v149
    v_fma_f32 v151, v175, v175, v151
    s_waitcnt lgkmcnt(6)
    v_mfma_f32_32x32x16_bf16 v[44:59], v[116:119], v[108:111], v[44:59]
    ds_read_b128 v[112:115], v15 offset:16384
    ds_read_b64_tr_b16 v[132:133], v19 offset:28672
    ds_read_b64_tr_b16 v[134:135], v19 offset:30464
    v_mfma_f32_16x16x32_bf16 v[152:155], v[116:119], v[168:171], v[152:155]
    v_lshlrev_b32 v172, 16, v108
    v_and_b32 v173, s60, v108
    v_add_f32 v148, v148, v172
    s_waitcnt lgkmcnt(7)
    v_mfma_f32_32x32x16_bf16 v[60:75], v[120:123], v[108:111], v[60:75]
    ds_read_b64_tr_b16 v[136:137], v19 offset:28800
    ds_read_b64_tr_b16 v[138:139], v19 offset:30592
    v_add_f32 v150, v150, v173
    v_fma_f32 v149, v172, v172, v149
    v_fma_f32 v151, v173, v173, v151
    s_waitcnt lgkmcnt(7)
    v_mfma_f32_32x32x16_bf16 v[76:91], v[124:127], v[108:111], v[76:91]
    ds_read_b64_tr_b16 v[140:141], v19 offset:28928
    ds_read_b64_tr_b16 v[142:143], v19 offset:30720
    v_lshlrev_b32 v174, 16, v109
    v_and_b32 v175, s60, v109
    v_add_f32 v148, v148, v174
    s_waitcnt lgkmcnt(7)
    v_mfma_f32_32x32x16_bf16 v[92:107], v[128:131], v[108:111], v[92:107]
    ds_read_b64_tr_b16 v[144:145], v19 offset:29056
    ds_read_b64_tr_b16 v[146:147], v19 offset:30848
    v_add_f32 v150, v150, v175
    v_fma_f32 v149, v174, v174, v149
    v_fma_f32 v151, v175, v175, v151
    s_waitcnt lgkmcnt(6)
    v_mfma_f32_32x32x16_bf16 v[44:59], v[132:135], v[112:115], v[44:59]
    ds_read_b128 v[108:111], v16 offset:16384
    ds_read_b64_tr_b16 v[116:117], v20 offset:28672
    ds_read_b64_tr_b16 v[118:119], v20 offset:30464
    v_lshlrev_b32 v172, 16, v112
    v_and_b32 v173, s60, v112
    v_add_f32 v148, v148, v172
    s_waitcnt lgkmcnt(7)
    v_mfma_f32_32x32x16_bf16 v[60:75], v[136:139], v[112:115], v[60:75]
    ds_read_b64_tr_b16 v[120:121], v20 offset:28800
    ds_read_b64_tr_b16 v[122:123], v20 offset:30592
    v_mfma_f32_16x16x32_bf16 v[156:159], v[136:139], v[168:171], v[156:159]
    v_add_f32 v150, v150, v173
    v_fma_f32 v149, v172, v172, v149
    v_fma_f32 v151, v173, v173, v151
    s_waitcnt lgkmcnt(7)
    v_mfma_f32_32x32x16_bf16 v[76:91], v[140:143], v[112:115], v[76:91]
    ds_read_b64_tr_b16 v[124:125], v20 offset:28928
    ds_read_b64_tr_b16 v[126:127], v20 offset:30720
    v_lshlrev_b32 v174, 16, v113
    v_and_b32 v175, s60, v113
    v_add_f32 v148, v148, v174
    s_waitcnt lgkmcnt(7)
    v_mfma_f32_32x32x16_bf16 v[92:107], v[144:147], v[112:115], v[92:107]
    ds_read_b64_tr_b16 v[128:129], v20 offset:29056
    ds_read_b64_tr_b16 v[130:131], v20 offset:30848
    v_add_f32 v150, v150, v175
    v_fma_f32 v149, v174, v174, v149
    v_fma_f32 v151, v175, v175, v151
    s_waitcnt lgkmcnt(6)
    v_mfma_f32_32x32x16_bf16 v[44:59], v[116:119], v[108:111], v[44:59]
    ds_read_b128 v[112:115], v17 offset:16384
    ds_read_b64_tr_b16 v[132:133], v21 offset:28672
    ds_read_b64_tr_b16 v[134:135], v21 offset:30464
    v_lshlrev_b32 v172, 16, v108
    v_and_b32 v173, s60, v108
    v_add_f32 v148, v148, v172
    s_waitcnt lgkmcnt(7)
    v_mfma_f32_32x32x16_bf16 v[60:75], v[120:123], v[108:111], v[60:75]
    ds_read_b64_tr_b16 v[136:137], v21 offset:28800
    ds_read_b64_tr_b16 v[138:139], v21 offset:30592
    v_add_f32 v150, v150, v173
    v_fma_f32 v149, v172, v172, v149
    v_fma_f32 v151, v173, v173, v151
    s_waitcnt lgkmcnt(7)
    v_mfma_f32_32x32x16_bf16 v[76:91], v[124:127], v[108:111], v[76:91]
    ds_read_b64_tr_b16 v[140:141], v21 offset:28928
    ds_read_b64_tr_b16 v[142:143], v21 offset:30720
    v_mfma_f32_16x16x32_bf16 v[160:163], v[124:127], v[168:171], v[160:163]
    v_lshlrev_b32 v174, 16, v109
    v_and_b32 v175, s60, v109
    v_add_f32 v148, v148, v174
    s_waitcnt lgkmcnt(7)
    v_mfma_f32_32x32x16_bf16 v[92:107], v[128:131], v[108:111], v[92:107]
    ds_read_b64_tr_b16 v[144:145], v21 offset:29056
    ds_read_b64_tr_b16 v[146:147], v21 offset:30848
    v_add_f32 v150, v150, v175
    v_fma_f32 v149, v174, v174, v149
    v_fma_f32 v151, v175, v175, v151
    s_waitcnt lgkmcnt(6)
    v_mfma_f32_32x32x16_bf16 v[44:59], v[132:135], v[112:115], v[44:59]
    v_lshlrev_b32 v172, 16, v112
    v_and_b32 v173, s60, v112
    v_add_f32 v148, v148, v172
    s_waitcnt lgkmcnt(4)
    v_mfma_f32_32x32x16_bf16 v[60:75], v[136:139], v[112:115], v[60:75]
    v_add_f32 v150, v150, v173
    v_fma_f32 v149, v172, v172, v149
    v_fma_f32 v151, v173, v173, v151
    s_waitcnt lgkmcnt(2)
    v_mfma_f32_32x32x16_bf16 v[76:91], v[140:143], v[112:115], v[76:91]
    v_lshlrev_b32 v174, 16, v113
    v_and_b32 v175, s60, v113
    v_add_f32 v148, v148, v174
    s_waitcnt lgkmcnt(0)
    v_mfma_f32_32x32x16_bf16 v[92:107], v[144:147], v[112:115], v[92:107]
    v_mfma_f32_16x16x32_bf16 v[164:167], v[144:147], v[168:171], v[164:167]
    v_add_f32 v150, v150, v175
    v_fma_f32 v149, v174, v174, v149
    v_fma_f32 v151, v175, v175, v151
    v_and_b32 v10, 31, v1
    v_lshrrev_b32 v12, 5, v1
    s_lshl_b32 s52, s45, 5
    v_add_u32 v11, s52, v10
    v_lshlrev_b32 v182, 5, v11
    v_add_u32 v182, 0x21000, v182
    v_lshl_add_u32 v180, v12, 3, v182
    v_lshlrev_b32 v183, 2, v10
    v_add_u32 v183, 0x22000, v183
    v_and_b32 v11, 1, v1
    v_lshlrev_b32 v11, 6, v11
    v_lshrrev_b32 v12, 4, v1
    v_lshl_add_u32 v181, v12, 4, v11
    s_lshl_b32 s52, s45, 7
    s_add_u32 s52, s52, 0x22000
    v_add_u32 v181, s52, v181
    v_add_f32 v148, v148, v150
    v_add_f32 v149, v149, v151
    ds_write_b64 v180, v[148:149]
    s_mov_b32 exec_lo, 0x30003
    s_mov_b32 exec_hi, 0x30003
    ds_write_b128 v181, v[152:155]
    ds_write_b128 v181, v[156:159] offset:1024
    ds_write_b128 v181, v[160:163] offset:2048
    ds_write_b128 v181, v[164:167] offset:3072
    s_mov_b64 exec, -1
    s_waitcnt lgkmcnt(0)
    s_barrier
    ds_read_b128 v[184:187], v182
    ds_read_b128 v[188:191], v182 offset:16
    ds_read_b32 v200, v183
    ds_read_b32 v201, v183 offset:128
    ds_read_b32 v202, v183 offset:256
    ds_read_b32 v203, v183 offset:384
    ds_read_b32 v204, v183 offset:1024
    ds_read_b32 v205, v183 offset:1152
    ds_read_b32 v206, v183 offset:1280
    ds_read_b32 v207, v183 offset:1408
    ds_read_b32 v208, v183 offset:2048
    ds_read_b32 v209, v183 offset:2176
    ds_read_b32 v210, v183 offset:2304
    ds_read_b32 v211, v183 offset:2432
    ds_read_b32 v212, v183 offset:3072
    ds_read_b32 v213, v183 offset:3200
    ds_read_b32 v214, v183 offset:3328
    ds_read_b32 v215, v183 offset:3456
    s_waitcnt lgkmcnt(15)
    v_add_f32 v184, v184, v186
    v_add_f32 v185, v185, v187
    v_add_f32 v188, v188, v190
    v_add_f32 v189, v189, v191
    v_add_f32 v184, v184, v188
    v_add_f32 v185, v185, v189
    v_mul_f32 v219, 0x3b000000, v184
    v_mul_f32 v217, 0x3b000000, v185
    v_fma_f32 v217, -v219, v219, v217
    v_cvt_pk_bf16_f32 v108, -v219, -v219
    v_cmp_gt_u32 vcc, 32, v1
    v_mov_b32 v110, 0
    v_mov_b32 v111, 0
    v_cndmask_b32 v108, v110, v108, vcc
    v_and_b32 v109, 0xffff, v108
    v_cvt_pk_bf16_f32 v217, v217, v217
    v_lshlrev_b32 v217, 16, v217
    v_add_f32 v217, 0x3727c5ac, v217
    v_cvt_pk_bf16_f32 v217, v217, v217
    v_lshlrev_b32 v217, 16, v217
    v_sqrt_f32 v217, v217
    s_nop 0
    v_cvt_pk_bf16_f32 v217, v217, v217
    v_lshlrev_b32 v217, 16, v217
    v_rcp_f32 v218, v217
    s_mov_b32 s55, 0x7060302
    s_waitcnt lgkmcnt(14)
    v_add_f32 v200, v200, v201
    s_waitcnt lgkmcnt(12)
    v_add_f32 v202, v202, v203
    v_add_f32 v200, v200, v202
    v_and_b32 v201, s60, v200
    v_sub_f32 v201, v200, v201
    v_and_b32 v202, s60, v201
    v_sub_f32 v202, v201, v202
    v_perm_b32 v116, v201, v200, s55
    v_lshrrev_b32 v117, 16, v202
    v_mov_b32 v118, 0
    v_mov_b32 v119, 0
    s_nop 1
    v_mfma_f32_32x32x16_bf16 v[44:59], v[116:119], v[108:111], v[44:59]
    s_waitcnt lgkmcnt(10)
    v_add_f32 v204, v204, v205
    s_waitcnt lgkmcnt(8)
    v_add_f32 v206, v206, v207
    v_add_f32 v204, v204, v206
    v_and_b32 v205, s60, v204
    v_sub_f32 v205, v204, v205
    v_and_b32 v206, s60, v205
    v_sub_f32 v206, v205, v206
    v_perm_b32 v120, v205, v204, s55
    v_lshrrev_b32 v121, 16, v206
    v_mov_b32 v122, 0
    v_mov_b32 v123, 0
    s_nop 1
    v_mfma_f32_32x32x16_bf16 v[60:75], v[120:123], v[108:111], v[60:75]
    s_waitcnt lgkmcnt(6)
    v_add_f32 v208, v208, v209
    s_waitcnt lgkmcnt(4)
    v_add_f32 v210, v210, v211
    v_add_f32 v208, v208, v210
    v_and_b32 v209, s60, v208
    v_sub_f32 v209, v208, v209
    v_and_b32 v210, s60, v209
    v_sub_f32 v210, v209, v210
    v_perm_b32 v124, v209, v208, s55
    v_lshrrev_b32 v125, 16, v210
    v_mov_b32 v126, 0
    v_mov_b32 v127, 0
    s_nop 1
    v_mfma_f32_32x32x16_bf16 v[76:91], v[124:127], v[108:111], v[76:91]
    s_waitcnt lgkmcnt(2)
    v_add_f32 v212, v212, v213
    s_waitcnt lgkmcnt(0)
    v_add_f32 v214, v214, v215
    v_add_f32 v212, v212, v214
    v_and_b32 v213, s60, v212
    v_sub_f32 v213, v212, v213
    v_and_b32 v214, s60, v213
    v_sub_f32 v214, v213, v214
    v_perm_b32 v128, v213, v212, s55
    v_lshrrev_b32 v129, 16, v214
    v_mov_b32 v130, 0
    v_mov_b32 v131, 0
    s_nop 1
    v_mfma_f32_32x32x16_bf16 v[92:107], v[128:131], v[108:111], v[92:107]
    v_mul_f32 v216, 0xbfb8aa3b, v218
    s_lshl_b32 s52, s47, 2
    s_add_u32 s52, s52, s45
    s_mul_i32 s52, s52, 0x70
    s_mul_i32 s53, s48, 14
    s_add_u32 s52, s52, s53
    s_add_u32 s52, s52, 0
    s_lshl_b32 s68, s52, 10
    s_mov_b32 s54, 0xbfb8aa3b
    v_mov_b32 v236, 0x30800000
    v_mov_b32 v237, 0x30800000
    v_mul_f32 v217, 0x4e800000, v217
    v_pk_mul_f32 v[220:221], v[216:217], v[44:45] op_sel_hi:[0,1]
    v_pk_mul_f32 v[222:223], v[216:217], v[46:47] op_sel_hi:[0,1]
    v_pk_mul_f32 v[224:225], v[216:217], v[48:49] op_sel_hi:[0,1]
    v_pk_mul_f32 v[226:227], v[216:217], v[50:51] op_sel_hi:[0,1]
    v_exp_f32 v220, v220
    v_exp_f32 v221, v221
    v_exp_f32 v222, v222
    v_exp_f32 v223, v223
    v_exp_f32 v224, v224
    v_exp_f32 v225, v225
    v_exp_f32 v226, v226
    v_exp_f32 v227, v227
    v_pk_fma_f32 v[220:221], v[220:221], v[236:237], v[236:237] clamp
    v_pk_fma_f32 v[222:223], v[222:223], v[236:237], v[236:237] clamp
    v_pk_fma_f32 v[224:225], v[224:225], v[236:237], v[236:237] clamp
    v_pk_fma_f32 v[226:227], v[226:227], v[236:237], v[236:237] clamp
    v_pk_mul_f32 v[238:239], v[220:221], v[222:223]
    v_pk_mul_f32 v[240:241], v[224:225], v[226:227]
    v_mul_f32 v242, v238, v239
    v_mul_f32 v244, v240, v241
    v_mul_f32 v242, v242, v217
    v_mul_f32 v244, v244, v217
    v_rcp_f32 v242, v242
    v_rcp_f32 v244, v244
    v_pk_mul_f32 v[44:45], v[44:45], v[222:223]
    v_pk_mul_f32 v[46:47], v[46:47], v[220:221]
    v_pk_mul_f32 v[48:49], v[48:49], v[226:227]
    v_pk_mul_f32 v[50:51], v[50:51], v[224:225]
    v_pk_mul_f32 v[238:239], v[238:239], v[242:243] op_sel:[1,0] op_sel_hi:[0,0]
    v_pk_mul_f32 v[240:241], v[240:241], v[244:245] op_sel:[1,0] op_sel_hi:[0,0]
    v_pk_mul_f32 v[44:45], v[44:45], v[238:239]
    v_pk_mul_f32 v[46:47], v[46:47], v[238:239]
    v_pk_mul_f32 v[48:49], v[48:49], v[240:241]
    v_pk_mul_f32 v[50:51], v[50:51], v[240:241]
    v_cvt_pk_bf16_f32 v228, v44, v45
    v_cvt_pk_bf16_f32 v229, v46, v47
    v_cvt_pk_bf16_f32 v230, v48, v49
    v_cvt_pk_bf16_f32 v231, v50, v51
    buffer_store_dwordx4 v[228:231], v28, s[28:31], s68 offen sc0 sc1
    v_pk_mul_f32 v[220:221], v[216:217], v[52:53] op_sel_hi:[0,1]
    v_pk_mul_f32 v[222:223], v[216:217], v[54:55] op_sel_hi:[0,1]
    v_pk_mul_f32 v[224:225], v[216:217], v[56:57] op_sel_hi:[0,1]
    v_pk_mul_f32 v[226:227], v[216:217], v[58:59] op_sel_hi:[0,1]
    v_exp_f32 v220, v220
    v_exp_f32 v221, v221
    v_exp_f32 v222, v222
    v_exp_f32 v223, v223
    v_exp_f32 v224, v224
    v_exp_f32 v225, v225
    v_exp_f32 v226, v226
    v_exp_f32 v227, v227
    v_pk_fma_f32 v[220:221], v[220:221], v[236:237], v[236:237] clamp
    v_pk_fma_f32 v[222:223], v[222:223], v[236:237], v[236:237] clamp
    v_pk_fma_f32 v[224:225], v[224:225], v[236:237], v[236:237] clamp
    v_pk_fma_f32 v[226:227], v[226:227], v[236:237], v[236:237] clamp
    v_pk_mul_f32 v[238:239], v[220:221], v[222:223]
    v_pk_mul_f32 v[240:241], v[224:225], v[226:227]
    v_mul_f32 v242, v238, v239
    v_mul_f32 v244, v240, v241
    v_mul_f32 v242, v242, v217
    v_mul_f32 v244, v244, v217
    v_rcp_f32 v242, v242
    v_rcp_f32 v244, v244
    v_pk_mul_f32 v[52:53], v[52:53], v[222:223]
    v_pk_mul_f32 v[54:55], v[54:55], v[220:221]
    v_pk_mul_f32 v[56:57], v[56:57], v[226:227]
    v_pk_mul_f32 v[58:59], v[58:59], v[224:225]
    v_pk_mul_f32 v[238:239], v[238:239], v[242:243] op_sel:[1,0] op_sel_hi:[0,0]
    v_pk_mul_f32 v[240:241], v[240:241], v[244:245] op_sel:[1,0] op_sel_hi:[0,0]
    v_pk_mul_f32 v[52:53], v[52:53], v[238:239]
    v_pk_mul_f32 v[54:55], v[54:55], v[238:239]
    v_pk_mul_f32 v[56:57], v[56:57], v[240:241]
    v_pk_mul_f32 v[58:59], v[58:59], v[240:241]
    v_cvt_pk_bf16_f32 v232, v52, v53
    v_cvt_pk_bf16_f32 v233, v54, v55
    v_cvt_pk_bf16_f32 v234, v56, v57
    v_cvt_pk_bf16_f32 v235, v58, v59
    buffer_store_dwordx4 v[232:235], v28, s[28:31], s68 offen offset:1024 sc0 sc1
    s_add_u32 s68, s68, 0x1000
    v_pk_mul_f32 v[220:221], v[216:217], v[60:61] op_sel_hi:[0,1]
    v_pk_mul_f32 v[222:223], v[216:217], v[62:63] op_sel_hi:[0,1]
    v_pk_mul_f32 v[224:225], v[216:217], v[64:65] op_sel_hi:[0,1]
    v_pk_mul_f32 v[226:227], v[216:217], v[66:67] op_sel_hi:[0,1]
    v_exp_f32 v220, v220
    v_exp_f32 v221, v221
    v_exp_f32 v222, v222
    v_exp_f32 v223, v223
    v_exp_f32 v224, v224
    v_exp_f32 v225, v225
    v_exp_f32 v226, v226
    v_exp_f32 v227, v227
    v_pk_fma_f32 v[220:221], v[220:221], v[236:237], v[236:237] clamp
    v_pk_fma_f32 v[222:223], v[222:223], v[236:237], v[236:237] clamp
    v_pk_fma_f32 v[224:225], v[224:225], v[236:237], v[236:237] clamp
    v_pk_fma_f32 v[226:227], v[226:227], v[236:237], v[236:237] clamp
    v_pk_mul_f32 v[238:239], v[220:221], v[222:223]
    v_pk_mul_f32 v[240:241], v[224:225], v[226:227]
    v_mul_f32 v242, v238, v239
    v_mul_f32 v244, v240, v241
    v_mul_f32 v242, v242, v217
    v_mul_f32 v244, v244, v217
    v_rcp_f32 v242, v242
    v_rcp_f32 v244, v244
    v_pk_mul_f32 v[60:61], v[60:61], v[222:223]
    v_pk_mul_f32 v[62:63], v[62:63], v[220:221]
    v_pk_mul_f32 v[64:65], v[64:65], v[226:227]
    v_pk_mul_f32 v[66:67], v[66:67], v[224:225]
    v_pk_mul_f32 v[238:239], v[238:239], v[242:243] op_sel:[1,0] op_sel_hi:[0,0]
    v_pk_mul_f32 v[240:241], v[240:241], v[244:245] op_sel:[1,0] op_sel_hi:[0,0]
    v_pk_mul_f32 v[60:61], v[60:61], v[238:239]
    v_pk_mul_f32 v[62:63], v[62:63], v[238:239]
    v_pk_mul_f32 v[64:65], v[64:65], v[240:241]
    v_pk_mul_f32 v[66:67], v[66:67], v[240:241]
    v_cvt_pk_bf16_f32 v228, v60, v61
    v_cvt_pk_bf16_f32 v229, v62, v63
    v_cvt_pk_bf16_f32 v230, v64, v65
    v_cvt_pk_bf16_f32 v231, v66, v67
    buffer_store_dwordx4 v[228:231], v28, s[28:31], s68 offen sc0 sc1
    v_pk_mul_f32 v[220:221], v[216:217], v[68:69] op_sel_hi:[0,1]
    v_pk_mul_f32 v[222:223], v[216:217], v[70:71] op_sel_hi:[0,1]
    v_pk_mul_f32 v[224:225], v[216:217], v[72:73] op_sel_hi:[0,1]
    v_pk_mul_f32 v[226:227], v[216:217], v[74:75] op_sel_hi:[0,1]
    v_exp_f32 v220, v220
    v_exp_f32 v221, v221
    v_exp_f32 v222, v222
    v_exp_f32 v223, v223
    v_exp_f32 v224, v224
    v_exp_f32 v225, v225
    v_exp_f32 v226, v226
    v_exp_f32 v227, v227
    v_pk_fma_f32 v[220:221], v[220:221], v[236:237], v[236:237] clamp
    v_pk_fma_f32 v[222:223], v[222:223], v[236:237], v[236:237] clamp
    v_pk_fma_f32 v[224:225], v[224:225], v[236:237], v[236:237] clamp
    v_pk_fma_f32 v[226:227], v[226:227], v[236:237], v[236:237] clamp
    v_pk_mul_f32 v[238:239], v[220:221], v[222:223]
    v_pk_mul_f32 v[240:241], v[224:225], v[226:227]
    v_mul_f32 v242, v238, v239
    v_mul_f32 v244, v240, v241
    v_mul_f32 v242, v242, v217
    v_mul_f32 v244, v244, v217
    v_rcp_f32 v242, v242
    v_rcp_f32 v244, v244
    v_pk_mul_f32 v[68:69], v[68:69], v[222:223]
    v_pk_mul_f32 v[70:71], v[70:71], v[220:221]
    v_pk_mul_f32 v[72:73], v[72:73], v[226:227]
    v_pk_mul_f32 v[74:75], v[74:75], v[224:225]
    v_pk_mul_f32 v[238:239], v[238:239], v[242:243] op_sel:[1,0] op_sel_hi:[0,0]
    v_pk_mul_f32 v[240:241], v[240:241], v[244:245] op_sel:[1,0] op_sel_hi:[0,0]
    v_pk_mul_f32 v[68:69], v[68:69], v[238:239]
    v_pk_mul_f32 v[70:71], v[70:71], v[238:239]
    v_pk_mul_f32 v[72:73], v[72:73], v[240:241]
    v_pk_mul_f32 v[74:75], v[74:75], v[240:241]
    v_cvt_pk_bf16_f32 v232, v68, v69
    v_cvt_pk_bf16_f32 v233, v70, v71
    v_cvt_pk_bf16_f32 v234, v72, v73
    v_cvt_pk_bf16_f32 v235, v74, v75
    buffer_store_dwordx4 v[232:235], v28, s[28:31], s68 offen offset:1024 sc0 sc1
    s_add_u32 s68, s68, 0x1000
    v_pk_mul_f32 v[220:221], v[216:217], v[76:77] op_sel_hi:[0,1]
    v_pk_mul_f32 v[222:223], v[216:217], v[78:79] op_sel_hi:[0,1]
    v_pk_mul_f32 v[224:225], v[216:217], v[80:81] op_sel_hi:[0,1]
    v_pk_mul_f32 v[226:227], v[216:217], v[82:83] op_sel_hi:[0,1]
    v_exp_f32 v220, v220
    v_exp_f32 v221, v221
    v_exp_f32 v222, v222
    v_exp_f32 v223, v223
    v_exp_f32 v224, v224
    v_exp_f32 v225, v225
    v_exp_f32 v226, v226
    v_exp_f32 v227, v227
    v_pk_fma_f32 v[220:221], v[220:221], v[236:237], v[236:237] clamp
    v_pk_fma_f32 v[222:223], v[222:223], v[236:237], v[236:237] clamp
    v_pk_fma_f32 v[224:225], v[224:225], v[236:237], v[236:237] clamp
    v_pk_fma_f32 v[226:227], v[226:227], v[236:237], v[236:237] clamp
    v_pk_mul_f32 v[238:239], v[220:221], v[222:223]
    v_pk_mul_f32 v[240:241], v[224:225], v[226:227]
    v_mul_f32 v242, v238, v239
    v_mul_f32 v244, v240, v241
    v_mul_f32 v242, v242, v217
    v_mul_f32 v244, v244, v217
    v_rcp_f32 v242, v242
    v_rcp_f32 v244, v244
    v_pk_mul_f32 v[76:77], v[76:77], v[222:223]
    v_pk_mul_f32 v[78:79], v[78:79], v[220:221]
    v_pk_mul_f32 v[80:81], v[80:81], v[226:227]
    v_pk_mul_f32 v[82:83], v[82:83], v[224:225]
    v_pk_mul_f32 v[238:239], v[238:239], v[242:243] op_sel:[1,0] op_sel_hi:[0,0]
    v_pk_mul_f32 v[240:241], v[240:241], v[244:245] op_sel:[1,0] op_sel_hi:[0,0]
    v_pk_mul_f32 v[76:77], v[76:77], v[238:239]
    v_pk_mul_f32 v[78:79], v[78:79], v[238:239]
    v_pk_mul_f32 v[80:81], v[80:81], v[240:241]
    v_pk_mul_f32 v[82:83], v[82:83], v[240:241]
    v_cvt_pk_bf16_f32 v228, v76, v77
    v_cvt_pk_bf16_f32 v229, v78, v79
    v_cvt_pk_bf16_f32 v230, v80, v81
    v_cvt_pk_bf16_f32 v231, v82, v83
    buffer_store_dwordx4 v[228:231], v28, s[28:31], s68 offen sc0 sc1
    v_pk_mul_f32 v[220:221], v[216:217], v[84:85] op_sel_hi:[0,1]
    v_pk_mul_f32 v[222:223], v[216:217], v[86:87] op_sel_hi:[0,1]
    v_pk_mul_f32 v[224:225], v[216:217], v[88:89] op_sel_hi:[0,1]
    v_pk_mul_f32 v[226:227], v[216:217], v[90:91] op_sel_hi:[0,1]
    v_exp_f32 v220, v220
    v_exp_f32 v221, v221
    v_exp_f32 v222, v222
    v_exp_f32 v223, v223
    v_exp_f32 v224, v224
    v_exp_f32 v225, v225
    v_exp_f32 v226, v226
    v_exp_f32 v227, v227
    v_pk_fma_f32 v[220:221], v[220:221], v[236:237], v[236:237] clamp
    v_pk_fma_f32 v[222:223], v[222:223], v[236:237], v[236:237] clamp
    v_pk_fma_f32 v[224:225], v[224:225], v[236:237], v[236:237] clamp
    v_pk_fma_f32 v[226:227], v[226:227], v[236:237], v[236:237] clamp
    v_pk_mul_f32 v[238:239], v[220:221], v[222:223]
    v_pk_mul_f32 v[240:241], v[224:225], v[226:227]
    v_mul_f32 v242, v238, v239
    v_mul_f32 v244, v240, v241
    v_mul_f32 v242, v242, v217
    v_mul_f32 v244, v244, v217
    v_rcp_f32 v242, v242
    v_rcp_f32 v244, v244
    v_pk_mul_f32 v[84:85], v[84:85], v[222:223]
    v_pk_mul_f32 v[86:87], v[86:87], v[220:221]
    v_pk_mul_f32 v[88:89], v[88:89], v[226:227]
    v_pk_mul_f32 v[90:91], v[90:91], v[224:225]
    v_pk_mul_f32 v[238:239], v[238:239], v[242:243] op_sel:[1,0] op_sel_hi:[0,0]
    v_pk_mul_f32 v[240:241], v[240:241], v[244:245] op_sel:[1,0] op_sel_hi:[0,0]
    v_pk_mul_f32 v[84:85], v[84:85], v[238:239]
    v_pk_mul_f32 v[86:87], v[86:87], v[238:239]
    v_pk_mul_f32 v[88:89], v[88:89], v[240:241]
    v_pk_mul_f32 v[90:91], v[90:91], v[240:241]
    v_cvt_pk_bf16_f32 v232, v84, v85
    v_cvt_pk_bf16_f32 v233, v86, v87
    v_cvt_pk_bf16_f32 v234, v88, v89
    v_cvt_pk_bf16_f32 v235, v90, v91
    buffer_store_dwordx4 v[232:235], v28, s[28:31], s68 offen offset:1024 sc0 sc1
    s_add_u32 s68, s68, 0x1000
    v_pk_mul_f32 v[220:221], v[216:217], v[92:93] op_sel_hi:[0,1]
    v_pk_mul_f32 v[222:223], v[216:217], v[94:95] op_sel_hi:[0,1]
    v_pk_mul_f32 v[224:225], v[216:217], v[96:97] op_sel_hi:[0,1]
    v_pk_mul_f32 v[226:227], v[216:217], v[98:99] op_sel_hi:[0,1]
    v_exp_f32 v220, v220
    v_exp_f32 v221, v221
    v_exp_f32 v222, v222
    v_exp_f32 v223, v223
    v_exp_f32 v224, v224
    v_exp_f32 v225, v225
    v_exp_f32 v226, v226
    v_exp_f32 v227, v227
    v_pk_fma_f32 v[220:221], v[220:221], v[236:237], v[236:237] clamp
    v_pk_fma_f32 v[222:223], v[222:223], v[236:237], v[236:237] clamp
    v_pk_fma_f32 v[224:225], v[224:225], v[236:237], v[236:237] clamp
    v_pk_fma_f32 v[226:227], v[226:227], v[236:237], v[236:237] clamp
    v_pk_mul_f32 v[238:239], v[220:221], v[222:223]
    v_pk_mul_f32 v[240:241], v[224:225], v[226:227]
    v_mul_f32 v242, v238, v239
    v_mul_f32 v244, v240, v241
    v_mul_f32 v242, v242, v217
    v_mul_f32 v244, v244, v217
    v_rcp_f32 v242, v242
    v_rcp_f32 v244, v244
    v_pk_mul_f32 v[92:93], v[92:93], v[222:223]
    v_pk_mul_f32 v[94:95], v[94:95], v[220:221]
    v_pk_mul_f32 v[96:97], v[96:97], v[226:227]
    v_pk_mul_f32 v[98:99], v[98:99], v[224:225]
    v_pk_mul_f32 v[238:239], v[238:239], v[242:243] op_sel:[1,0] op_sel_hi:[0,0]
    v_pk_mul_f32 v[240:241], v[240:241], v[244:245] op_sel:[1,0] op_sel_hi:[0,0]
    v_pk_mul_f32 v[92:93], v[92:93], v[238:239]
    v_pk_mul_f32 v[94:95], v[94:95], v[238:239]
    v_pk_mul_f32 v[96:97], v[96:97], v[240:241]
    v_pk_mul_f32 v[98:99], v[98:99], v[240:241]
    v_cvt_pk_bf16_f32 v228, v92, v93
    v_cvt_pk_bf16_f32 v229, v94, v95
    v_cvt_pk_bf16_f32 v230, v96, v97
    v_cvt_pk_bf16_f32 v231, v98, v99
    buffer_store_dwordx4 v[228:231], v28, s[28:31], s68 offen sc0 sc1
    v_pk_mul_f32 v[220:221], v[216:217], v[100:101] op_sel_hi:[0,1]
    v_pk_mul_f32 v[222:223], v[216:217], v[102:103] op_sel_hi:[0,1]
    v_pk_mul_f32 v[224:225], v[216:217], v[104:105] op_sel_hi:[0,1]
    v_pk_mul_f32 v[226:227], v[216:217], v[106:107] op_sel_hi:[0,1]
    v_exp_f32 v220, v220
    v_exp_f32 v221, v221
    v_exp_f32 v222, v222
    v_exp_f32 v223, v223
    v_exp_f32 v224, v224
    v_exp_f32 v225, v225
    v_exp_f32 v226, v226
    v_exp_f32 v227, v227
    v_pk_fma_f32 v[220:221], v[220:221], v[236:237], v[236:237] clamp
    v_pk_fma_f32 v[222:223], v[222:223], v[236:237], v[236:237] clamp
    v_pk_fma_f32 v[224:225], v[224:225], v[236:237], v[236:237] clamp
    v_pk_fma_f32 v[226:227], v[226:227], v[236:237], v[236:237] clamp
    v_pk_mul_f32 v[238:239], v[220:221], v[222:223]
    v_pk_mul_f32 v[240:241], v[224:225], v[226:227]
    v_mul_f32 v242, v238, v239
    v_mul_f32 v244, v240, v241
    v_mul_f32 v242, v242, v217
    v_mul_f32 v244, v244, v217
    v_rcp_f32 v242, v242
    v_rcp_f32 v244, v244
    v_pk_mul_f32 v[100:101], v[100:101], v[222:223]
    v_pk_mul_f32 v[102:103], v[102:103], v[220:221]
    v_pk_mul_f32 v[104:105], v[104:105], v[226:227]
    v_pk_mul_f32 v[106:107], v[106:107], v[224:225]
    v_pk_mul_f32 v[238:239], v[238:239], v[242:243] op_sel:[1,0] op_sel_hi:[0,0]
    v_pk_mul_f32 v[240:241], v[240:241], v[244:245] op_sel:[1,0] op_sel_hi:[0,0]
    v_pk_mul_f32 v[100:101], v[100:101], v[238:239]
    v_pk_mul_f32 v[102:103], v[102:103], v[238:239]
    v_pk_mul_f32 v[104:105], v[104:105], v[240:241]
    v_pk_mul_f32 v[106:107], v[106:107], v[240:241]
    v_cvt_pk_bf16_f32 v232, v100, v101
    v_cvt_pk_bf16_f32 v233, v102, v103
    v_cvt_pk_bf16_f32 v234, v104, v105
    v_cvt_pk_bf16_f32 v235, v106, v107
    buffer_store_dwordx4 v[232:235], v28, s[28:31], s68 offen offset:1024 sc0 sc1
    s_waitcnt vmcnt(0)
    s_endpgm
hh_k1_r3:
    v_lshrrev_b32 v11, 3, v1
    v_lshrrev_b32 v12, 4, v1
    v_and_b32 v13, 7, v1
    s_lshl_b32 s52, s44, 4
    v_add_u32 v14, s52, v11
    v_lshlrev_b32 v5, 10, v14
    v_xor_b32 v14, v13, v12
    v_lshl_add_u32 v5, v14, 4, v5
    v_add_u32 v14, s52, v11
    v_add_u32 v14, 8, v14
    v_lshlrev_b32 v6, 10, v14
    v_xor_b32 v14, v13, v12
    v_xor_b32 v14, 4, v14
    v_lshl_add_u32 v6, v14, 4, v6
    s_add_u32 s53, s44, 4
    s_and_b32 s53, s53, 7
    s_lshl_b32 s59, s53, 10
    s_add_u32 s59, s59, 0xc000
    s_lshl_b32 s58, s44, 11
    s_lshl_b32 s53, s53, 6
    v_add_u32 v11, s53, v1
    v_mul_u32_u24 v12, 0x925, v11
    v_lshrrev_b32 v12, 16, v12
    v_mul_u32_u24 v13, 28, v12
    v_sub_u32 v13, v11, v13
    v_mul_u32_u24 v7, 0xe00, v12
    v_lshl_add_u32 v7, v13, 4, v7
    v_add_u32 v11, s53, v1
    v_add_u32 v11, 0x200, v11
    v_mul_u32_u24 v12, 0x925, v11
    v_lshrrev_b32 v12, 16, v12
    v_mul_u32_u24 v13, 28, v12
    v_sub_u32 v13, v11, v13
    v_mul_u32_u24 v8, 0xe00, v12
    v_lshl_add_u32 v8, v13, 4, v8
    v_add_u32 v11, s53, v1
    v_add_u32 v11, 0x400, v11
    v_mul_u32_u24 v12, 0x925, v11
    v_lshrrev_b32 v12, 16, v12
    v_mul_u32_u24 v13, 28, v12
    v_sub_u32 v13, v11, v13
    v_mul_u32_u24 v9, 0xe00, v12
    v_lshl_add_u32 v9, v13, 4, v9
    v_add_u32 v11, s53, v1
    v_add_u32 v11, 0x600, v11
    v_mul_u32_u24 v12, 0x925, v11
    v_lshrrev_b32 v12, 16, v12
    v_mul_u32_u24 v13, 28, v12
    v_sub_u32 v13, v11, v13
    v_mul_u32_u24 v10, 0xe00, v12
    v_lshl_add_u32 v10, v13, 4, v10
    s_mov_b32 s56, 0
    s_mov_b32 s57, 0
    s_waitcnt lgkmcnt(0)
    s_lshl_b32 s52, s47, 17
    s_add_u32 s20, s4, s52
    s_addc_u32 s21, s5, 0
    s_mov_b32 s22, 0x20000
    s_mov_b32 s23, 0x20000
    s_mul_i32 s52, s48, 0x1c0
    s_add_u32 s24, s12, s52
    s_addc_u32 s25, s13, 0
    s_mov_b32 s26, 0x1bf3c0
    s_mov_b32 s27, 0x20000
    s_mov_b32 s28, s16
    s_mov_b32 s29, s17
    s_mov_b32 s30, 0x1600000
    s_mov_b32 s31, 0x20000
    s_mov_b32 s56, 0
    s_add_u32 m0, s58, 0
    s_nop 0
    buffer_load_dwordx4 v5, s[20:23], s56 offen lds
    s_mov_b32 s56, 0
    s_add_u32 m0, s58, 0x400
    s_nop 0
    buffer_load_dwordx4 v6, s[20:23], s56 offen lds
    s_mov_b32 s57, 0
    s_add_u32 m0, s59, 0
    s_nop 0
    buffer_load_dwordx4 v7, s[24:27], s57 offen lds
    s_mov_b32 s57, 0
    s_add_u32 m0, s59, 0x2000
    s_nop 0
    buffer_load_dwordx4 v8, s[24:27], s57 offen lds
    s_mov_b32 s57, 0
    s_add_u32 m0, s59, 0x4000
    s_nop 0
    buffer_load_dwordx4 v9, s[24:27], s57 offen lds
    s_mov_b32 s57, 0
    s_add_u32 m0, s59, 0x6000
    s_nop 0
    buffer_load_dwordx4 v10, s[24:27], s57 offen lds
    s_barrier
    v_and_b32 v11, 31, v1
    s_lshl_b32 s52, s45, 5
    v_add_u32 v11, s52, v11
    v_lshlrev_b32 v11, 7, v11
    v_lshrrev_b32 v12, 5, v1
    v_bfe_u32 v13, v1, 1, 3
    v_xor_b32 v12, v12, v13
    v_lshl_add_u32 v11, v12, 4, v11
    v_lshrrev_b32 v12, 5, v1
    v_bfe_u32 v13, v1, 2, 2
    v_lshl_add_u32 v12, v12, 3, v13
    v_mul_u32_u24 v12, 0x1c0, v12
    v_bfe_u32 v13, v1, 4, 1
    v_lshl_add_u32 v12, v13, 5, v12
    v_and_b32 v13, 3, v1
    v_lshl_add_u32 v12, v13, 3, v12
    v_add_u32 v12, 0xc040, v12
    s_add_u32 s52, s45, 2
    s_and_b32 s52, s52, 3
    s_lshl_b32 s53, s52, 5
    v_xor_b32 v15, s53, v11
    s_mul_i32 s53, s52, 0x1c00
    v_add_u32 v19, s53, v12
    v_add_u32 v23, 0xe000, v19
    s_add_u32 s52, s45, 3
    s_and_b32 s52, s52, 3
    s_lshl_b32 s53, s52, 5
    v_xor_b32 v16, s53, v11
    s_mul_i32 s53, s52, 0x1c00
    v_add_u32 v20, s53, v12
    v_add_u32 v24, 0xe000, v20
    s_add_u32 s52, s45, 4
    s_and_b32 s52, s52, 3
    s_lshl_b32 s53, s52, 5
    v_xor_b32 v17, s53, v11
    s_mul_i32 s53, s52, 0x1c00
    v_add_u32 v21, s53, v12
    v_add_u32 v25, 0xe000, v21
    s_add_u32 s52, s45, 5
    s_and_b32 s52, s52, 3
    s_lshl_b32 s53, s52, 5
    v_xor_b32 v18, s53, v11
    s_mul_i32 s53, s52, 0x1c00
    v_add_u32 v22, s53, v12
    v_add_u32 v26, 0xe000, v22
    s_mov_b32 s56, 0x80
    s_add_u32 m0, s58, 0x4000
    s_nop 0
    buffer_load_dwordx4 v5, s[20:23], s56 offen lds
    s_mov_b32 s56, 0x80
    s_add_u32 m0, s58, 0x4400
    s_nop 0
    buffer_load_dwordx4 v6, s[20:23], s56 offen lds
    s_mov_b32 s57, 0x38000
    s_add_u32 m0, s59, 0x7000
    s_nop 0
    buffer_load_dwordx4 v7, s[24:27], s57 offen lds
    s_mov_b32 s57, 0x38000
    s_add_u32 m0, s59, 0x9000
    s_nop 0
    buffer_load_dwordx4 v8, s[24:27], s57 offen lds
    s_mov_b32 s57, 0x38000
    s_add_u32 m0, s59, 0xb000
    s_nop 0
    buffer_load_dwordx4 v9, s[24:27], s57 offen lds
    s_mov_b32 s57, 0x38000
    s_add_u32 m0, s59, 0xd000
    s_nop 0
    buffer_load_dwordx4 v10, s[24:27], s57 offen lds
    v_lshrrev_b32 v12, 2, v1
    v_and_b32 v13, 3, v1
    v_lshlrev_b32 v13, 4, v13
    v_lshl_add_u32 v27, v12, 10, v13
    v_lshlrev_b32 v28, 4, v1
    s_and_b32 s55, s2, 0x7f
    s_lshl_b32 s55, s55, 1
    s_and_b32 s52, s45, 1
    s_add_u32 s55, s55, s52
    s_add_u32 s55, s55, 0x800
    s_lshr_b32 s52, s55, 4
    s_and_b32 s53, s55, 15
    s_mul_i32 s66, s53, 0x90
    s_add_u32 s66, s66, s52
    s_lshl_b32 s66, s66, 10
    s_add_u32 s66, s66, 0xb00000
    s_cmp_ge_u32 s52, 0x70
    s_cselect_b32 s32, s10, s14
    s_cselect_b32 s33, s11, s15
    s_mov_b32 s55, 0x1c0000
    s_cselect_b32 s34, 0x80000, s55
    s_mov_b32 s35, 0x20000
    s_cselect_b32 s54, 0x70, 0
    s_sub_u32 s54, s52, s54
    s_lshl_b32 s64, s54, 14
    s_lshl_b32 s53, s53, 6
    s_add_u32 s64, s64, s53
    s_cmp_lt_u32 s45, 2
    s_cselect_b32 s66, s66, 0x7fff0000
    s_cselect_b32 s64, s64, 0x7fff0000
    s_lshl_b32 s18, s44, 10
    s_add_u32 s18, s18, 0x21000
    v_lshrrev_b32 v12, 5, v1
    v_bfe_u32 v13, v1, 2, 2
    v_lshl_add_u32 v12, v12, 2, v13
    v_bfe_u32 v13, v1, 4, 1
    v_and_b32 v14, 3, v1
    v_lshl_add_u32 v40, v13, 2, v14
    v_lshlrev_b32 v40, 3, v40
    v_lshl_add_u32 v40, v12, 6, v40
    v_add_u32 v40, s18, v40
    v_lshrrev_b32 v12, 4, v1
    v_xor_b32 v12, v12, v1
    v_and_b32 v12, 1, v12
    v_cmp_eq_u32 vcc, 0, v12
    v_mov_b32 v12, 0
    v_mov_b32 v13, 0x3f803f80
    v_cndmask_b32 v140, v12, v13, vcc
    v_cndmask_b32 v141, v12, v13, vcc
    v_cndmask_b32 v142, v12, v13, vcc
    v_cndmask_b32 v143, v12, v13, vcc
    s_mov_b32 s60, 0xffff0000
    v_mov_b32 v124, 0
    v_mov_b32 v125, 0
    v_mov_b32 v126, 0
    v_mov_b32 v127, 0
    s_waitcnt vmcnt(6)
    s_barrier
    ds_read_b128 v[92:95], v15
    ds_read_b64_tr_b16 v[100:101], v19
    ds_read_b64_tr_b16 v[102:103], v19 offset:1792
    ds_read_b64_tr_b16 v[104:105], v19 offset:128
    ds_read_b64_tr_b16 v[106:107], v19 offset:1920
    ds_read_b64_tr_b16 v[108:109], v19 offset:256
    ds_read_b64_tr_b16 v[110:111], v19 offset:2048
    s_waitcnt lgkmcnt(4)
    v_mfma_f32_32x32x16_bf16 v[44:59], v[100:103], v[92:95], 0
    ds_read_b128 v[96:99], v16
    ds_read_b64_tr_b16 v[112:113], v20
    ds_read_b64_tr_b16 v[114:115], v20 offset:1792
    v_mfma_f32_16x16x32_bf16 v[128:131], v[100:103], v[140:143], 0
    v_lshlrev_b32 v144, 16, v94
    v_and_b32 v145, s60, v94
    v_add_f32 v124, v124, v144
    v_add_f32 v126, v126, v145
    s_waitcnt lgkmcnt(5)
    v_mfma_f32_32x32x16_bf16 v[60:75], v[104:107], v[92:95], 0
    ds_read_b64_tr_b16 v[116:117], v20 offset:128
    ds_read_b64_tr_b16 v[118:119], v20 offset:1920
    s_mov_b32 s56, 0x100
    s_add_u32 m0, s58, 0x8000
    s_nop 0
    buffer_load_dwordx4 v5, s[20:23], s56 offen lds
    v_fma_f32 v125, v144, v144, v125
    v_fma_f32 v127, v145, v145, v127
    v_lshlrev_b32 v146, 16, v95
    v_and_b32 v147, s60, v95
    s_waitcnt lgkmcnt(5)
    v_mfma_f32_32x32x16_bf16 v[76:91], v[108:111], v[92:95], 0
    ds_read_b64_tr_b16 v[120:121], v20 offset:256
    ds_read_b64_tr_b16 v[122:123], v20 offset:2048
    s_mov_b32 s56, 0x100
    s_add_u32 m0, s58, 0x8400
    s_nop 0
    buffer_load_dwordx4 v6, s[20:23], s56 offen lds
    v_add_f32 v124, v124, v146
    v_add_f32 v126, v126, v147
    v_fma_f32 v125, v146, v146, v125
    v_fma_f32 v127, v147, v147, v127
    s_waitcnt lgkmcnt(4)
    v_mfma_f32_32x32x16_bf16 v[44:59], v[112:115], v[96:99], v[44:59]
    ds_read_b128 v[92:95], v17
    ds_read_b64_tr_b16 v[100:101], v21
    ds_read_b64_tr_b16 v[102:103], v21 offset:1792
    v_lshlrev_b32 v144, 16, v98
    v_and_b32 v145, s60, v98
    v_add_f32 v124, v124, v144
    v_add_f32 v126, v126, v145
    s_waitcnt lgkmcnt(5)
    v_mfma_f32_32x32x16_bf16 v[60:75], v[116:119], v[96:99], v[60:75]
    ds_read_b64_tr_b16 v[104:105], v21 offset:128
    ds_read_b64_tr_b16 v[106:107], v21 offset:1920
    s_mov_b32 s57, 0x70000
    s_add_u32 m0, s59, 0xe000
    s_nop 0
    buffer_load_dwordx4 v7, s[24:27], s57 offen lds
    v_mfma_f32_16x16x32_bf16 v[132:135], v[116:119], v[140:143], 0
    v_fma_f32 v125, v144, v144, v125
    v_fma_f32 v127, v145, v145, v127
    v_lshlrev_b32 v146, 16, v99
    v_and_b32 v147, s60, v99
    s_waitcnt lgkmcnt(5)
    v_mfma_f32_32x32x16_bf16 v[76:91], v[120:123], v[96:99], v[76:91]
    ds_read_b64_tr_b16 v[108:109], v21 offset:256
    ds_read_b64_tr_b16 v[110:111], v21 offset:2048
    s_mov_b32 s57, 0x70000
    s_add_u32 m0, s59, 0x10000
    s_nop 0
    buffer_load_dwordx4 v8, s[24:27], s57 offen lds
    v_add_f32 v124, v124, v146
    v_add_f32 v126, v126, v147
    v_fma_f32 v125, v146, v146, v125
    v_fma_f32 v127, v147, v147, v127
    s_waitcnt lgkmcnt(4)
    v_mfma_f32_32x32x16_bf16 v[44:59], v[100:103], v[92:95], v[44:59]
    ds_read_b128 v[96:99], v18
    ds_read_b64_tr_b16 v[112:113], v22
    ds_read_b64_tr_b16 v[114:115], v22 offset:1792
    v_lshlrev_b32 v144, 16, v94
    v_and_b32 v145, s60, v94
    v_add_f32 v124, v124, v144
    v_add_f32 v126, v126, v145
    s_waitcnt lgkmcnt(5)
    v_mfma_f32_32x32x16_bf16 v[60:75], v[104:107], v[92:95], v[60:75]
    ds_read_b64_tr_b16 v[116:117], v22 offset:128
    ds_read_b64_tr_b16 v[118:119], v22 offset:1920
    s_mov_b32 s57, 0x70000
    s_add_u32 m0, s59, 0x12000
    s_nop 0
    buffer_load_dwordx4 v9, s[24:27], s57 offen lds
    v_fma_f32 v125, v144, v144, v125
    v_fma_f32 v127, v145, v145, v127
    v_lshlrev_b32 v146, 16, v95
    v_and_b32 v147, s60, v95
    s_waitcnt lgkmcnt(5)
    v_mfma_f32_32x32x16_bf16 v[76:91], v[108:111], v[92:95], v[76:91]
    ds_read_b64_tr_b16 v[120:121], v22 offset:256
    ds_read_b64_tr_b16 v[122:123], v22 offset:2048
    s_mov_b32 s57, 0x70000
    s_add_u32 m0, s59, 0x14000
    s_nop 0
    buffer_load_dwordx4 v10, s[24:27], s57 offen lds
    v_mfma_f32_16x16x32_bf16 v[136:139], v[108:111], v[140:143], 0
    v_add_f32 v124, v124, v146
    v_add_f32 v126, v126, v147
    v_fma_f32 v125, v146, v146, v125
    v_fma_f32 v127, v147, v147, v127
    s_waitcnt lgkmcnt(4)
    v_mfma_f32_32x32x16_bf16 v[44:59], v[112:115], v[96:99], v[44:59]
    v_lshlrev_b32 v144, 16, v98
    v_and_b32 v145, s60, v98
    v_add_f32 v124, v124, v144
    v_add_f32 v126, v126, v145
    s_waitcnt lgkmcnt(2)
    v_mfma_f32_32x32x16_bf16 v[60:75], v[116:119], v[96:99], v[60:75]
    s_waitcnt lgkmcnt(0)
    s_waitcnt vmcnt(6)
    s_barrier
    ds_read_b128 v[92:95], v15 offset:16384
    ds_read_b64_tr_b16 v[100:101], v19 offset:28672
    ds_read_b64_tr_b16 v[102:103], v19 offset:30464
    ds_read_b64_tr_b16 v[104:105], v19 offset:28800
    ds_read_b64_tr_b16 v[106:107], v19 offset:30592
    ds_read_b64_tr_b16 v[108:109], v19 offset:28928
    ds_read_b64_tr_b16 v[110:111], v19 offset:30720
    v_fma_f32 v125, v144, v144, v125
    v_fma_f32 v127, v145, v145, v127
    v_lshlrev_b32 v146, 16, v99
    v_and_b32 v147, s60, v99
    v_mfma_f32_32x32x16_bf16 v[76:91], v[120:123], v[96:99], v[76:91]
    v_add_f32 v124, v124, v146
    v_add_f32 v126, v126, v147
    v_fma_f32 v125, v146, v146, v125
    v_fma_f32 v127, v147, v147, v127
    s_waitcnt lgkmcnt(4)
    v_mfma_f32_32x32x16_bf16 v[44:59], v[100:103], v[92:95], v[44:59]
    ds_read_b128 v[96:99], v16 offset:16384
    ds_read_b64_tr_b16 v[112:113], v20 offset:28672
    ds_read_b64_tr_b16 v[114:115], v20 offset:30464
    s_mov_b32 s56, 0x180
    s_add_u32 m0, s58, 0
    s_nop 0
    buffer_load_dwordx4 v5, s[20:23], s56 offen lds
    v_mfma_f32_16x16x32_bf16 v[128:131], v[100:103], v[140:143], v[128:131]
    v_lshlrev_b32 v144, 16, v94
    v_and_b32 v145, s60, v94
    v_add_f32 v124, v124, v144
    v_add_f32 v126, v126, v145
    s_waitcnt lgkmcnt(5)
    v_mfma_f32_32x32x16_bf16 v[60:75], v[104:107], v[92:95], v[60:75]
    ds_read_b64_tr_b16 v[116:117], v20 offset:28800
    ds_read_b64_tr_b16 v[118:119], v20 offset:30592
    v_fma_f32 v125, v144, v144, v125
    v_fma_f32 v127, v145, v145, v127
    v_lshlrev_b32 v146, 16, v95
    v_and_b32 v147, s60, v95
    s_waitcnt lgkmcnt(5)
    v_mfma_f32_32x32x16_bf16 v[76:91], v[108:111], v[92:95], v[76:91]
    ds_read_b64_tr_b16 v[120:121], v20 offset:28928
    ds_read_b64_tr_b16 v[122:123], v20 offset:30720
    s_mov_b32 s56, 0x180
    s_add_u32 m0, s58, 0x400
    s_nop 0
    buffer_load_dwordx4 v6, s[20:23], s56 offen lds
    v_add_f32 v124, v124, v146
    v_add_f32 v126, v126, v147
    v_fma_f32 v125, v146, v146, v125
    v_fma_f32 v127, v147, v147, v127
    s_waitcnt lgkmcnt(4)
    v_mfma_f32_32x32x16_bf16 v[44:59], v[112:115], v[96:99], v[44:59]
    ds_read_b128 v[92:95], v17 offset:16384
    ds_read_b64_tr_b16 v[100:101], v21 offset:28672
    ds_read_b64_tr_b16 v[102:103], v21 offset:30464
    s_mov_b32 s57, 0xa8000
    s_add_u32 m0, s59, 0
    s_nop 0
    buffer_load_dwordx4 v7, s[24:27], s57 offen lds
    v_lshlrev_b32 v144, 16, v98
    v_and_b32 v145, s60, v98
    v_add_f32 v124, v124, v144
    v_add_f32 v126, v126, v145
    s_waitcnt lgkmcnt(5)
    v_mfma_f32_32x32x16_bf16 v[60:75], v[116:119], v[96:99], v[60:75]
    ds_read_b64_tr_b16 v[104:105], v21 offset:28800
    ds_read_b64_tr_b16 v[106:107], v21 offset:30592
    v_mfma_f32_16x16x32_bf16 v[132:135], v[116:119], v[140:143], v[132:135]
    v_fma_f32 v125, v144, v144, v125
    v_fma_f32 v127, v145, v145, v127
    v_lshlrev_b32 v146, 16, v99
    v_and_b32 v147, s60, v99
    s_waitcnt lgkmcnt(5)
    v_mfma_f32_32x32x16_bf16 v[76:91], v[120:123], v[96:99], v[76:91]
    ds_read_b64_tr_b16 v[108:109], v21 offset:28928
    ds_read_b64_tr_b16 v[110:111], v21 offset:30720
    s_mov_b32 s57, 0xa8000
    s_add_u32 m0, s59, 0x2000
    s_nop 0
    buffer_load_dwordx4 v8, s[24:27], s57 offen lds
    v_add_f32 v124, v124, v146
    v_add_f32 v126, v126, v147
    v_fma_f32 v125, v146, v146, v125
    v_fma_f32 v127, v147, v147, v127
    s_waitcnt lgkmcnt(4)
    v_mfma_f32_32x32x16_bf16 v[44:59], v[100:103], v[92:95], v[44:59]
    ds_read_b128 v[96:99], v18 offset:16384
    ds_read_b64_tr_b16 v[112:113], v22 offset:28672
    ds_read_b64_tr_b16 v[114:115], v22 offset:30464
    v_lshlrev_b32 v144, 16, v94
    v_and_b32 v145, s60, v94
    v_add_f32 v124, v124, v144
    v_add_f32 v126, v126, v145
    s_waitcnt lgkmcnt(5)
    v_mfma_f32_32x32x16_bf16 v[60:75], v[104:107], v[92:95], v[60:75]
    ds_read_b64_tr_b16 v[116:117], v22 offset:28800
    ds_read_b64_tr_b16 v[118:119], v22 offset:30592
    s_mov_b32 s57, 0xa8000
    s_add_u32 m0, s59, 0x4000
    s_nop 0
    buffer_load_dwordx4 v9, s[24:27], s57 offen lds
    v_fma_f32 v125, v144, v144, v125
    v_fma_f32 v127, v145, v145, v127
    v_lshlrev_b32 v146, 16, v95
    v_and_b32 v147, s60, v95
    s_waitcnt lgkmcnt(5)
    v_mfma_f32_32x32x16_bf16 v[76:91], v[108:111], v[92:95], v[76:91]
    ds_read_b64_tr_b16 v[120:121], v22 offset:28928
    ds_read_b64_tr_b16 v[122:123], v22 offset:30720
    s_mov_b32 s57, 0xa8000
    s_add_u32 m0, s59, 0x6000
    s_nop 0
    buffer_load_dwordx4 v10, s[24:27], s57 offen lds
    v_mfma_f32_16x16x32_bf16 v[136:139], v[108:111], v[140:143], v[136:139]
    v_add_f32 v124, v124, v146
    v_add_f32 v126, v126, v147
    v_fma_f32 v125, v146, v146, v125
    v_fma_f32 v127, v147, v147, v127
    s_waitcnt lgkmcnt(4)
    v_mfma_f32_32x32x16_bf16 v[44:59], v[112:115], v[96:99], v[44:59]
    v_lshlrev_b32 v144, 16, v98
    v_and_b32 v145, s60, v98
    v_add_f32 v124, v124, v144
    v_add_f32 v126, v126, v145
    s_waitcnt lgkmcnt(2)
    v_mfma_f32_32x32x16_bf16 v[60:75], v[116:119], v[96:99], v[60:75]
    s_waitcnt lgkmcnt(0)
    s_waitcnt vmcnt(6)
    s_barrier
    ds_read_b128 v[92:95], v15 offset:32768
    ds_read_b64_tr_b16 v[100:101], v23
    ds_read_b64_tr_b16 v[102:103], v23 offset:1792
    ds_read_b64_tr_b16 v[104:105], v23 offset:128
    ds_read_b64_tr_b16 v[106:107], v23 offset:1920
    ds_read_b64_tr_b16 v[108:109], v23 offset:256
    ds_read_b64_tr_b16 v[110:111], v23 offset:2048
    v_fma_f32 v125, v144, v144, v125
    v_fma_f32 v127, v145, v145, v127
    v_lshlrev_b32 v146, 16, v99
    v_and_b32 v147, s60, v99
    v_mfma_f32_32x32x16_bf16 v[76:91], v[120:123], v[96:99], v[76:91]
    v_add_f32 v124, v124, v146
    v_add_f32 v126, v126, v147
    v_fma_f32 v125, v146, v146, v125
    v_fma_f32 v127, v147, v147, v127
    s_waitcnt lgkmcnt(4)
    v_mfma_f32_32x32x16_bf16 v[44:59], v[100:103], v[92:95], v[44:59]
    ds_read_b128 v[96:99], v16 offset:32768
    ds_read_b64_tr_b16 v[112:113], v24
    ds_read_b64_tr_b16 v[114:115], v24 offset:1792
    s_mov_b32 s56, 0x200
    s_add_u32 m0, s58, 0x4000
    s_nop 0
    buffer_load_dwordx4 v5, s[20:23], s56 offen lds
    v_mfma_f32_16x16x32_bf16 v[128:131], v[100:103], v[140:143], v[128:131]
    v_lshlrev_b32 v144, 16, v94
    v_and_b32 v145, s60, v94
    v_add_f32 v124, v124, v144
    v_add_f32 v126, v126, v145
    s_waitcnt lgkmcnt(5)
    v_mfma_f32_32x32x16_bf16 v[60:75], v[104:107], v[92:95], v[60:75]
    ds_read_b64_tr_b16 v[116:117], v24 offset:128
    ds_read_b64_tr_b16 v[118:119], v24 offset:1920
    v_fma_f32 v125, v144, v144, v125
    v_fma_f32 v127, v145, v145, v127
    v_lshlrev_b32 v146, 16, v95
    v_and_b32 v147, s60, v95
    s_waitcnt lgkmcnt(5)
    v_mfma_f32_32x32x16_bf16 v[76:91], v[108:111], v[92:95], v[76:91]
    ds_read_b64_tr_b16 v[120:121], v24 offset:256
    ds_read_b64_tr_b16 v[122:123], v24 offset:2048
    s_mov_b32 s56, 0x200
    s_add_u32 m0, s58, 0x4400
    s_nop 0
    buffer_load_dwordx4 v6, s[20:23], s56 offen lds
    v_add_f32 v124, v124, v146
    v_add_f32 v126, v126, v147
    v_fma_f32 v125, v146, v146, v125
    v_fma_f32 v127, v147, v147, v127
    s_waitcnt lgkmcnt(4)
    v_mfma_f32_32x32x16_bf16 v[44:59], v[112:115], v[96:99], v[44:59]
    ds_read_b128 v[92:95], v17 offset:32768
    ds_read_b64_tr_b16 v[100:101], v25
    ds_read_b64_tr_b16 v[102:103], v25 offset:1792
    s_mov_b32 s57, 0xe0000
    s_add_u32 m0, s59, 0x7000
    s_nop 0
    buffer_load_dwordx4 v7, s[24:27], s57 offen lds
    v_lshlrev_b32 v144, 16, v98
    v_and_b32 v145, s60, v98
    v_add_f32 v124, v124, v144
    v_add_f32 v126, v126, v145
    s_waitcnt lgkmcnt(5)
    v_mfma_f32_32x32x16_bf16 v[60:75], v[116:119], v[96:99], v[60:75]
    ds_read_b64_tr_b16 v[104:105], v25 offset:128
    ds_read_b64_tr_b16 v[106:107], v25 offset:1920
    v_mfma_f32_16x16x32_bf16 v[132:135], v[116:119], v[140:143], v[132:135]
    v_fma_f32 v125, v144, v144, v125
    v_fma_f32 v127, v145, v145, v127
    v_lshlrev_b32 v146, 16, v99
    v_and_b32 v147, s60, v99
    s_waitcnt lgkmcnt(5)
    v_mfma_f32_32x32x16_bf16 v[76:91], v[120:123], v[96:99], v[76:91]
    ds_read_b64_tr_b16 v[108:109], v25 offset:256
    ds_read_b64_tr_b16 v[110:111], v25 offset:2048
    s_mov_b32 s57, 0xe0000
    s_add_u32 m0, s59, 0x9000
    s_nop 0
    buffer_load_dwordx4 v8, s[24:27], s57 offen lds
    v_add_f32 v124, v124, v146
    v_add_f32 v126, v126, v147
    v_fma_f32 v125, v146, v146, v125
    v_fma_f32 v127, v147, v147, v127
    s_waitcnt lgkmcnt(4)
    v_mfma_f32_32x32x16_bf16 v[44:59], v[100:103], v[92:95], v[44:59]
    ds_read_b128 v[96:99], v18 offset:32768
    ds_read_b64_tr_b16 v[112:113], v26
    ds_read_b64_tr_b16 v[114:115], v26 offset:1792
    v_lshlrev_b32 v144, 16, v94
    v_and_b32 v145, s60, v94
    v_add_f32 v124, v124, v144
    v_add_f32 v126, v126, v145
    s_waitcnt lgkmcnt(5)
    v_mfma_f32_32x32x16_bf16 v[60:75], v[104:107], v[92:95], v[60:75]
    ds_read_b64_tr_b16 v[116:117], v26 offset:128
    ds_read_b64_tr_b16 v[118:119], v26 offset:1920
    s_mov_b32 s57, 0xe0000
    s_add_u32 m0, s59, 0xb000
    s_nop 0
    buffer_load_dwordx4 v9, s[24:27], s57 offen lds
    v_fma_f32 v125, v144, v144, v125
    v_fma_f32 v127, v145, v145, v127
    v_lshlrev_b32 v146, 16, v95
    v_and_b32 v147, s60, v95
    s_waitcnt lgkmcnt(5)
    v_mfma_f32_32x32x16_bf16 v[76:91], v[108:111], v[92:95], v[76:91]
    ds_read_b64_tr_b16 v[120:121], v26 offset:256
    ds_read_b64_tr_b16 v[122:123], v26 offset:2048
    s_mov_b32 s57, 0xe0000
    s_add_u32 m0, s59, 0xd000
    s_nop 0
    buffer_load_dwordx4 v10, s[24:27], s57 offen lds
    v_mfma_f32_16x16x32_bf16 v[136:139], v[108:111], v[140:143], v[136:139]
    v_add_f32 v124, v124, v146
    v_add_f32 v126, v126, v147
    v_fma_f32 v125, v146, v146, v125
    v_fma_f32 v127, v147, v147, v127
    s_waitcnt lgkmcnt(4)
    v_mfma_f32_32x32x16_bf16 v[44:59], v[112:115], v[96:99], v[44:59]
    v_lshlrev_b32 v144, 16, v98
    v_and_b32 v145, s60, v98
    v_add_f32 v124, v124, v144
    v_add_f32 v126, v126, v145
    s_waitcnt lgkmcnt(2)
    v_mfma_f32_32x32x16_bf16 v[60:75], v[116:119], v[96:99], v[60:75]
    s_waitcnt lgkmcnt(0)
    s_waitcnt vmcnt(6)
    s_barrier
    ds_read_b128 v[92:95], v15
    ds_read_b64_tr_b16 v[100:101], v19
    ds_read_b64_tr_b16 v[102:103], v19 offset:1792
    ds_read_b64_tr_b16 v[104:105], v19 offset:128
    ds_read_b64_tr_b16 v[106:107], v19 offset:1920
    ds_read_b64_tr_b16 v[108:109], v19 offset:256
    ds_read_b64_tr_b16 v[110:111], v19 offset:2048
    v_fma_f32 v125, v144, v144, v125
    v_fma_f32 v127, v145, v145, v127
    v_lshlrev_b32 v146, 16, v99
    v_and_b32 v147, s60, v99
    v_mfma_f32_32x32x16_bf16 v[76:91], v[120:123], v[96:99], v[76:91]
    v_add_f32 v124, v124, v146
    v_add_f32 v126, v126, v147
    v_fma_f32 v125, v146, v146, v125
    v_fma_f32 v127, v147, v147, v127
    s_waitcnt lgkmcnt(4)
    v_mfma_f32_32x32x16_bf16 v[44:59], v[100:103], v[92:95], v[44:59]
    ds_read_b128 v[96:99], v16
    ds_read_b64_tr_b16 v[112:113], v20
    ds_read_b64_tr_b16 v[114:115], v20 offset:1792
    s_mov_b32 s56, 0x280
    s_add_u32 m0, s58, 0x8000
    s_nop 0
    buffer_load_dwordx4 v5, s[20:23], s56 offen lds
    v_mfma_f32_16x16x32_bf16 v[128:131], v[100:103], v[140:143], v[128:131]
    v_lshlrev_b32 v144, 16, v94
    v_and_b32 v145, s60, v94
    v_add_f32 v124, v124, v144
    v_add_f32 v126, v126, v145
    s_waitcnt lgkmcnt(5)
    v_mfma_f32_32x32x16_bf16 v[60:75], v[104:107], v[92:95], v[60:75]
    ds_read_b64_tr_b16 v[116:117], v20 offset:128
    ds_read_b64_tr_b16 v[118:119], v20 offset:1920
    v_fma_f32 v125, v144, v144, v125
    v_fma_f32 v127, v145, v145, v127
    v_lshlrev_b32 v146, 16, v95
    v_and_b32 v147, s60, v95
    s_waitcnt lgkmcnt(5)
    v_mfma_f32_32x32x16_bf16 v[76:91], v[108:111], v[92:95], v[76:91]
    ds_read_b64_tr_b16 v[120:121], v20 offset:256
    ds_read_b64_tr_b16 v[122:123], v20 offset:2048
    s_mov_b32 s56, 0x280
    s_add_u32 m0, s58, 0x8400
    s_nop 0
    buffer_load_dwordx4 v6, s[20:23], s56 offen lds
    v_add_f32 v124, v124, v146
    v_add_f32 v126, v126, v147
    v_fma_f32 v125, v146, v146, v125
    v_fma_f32 v127, v147, v147, v127
    s_waitcnt lgkmcnt(4)
    v_mfma_f32_32x32x16_bf16 v[44:59], v[112:115], v[96:99], v[44:59]
    ds_read_b128 v[92:95], v17
    ds_read_b64_tr_b16 v[100:101], v21
    ds_read_b64_tr_b16 v[102:103], v21 offset:1792
    s_mov_b32 s57, 0x118000
    s_add_u32 m0, s59, 0xe000
    s_nop 0
    buffer_load_dwordx4 v7, s[24:27], s57 offen lds
    v_lshlrev_b32 v144, 16, v98
    v_and_b32 v145, s60, v98
    v_add_f32 v124, v124, v144
    v_add_f32 v126, v126, v145
    s_waitcnt lgkmcnt(5)
    v_mfma_f32_32x32x16_bf16 v[60:75], v[116:119], v[96:99], v[60:75]
    ds_read_b64_tr_b16 v[104:105], v21 offset:128
    ds_read_b64_tr_b16 v[106:107], v21 offset:1920
    v_mfma_f32_16x16x32_bf16 v[132:135], v[116:119], v[140:143], v[132:135]
    v_fma_f32 v125, v144, v144, v125
    v_fma_f32 v127, v145, v145, v127
    v_lshlrev_b32 v146, 16, v99
    v_and_b32 v147, s60, v99
    s_waitcnt lgkmcnt(5)
    v_mfma_f32_32x32x16_bf16 v[76:91], v[120:123], v[96:99], v[76:91]
    ds_read_b64_tr_b16 v[108:109], v21 offset:256
    ds_read_b64_tr_b16 v[110:111], v21 offset:2048
    s_mov_b32 s57, 0x118000
    s_add_u32 m0, s59, 0x10000
    s_nop 0
    buffer_load_dwordx4 v8, s[24:27], s57 offen lds
    v_add_f32 v124, v124, v146
    v_add_f32 v126, v126, v147
    v_fma_f32 v125, v146, v146, v125
    v_fma_f32 v127, v147, v147, v127
    s_waitcnt lgkmcnt(4)
    v_mfma_f32_32x32x16_bf16 v[44:59], v[100:103], v[92:95], v[44:59]
    ds_read_b128 v[96:99], v18
    ds_read_b64_tr_b16 v[112:113], v22
    ds_read_b64_tr_b16 v[114:115], v22 offset:1792
    v_lshlrev_b32 v144, 16, v94
    v_and_b32 v145, s60, v94
    v_add_f32 v124, v124, v144
    v_add_f32 v126, v126, v145
    s_waitcnt lgkmcnt(5)
    v_mfma_f32_32x32x16_bf16 v[60:75], v[104:107], v[92:95], v[60:75]
    ds_read_b64_tr_b16 v[116:117], v22 offset:128
    ds_read_b64_tr_b16 v[118:119], v22 offset:1920
    s_mov_b32 s57, 0x118000
    s_add_u32 m0, s59, 0x12000
    s_nop 0
    buffer_load_dwordx4 v9, s[24:27], s57 offen lds
    v_fma_f32 v125, v144, v144, v125
    v_fma_f32 v127, v145, v145, v127
    v_lshlrev_b32 v146, 16, v95
    v_and_b32 v147, s60, v95
    s_waitcnt lgkmcnt(5)
    v_mfma_f32_32x32x16_bf16 v[76:91], v[108:111], v[92:95], v[76:91]
    ds_read_b64_tr_b16 v[120:121], v22 offset:256
    ds_read_b64_tr_b16 v[122:123], v22 offset:2048
    s_mov_b32 s57, 0x118000
    s_add_u32 m0, s59, 0x14000
    s_nop 0
    buffer_load_dwordx4 v10, s[24:27], s57 offen lds
    v_mfma_f32_16x16x32_bf16 v[136:139], v[108:111], v[140:143], v[136:139]
    v_add_f32 v124, v124, v146
    v_add_f32 v126, v126, v147
    v_fma_f32 v125, v146, v146, v125
    v_fma_f32 v127, v147, v147, v127
    s_waitcnt lgkmcnt(4)
    v_mfma_f32_32x32x16_bf16 v[44:59], v[112:115], v[96:99], v[44:59]
    v_lshlrev_b32 v144, 16, v98
    v_and_b32 v145, s60, v98
    v_add_f32 v124, v124, v144
    v_add_f32 v126, v126, v145
    s_waitcnt lgkmcnt(2)
    v_mfma_f32_32x32x16_bf16 v[60:75], v[116:119], v[96:99], v[60:75]
    s_waitcnt lgkmcnt(0)
    s_waitcnt vmcnt(6)
    s_barrier
    ds_read_b128 v[92:95], v15 offset:16384
    ds_read_b64_tr_b16 v[100:101], v19 offset:28672
    ds_read_b64_tr_b16 v[102:103], v19 offset:30464
    ds_read_b64_tr_b16 v[104:105], v19 offset:28800
    ds_read_b64_tr_b16 v[106:107], v19 offset:30592
    ds_read_b64_tr_b16 v[108:109], v19 offset:28928
    ds_read_b64_tr_b16 v[110:111], v19 offset:30720
    v_fma_f32 v125, v144, v144, v125
    v_fma_f32 v127, v145, v145, v127
    v_lshlrev_b32 v146, 16, v99
    v_and_b32 v147, s60, v99
    v_mfma_f32_32x32x16_bf16 v[76:91], v[120:123], v[96:99], v[76:91]
    v_add_f32 v124, v124, v146
    v_add_f32 v126, v126, v147
    v_fma_f32 v125, v146, v146, v125
    v_fma_f32 v127, v147, v147, v127
    s_waitcnt lgkmcnt(4)
    v_mfma_f32_32x32x16_bf16 v[44:59], v[100:103], v[92:95], v[44:59]
    ds_read_b128 v[96:99], v16 offset:16384
    ds_read_b64_tr_b16 v[112:113], v20 offset:28672
    ds_read_b64_tr_b16 v[114:115], v20 offset:30464
    s_mov_b32 s56, 0x300
    s_add_u32 m0, s58, 0
    s_nop 0
    buffer_load_dwordx4 v5, s[20:23], s56 offen lds
    s_add_u32 m0, s18, 0x3400
    s_nop 0
    buffer_load_dwordx4 v27, s[32:35], s64 offen lds
    v_mfma_f32_16x16x32_bf16 v[128:131], v[100:103], v[140:143], v[128:131]
    v_lshlrev_b32 v144, 16, v94
    v_and_b32 v145, s60, v94
    v_add_f32 v124, v124, v144
    v_add_f32 v126, v126, v145
    s_waitcnt lgkmcnt(5)
    v_mfma_f32_32x32x16_bf16 v[60:75], v[104:107], v[92:95], v[60:75]
    ds_read_b64_tr_b16 v[116:117], v20 offset:28800
    ds_read_b64_tr_b16 v[118:119], v20 offset:30592
    v_fma_f32 v125, v144, v144, v125
    v_fma_f32 v127, v145, v145, v127
    v_lshlrev_b32 v146, 16, v95
    v_and_b32 v147, s60, v95
    s_waitcnt lgkmcnt(5)
    v_mfma_f32_32x32x16_bf16 v[76:91], v[108:111], v[92:95], v[76:91]
    ds_read_b64_tr_b16 v[120:121], v20 offset:28928
    ds_read_b64_tr_b16 v[122:123], v20 offset:30720
    s_mov_b32 s56, 0x300
    s_add_u32 m0, s58, 0x400
    s_nop 0
    buffer_load_dwordx4 v6, s[20:23], s56 offen lds
    v_add_f32 v124, v124, v146
    v_add_f32 v126, v126, v147
    v_fma_f32 v125, v146, v146, v125
    v_fma_f32 v127, v147, v147, v127
    s_waitcnt lgkmcnt(4)
    v_mfma_f32_32x32x16_bf16 v[44:59], v[112:115], v[96:99], v[44:59]
    ds_read_b128 v[92:95], v17 offset:16384
    ds_read_b64_tr_b16 v[100:101], v21 offset:28672
    ds_read_b64_tr_b16 v[102:103], v21 offset:30464
    s_mov_b32 s57, 0x150000
    s_add_u32 m0, s59, 0
    s_nop 0
    buffer_load_dwordx4 v7, s[24:27], s57 offen lds
    v_lshlrev_b32 v144, 16, v98
    v_and_b32 v145, s60, v98
    v_add_f32 v124, v124, v144
    v_add_f32 v126, v126, v145
    s_waitcnt lgkmcnt(5)
    v_mfma_f32_32x32x16_bf16 v[60:75], v[116:119], v[96:99], v[60:75]
    ds_read_b64_tr_b16 v[104:105], v21 offset:28800
    ds_read_b64_tr_b16 v[106:107], v21 offset:30592
    v_mfma_f32_16x16x32_bf16 v[132:135], v[116:119], v[140:143], v[132:135]
    v_fma_f32 v125, v144, v144, v125
    v_fma_f32 v127, v145, v145, v127
    v_lshlrev_b32 v146, 16, v99
    v_and_b32 v147, s60, v99
    s_waitcnt lgkmcnt(5)
    v_mfma_f32_32x32x16_bf16 v[76:91], v[120:123], v[96:99], v[76:91]
    ds_read_b64_tr_b16 v[108:109], v21 offset:28928
    ds_read_b64_tr_b16 v[110:111], v21 offset:30720
    s_mov_b32 s57, 0x150000
    s_add_u32 m0, s59, 0x2000
    s_nop 0
    buffer_load_dwordx4 v8, s[24:27], s57 offen lds
    v_add_f32 v124, v124, v146
    v_add_f32 v126, v126, v147
    v_fma_f32 v125, v146, v146, v125
    v_fma_f32 v127, v147, v147, v127
    s_waitcnt lgkmcnt(4)
    v_mfma_f32_32x32x16_bf16 v[44:59], v[100:103], v[92:95], v[44:59]
    ds_read_b128 v[96:99], v18 offset:16384
    ds_read_b64_tr_b16 v[112:113], v22 offset:28672
    ds_read_b64_tr_b16 v[114:115], v22 offset:30464
    v_lshlrev_b32 v144, 16, v94
    v_and_b32 v145, s60, v94
    v_add_f32 v124, v124, v144
    v_add_f32 v126, v126, v145
    s_waitcnt lgkmcnt(5)
    v_mfma_f32_32x32x16_bf16 v[60:75], v[104:107], v[92:95], v[60:75]
    ds_read_b64_tr_b16 v[116:117], v22 offset:28800
    ds_read_b64_tr_b16 v[118:119], v22 offset:30592
    s_mov_b32 s57, 0x150000
    s_add_u32 m0, s59, 0x4000
    s_nop 0
    buffer_load_dwordx4 v9, s[24:27], s57 offen lds
    v_fma_f32 v125, v144, v144, v125
    v_fma_f32 v127, v145, v145, v127
    v_lshlrev_b32 v146, 16, v95
    v_and_b32 v147, s60, v95
    s_waitcnt lgkmcnt(5)
    v_mfma_f32_32x32x16_bf16 v[76:91], v[108:111], v[92:95], v[76:91]
    ds_read_b64_tr_b16 v[120:121], v22 offset:28928
    ds_read_b64_tr_b16 v[122:123], v22 offset:30720
    s_mov_b32 s57, 0x150000
    s_add_u32 m0, s59, 0x6000
    s_nop 0
    buffer_load_dwordx4 v10, s[24:27], s57 offen lds
    v_mfma_f32_16x16x32_bf16 v[136:139], v[108:111], v[140:143], v[136:139]
    v_add_f32 v124, v124, v146
    v_add_f32 v126, v126, v147
    v_fma_f32 v125, v146, v146, v125
    v_fma_f32 v127, v147, v147, v127
    s_waitcnt lgkmcnt(4)
    v_mfma_f32_32x32x16_bf16 v[44:59], v[112:115], v[96:99], v[44:59]
    v_lshlrev_b32 v144, 16, v98
    v_and_b32 v145, s60, v98
    v_add_f32 v124, v124, v144
    v_add_f32 v126, v126, v145
    s_waitcnt lgkmcnt(2)
    v_mfma_f32_32x32x16_bf16 v[60:75], v[116:119], v[96:99], v[60:75]
    s_waitcnt lgkmcnt(0)
    s_waitcnt vmcnt(7)
    s_barrier
    ds_read_b128 v[92:95], v15 offset:32768
    ds_read_b64_tr_b16 v[100:101], v23
    ds_read_b64_tr_b16 v[102:103], v23 offset:1792
    ds_read_b64_tr_b16 v[104:105], v23 offset:128
    ds_read_b64_tr_b16 v[106:107], v23 offset:1920
    ds_read_b64_tr_b16 v[108:109], v23 offset:256
    ds_read_b64_tr_b16 v[110:111], v23 offset:2048
    v_fma_f32 v125, v144, v144, v125
    v_fma_f32 v127, v145, v145, v127
    v_lshlrev_b32 v146, 16, v99
    v_and_b32 v147, s60, v99
    v_mfma_f32_32x32x16_bf16 v[76:91], v[120:123], v[96:99], v[76:91]
    v_add_f32 v124, v124, v146
    v_add_f32 v126, v126, v147
    v_fma_f32 v125, v146, v146, v125
    v_fma_f32 v127, v147, v147, v127
    s_waitcnt lgkmcnt(4)
    v_mfma_f32_32x32x16_bf16 v[44:59], v[100:103], v[92:95], v[44:59]
    ds_read_b128 v[96:99], v16 offset:32768
    ds_read_b64_tr_b16 v[112:113], v24
    ds_read_b64_tr_b16 v[114:115], v24 offset:1792
    s_mov_b32 s56, 0x380
    s_add_u32 m0, s58, 0x4000
    s_nop 0
    buffer_load_dwordx4 v5, s[20:23], s56 offen lds
    v_mfma_f32_16x16x32_bf16 v[128:131], v[100:103], v[140:143], v[128:131]
    v_lshlrev_b32 v144, 16, v94
    v_and_b32 v145, s60, v94
    v_add_f32 v124, v124, v144
    v_add_f32 v126, v126, v145
    s_waitcnt lgkmcnt(5)
    v_mfma_f32_32x32x16_bf16 v[60:75], v[104:107], v[92:95], v[60:75]
    ds_read_b64_tr_b16 v[116:117], v24 offset:128
    ds_read_b64_tr_b16 v[118:119], v24 offset:1920
    v_fma_f32 v125, v144, v144, v125
    v_fma_f32 v127, v145, v145, v127
    v_lshlrev_b32 v146, 16, v95
    v_and_b32 v147, s60, v95
    s_waitcnt lgkmcnt(5)
    v_mfma_f32_32x32x16_bf16 v[76:91], v[108:111], v[92:95], v[76:91]
    ds_read_b64_tr_b16 v[120:121], v24 offset:256
    ds_read_b64_tr_b16 v[122:123], v24 offset:2048
    s_mov_b32 s56, 0x380
    s_add_u32 m0, s58, 0x4400
    s_nop 0
    buffer_load_dwordx4 v6, s[20:23], s56 offen lds
    v_add_f32 v124, v124, v146
    v_add_f32 v126, v126, v147
    v_fma_f32 v125, v146, v146, v125
    v_fma_f32 v127, v147, v147, v127
    s_waitcnt lgkmcnt(4)
    v_mfma_f32_32x32x16_bf16 v[44:59], v[112:115], v[96:99], v[44:59]
    ds_read_b128 v[92:95], v17 offset:32768
    ds_read_b64_tr_b16 v[100:101], v25
    ds_read_b64_tr_b16 v[102:103], v25 offset:1792
    s_mov_b32 s57, 0x188000
    s_add_u32 m0, s59, 0x7000
    s_nop 0
    buffer_load_dwordx4 v7, s[24:27], s57 offen lds
    v_lshlrev_b32 v144, 16, v98
    v_and_b32 v145, s60, v98
    v_add_f32 v124, v124, v144
    v_add_f32 v126, v126, v145
    s_waitcnt lgkmcnt(5)
    v_mfma_f32_32x32x16_bf16 v[60:75], v[116:119], v[96:99], v[60:75]
    ds_read_b64_tr_b16 v[104:105], v25 offset:128
    ds_read_b64_tr_b16 v[106:107], v25 offset:1920
    v_mfma_f32_16x16x32_bf16 v[132:135], v[116:119], v[140:143], v[132:135]
    v_fma_f32 v125, v144, v144, v125
    v_fma_f32 v127, v145, v145, v127
    v_lshlrev_b32 v146, 16, v99
    v_and_b32 v147, s60, v99
    s_waitcnt lgkmcnt(5)
    v_mfma_f32_32x32x16_bf16 v[76:91], v[120:123], v[96:99], v[76:91]
    ds_read_b64_tr_b16 v[108:109], v25 offset:256
    ds_read_b64_tr_b16 v[110:111], v25 offset:2048
    s_mov_b32 s57, 0x188000
    s_add_u32 m0, s59, 0x9000
    s_nop 0
    buffer_load_dwordx4 v8, s[24:27], s57 offen lds
    v_add_f32 v124, v124, v146
    v_add_f32 v126, v126, v147
    v_fma_f32 v125, v146, v146, v125
    v_fma_f32 v127, v147, v147, v127
    s_waitcnt lgkmcnt(4)
    v_mfma_f32_32x32x16_bf16 v[44:59], v[100:103], v[92:95], v[44:59]
    ds_read_b128 v[96:99], v18 offset:32768
    ds_read_b64_tr_b16 v[112:113], v26
    ds_read_b64_tr_b16 v[114:115], v26 offset:1792
    v_lshlrev_b32 v144, 16, v94
    v_and_b32 v145, s60, v94
    v_add_f32 v124, v124, v144
    v_add_f32 v126, v126, v145
    s_waitcnt lgkmcnt(5)
    v_mfma_f32_32x32x16_bf16 v[60:75], v[104:107], v[92:95], v[60:75]
    ds_read_b64_tr_b16 v[116:117], v26 offset:128
    ds_read_b64_tr_b16 v[118:119], v26 offset:1920
    s_mov_b32 s57, 0x188000
    s_add_u32 m0, s59, 0xb000
    s_nop 0
    buffer_load_dwordx4 v9, s[24:27], s57 offen lds
    v_fma_f32 v125, v144, v144, v125
    v_fma_f32 v127, v145, v145, v127
    v_lshlrev_b32 v146, 16, v95
    v_and_b32 v147, s60, v95
    s_waitcnt lgkmcnt(5)
    v_mfma_f32_32x32x16_bf16 v[76:91], v[108:111], v[92:95], v[76:91]
    ds_read_b64_tr_b16 v[120:121], v26 offset:256
    ds_read_b64_tr_b16 v[122:123], v26 offset:2048
    s_mov_b32 s57, 0x188000
    s_add_u32 m0, s59, 0xd000
    s_nop 0
    buffer_load_dwordx4 v10, s[24:27], s57 offen lds
    v_mfma_f32_16x16x32_bf16 v[136:139], v[108:111], v[140:143], v[136:139]
    v_add_f32 v124, v124, v146
    v_add_f32 v126, v126, v147
    v_fma_f32 v125, v146, v146, v125
    v_fma_f32 v127, v147, v147, v127
    s_waitcnt lgkmcnt(4)
    v_mfma_f32_32x32x16_bf16 v[44:59], v[112:115], v[96:99], v[44:59]
    v_lshlrev_b32 v144, 16, v98
    v_and_b32 v145, s60, v98
    v_add_f32 v124, v124, v144
    v_add_f32 v126, v126, v145
    s_waitcnt lgkmcnt(2)
    v_mfma_f32_32x32x16_bf16 v[60:75], v[116:119], v[96:99], v[60:75]
    s_waitcnt lgkmcnt(0)
    s_waitcnt vmcnt(6)
    s_barrier
    ds_read_b128 v[92:95], v15
    ds_read_b64_tr_b16 v[100:101], v19
    ds_read_b64_tr_b16 v[102:103], v19 offset:1792
    ds_read_b64_tr_b16 v[104:105], v19 offset:128
    ds_read_b64_tr_b16 v[106:107], v19 offset:1920
    ds_read_b64_tr_b16 v[108:109], v19 offset:256
    ds_read_b64_tr_b16 v[110:111], v19 offset:2048
    v_fma_f32 v125, v144, v144, v125
    v_fma_f32 v127, v145, v145, v127
    v_lshlrev_b32 v146, 16, v99
    v_and_b32 v147, s60, v99
    v_mfma_f32_32x32x16_bf16 v[76:91], v[120:123], v[96:99], v[76:91]
    v_add_f32 v124, v124, v146
    v_add_f32 v126, v126, v147
    v_fma_f32 v125, v146, v146, v125
    v_fma_f32 v127, v147, v147, v127
    s_waitcnt lgkmcnt(4)
    v_mfma_f32_32x32x16_bf16 v[44:59], v[100:103], v[92:95], v[44:59]
    ds_read_b128 v[96:99], v16
    ds_read_b64_tr_b16 v[112:113], v20
    ds_read_b64_tr_b16 v[114:115], v20 offset:1792
    ds_read_b64_tr_b16 v[32:33], v40 offset:13312
    ds_read_b64_tr_b16 v[34:35], v40 offset:13824
    v_mfma_f32_16x16x32_bf16 v[128:131], v[100:103], v[140:143], v[128:131]
    v_lshlrev_b32 v144, 16, v94
    v_and_b32 v145, s60, v94
    v_add_f32 v124, v124, v144
    v_add_f32 v126, v126, v145
    s_waitcnt lgkmcnt(7)
    v_mfma_f32_32x32x16_bf16 v[60:75], v[104:107], v[92:95], v[60:75]
    ds_read_b64_tr_b16 v[116:117], v20 offset:128
    ds_read_b64_tr_b16 v[118:119], v20 offset:1920
    v_fma_f32 v125, v144, v144, v125
    v_fma_f32 v127, v145, v145, v127
    v_lshlrev_b32 v146, 16, v95
    v_and_b32 v147, s60, v95
    s_waitcnt lgkmcnt(7)
    v_mfma_f32_32x32x16_bf16 v[76:91], v[108:111], v[92:95], v[76:91]
    ds_read_b64_tr_b16 v[120:121], v20 offset:256
    ds_read_b64_tr_b16 v[122:123], v20 offset:2048
    v_add_f32 v124, v124, v146
    v_add_f32 v126, v126, v147
    v_fma_f32 v125, v146, v146, v125
    v_fma_f32 v127, v147, v147, v127
    s_waitcnt lgkmcnt(6)
    v_mfma_f32_32x32x16_bf16 v[44:59], v[112:115], v[96:99], v[44:59]
    ds_read_b128 v[92:95], v17
    ds_read_b64_tr_b16 v[100:101], v21
    ds_read_b64_tr_b16 v[102:103], v21 offset:1792
    v_lshlrev_b32 v144, 16, v98
    v_and_b32 v145, s60, v98
    v_add_f32 v124, v124, v144
    v_add_f32 v126, v126, v145
    s_waitcnt lgkmcnt(5)
    v_mfma_f32_32x32x16_bf16 v[60:75], v[116:119], v[96:99], v[60:75]
    ds_read_b64_tr_b16 v[104:105], v21 offset:128
    ds_read_b64_tr_b16 v[106:107], v21 offset:1920
    v_mfma_f32_16x16x32_bf16 v[132:135], v[116:119], v[140:143], v[132:135]
    v_fma_f32 v125, v144, v144, v125
    v_fma_f32 v127, v145, v145, v127
    v_lshlrev_b32 v146, 16, v99
    v_and_b32 v147, s60, v99
    s_waitcnt lgkmcnt(5)
    v_mfma_f32_32x32x16_bf16 v[76:91], v[120:123], v[96:99], v[76:91]
    ds_read_b64_tr_b16 v[108:109], v21 offset:256
    ds_read_b64_tr_b16 v[110:111], v21 offset:2048
    v_add_f32 v124, v124, v146
    v_add_f32 v126, v126, v147
    v_fma_f32 v125, v146, v146, v125
    v_fma_f32 v127, v147, v147, v127
    s_waitcnt lgkmcnt(4)
    v_mfma_f32_32x32x16_bf16 v[44:59], v[100:103], v[92:95], v[44:59]
    ds_read_b128 v[96:99], v18
    ds_read_b64_tr_b16 v[112:113], v22
    ds_read_b64_tr_b16 v[114:115], v22 offset:1792
    v_lshlrev_b32 v144, 16, v94
    v_and_b32 v145, s60, v94
    v_add_f32 v124, v124, v144
    v_add_f32 v126, v126, v145
    s_waitcnt lgkmcnt(5)
    v_mfma_f32_32x32x16_bf16 v[60:75], v[104:107], v[92:95], v[60:75]
    ds_read_b64_tr_b16 v[116:117], v22 offset:128
    ds_read_b64_tr_b16 v[118:119], v22 offset:1920
    v_fma_f32 v125, v144, v144, v125
    v_fma_f32 v127, v145, v145, v127
    v_lshlrev_b32 v146, 16, v95
    v_and_b32 v147, s60, v95
    s_waitcnt lgkmcnt(5)
    v_mfma_f32_32x32x16_bf16 v[76:91], v[108:111], v[92:95], v[76:91]
    ds_read_b64_tr_b16 v[120:121], v22 offset:256
    ds_read_b64_tr_b16 v[122:123], v22 offset:2048
    v_mfma_f32_16x16x32_bf16 v[136:139], v[108:111], v[140:143], v[136:139]
    v_add_f32 v124, v124, v146
    v_add_f32 v126, v126, v147
    v_fma_f32 v125, v146, v146, v125
    v_fma_f32 v127, v147, v147, v127
    s_waitcnt lgkmcnt(4)
    v_mfma_f32_32x32x16_bf16 v[44:59], v[112:115], v[96:99], v[44:59]
    v_lshlrev_b32 v144, 16, v98
    v_and_b32 v145, s60, v98
    v_add_f32 v124, v124, v144
    v_add_f32 v126, v126, v145
    s_waitcnt lgkmcnt(2)
    v_mfma_f32_32x32x16_bf16 v[60:75], v[116:119], v[96:99], v[60:75]
    s_waitcnt lgkmcnt(0)
    s_waitcnt vmcnt(0)
    s_barrier
    ds_read_b128 v[92:95], v15 offset:16384
    ds_read_b64_tr_b16 v[100:101], v19 offset:28672
    ds_read_b64_tr_b16 v[102:103], v19 offset:30464
    ds_read_b64_tr_b16 v[104:105], v19 offset:28800
    ds_read_b64_tr_b16 v[106:107], v19 offset:30592
    ds_read_b64_tr_b16 v[108:109], v19 offset:28928
    ds_read_b64_tr_b16 v[110:111], v19 offset:30720
    v_fma_f32 v125, v144, v144, v125
    v_fma_f32 v127, v145, v145, v127
    v_lshlrev_b32 v146, 16, v99
    v_and_b32 v147, s60, v99
    v_mfma_f32_32x32x16_bf16 v[76:91], v[120:123], v[96:99], v[76:91]
    v_add_f32 v124, v124, v146
    v_add_f32 v126, v126, v147
    v_fma_f32 v125, v146, v146, v125
    v_fma_f32 v127, v147, v147, v127
    s_waitcnt lgkmcnt(4)
    v_mfma_f32_32x32x16_bf16 v[44:59], v[100:103], v[92:95], v[44:59]
    ds_read_b128 v[96:99], v16 offset:16384
    ds_read_b64_tr_b16 v[112:113], v20 offset:28672
    ds_read_b64_tr_b16 v[114:115], v20 offset:30464
    buffer_store_dwordx4 v[32:35], v28, s[28:31], s66 offen sc0 sc1
    v_mfma_f32_16x16x32_bf16 v[128:131], v[100:103], v[140:143], v[128:131]
    v_lshlrev_b32 v144, 16, v94
    v_and_b32 v145, s60, v94
    v_add_f32 v124, v124, v144
    v_add_f32 v126, v126, v145
    s_waitcnt lgkmcnt(5)
    v_mfma_f32_32x32x16_bf16 v[60:75], v[104:107], v[92:95], v[60:75]
    ds_read_b64_tr_b16 v[116:117], v20 offset:28800
    ds_read_b64_tr_b16 v[118:119], v20 offset:30592
    v_fma_f32 v125, v144, v144, v125
    v_fma_f32 v127, v145, v145, v127
    v_lshlrev_b32 v146, 16, v95
    v_and_b32 v147, s60, v95
    s_waitcnt lgkmcnt(5)
    v_mfma_f32_32x32x16_bf16 v[76:91], v[108:111], v[92:95], v[76:91]
    ds_read_b64_tr_b16 v[120:121], v20 offset:28928
    ds_read_b64_tr_b16 v[122:123], v20 offset:30720
    v_add_f32 v124, v124, v146
    v_add_f32 v126, v126, v147
    v_fma_f32 v125, v146, v146, v125
    v_fma_f32 v127, v147, v147, v127
    s_waitcnt lgkmcnt(4)
    v_mfma_f32_32x32x16_bf16 v[44:59], v[112:115], v[96:99], v[44:59]
    ds_read_b128 v[92:95], v17 offset:16384
    ds_read_b64_tr_b16 v[100:101], v21 offset:28672
    ds_read_b64_tr_b16 v[102:103], v21 offset:30464
    v_lshlrev_b32 v144, 16, v98
    v_and_b32 v145, s60, v98
    v_add_f32 v124, v124, v144
    v_add_f32 v126, v126, v145
    s_waitcnt lgkmcnt(5)
    v_mfma_f32_32x32x16_bf16 v[60:75], v[116:119], v[96:99], v[60:75]
    ds_read_b64_tr_b16 v[104:105], v21 offset:28800
    ds_read_b64_tr_b16 v[106:107], v21 offset:30592
    v_mfma_f32_16x16x32_bf16 v[132:135], v[116:119], v[140:143], v[132:135]
    v_fma_f32 v125, v144, v144, v125
    v_fma_f32 v127, v145, v145, v127
    v_lshlrev_b32 v146, 16, v99
    v_and_b32 v147, s60, v99
    s_waitcnt lgkmcnt(5)
    v_mfma_f32_32x32x16_bf16 v[76:91], v[120:123], v[96:99], v[76:91]
    ds_read_b64_tr_b16 v[108:109], v21 offset:28928
    ds_read_b64_tr_b16 v[110:111], v21 offset:30720
    v_add_f32 v124, v124, v146
    v_add_f32 v126, v126, v147
    v_fma_f32 v125, v146, v146, v125
    v_fma_f32 v127, v147, v147, v127
    s_waitcnt lgkmcnt(4)
    v_mfma_f32_32x32x16_bf16 v[44:59], v[100:103], v[92:95], v[44:59]
    ds_read_b128 v[96:99], v18 offset:16384
    ds_read_b64_tr_b16 v[112:113], v22 offset:28672
    ds_read_b64_tr_b16 v[114:115], v22 offset:30464
    v_lshlrev_b32 v144, 16, v94
    v_and_b32 v145, s60, v94
    v_add_f32 v124, v124, v144
    v_add_f32 v126, v126, v145
    s_waitcnt lgkmcnt(5)
    v_mfma_f32_32x32x16_bf16 v[60:75], v[104:107], v[92:95], v[60:75]
    ds_read_b64_tr_b16 v[116:117], v22 offset:28800
    ds_read_b64_tr_b16 v[118:119], v22 offset:30592
    v_fma_f32 v125, v144, v144, v125
    v_fma_f32 v127, v145, v145, v127
    v_lshlrev_b32 v146, 16, v95
    v_and_b32 v147, s60, v95
    s_waitcnt lgkmcnt(5)
    v_mfma_f32_32x32x16_bf16 v[76:91], v[108:111], v[92:95], v[76:91]
    ds_read_b64_tr_b16 v[120:121], v22 offset:28928
    ds_read_b64_tr_b16 v[122:123], v22 offset:30720
    v_mfma_f32_16x16x32_bf16 v[136:139], v[108:111], v[140:143], v[136:139]
    v_add_f32 v124, v124, v146
    v_add_f32 v126, v126, v147
    v_fma_f32 v125, v146, v146, v125
    v_fma_f32 v127, v147, v147, v127
    s_waitcnt lgkmcnt(4)
    v_mfma_f32_32x32x16_bf16 v[44:59], v[112:115], v[96:99], v[44:59]
    v_lshlrev_b32 v144, 16, v98
    v_and_b32 v145, s60, v98
    v_add_f32 v124, v124, v144
    v_add_f32 v126, v126, v145
    s_waitcnt lgkmcnt(2)
    v_mfma_f32_32x32x16_bf16 v[60:75], v[116:119], v[96:99], v[60:75]
    v_fma_f32 v125, v144, v144, v125
    v_fma_f32 v127, v145, v145, v127
    v_lshlrev_b32 v146, 16, v99
    v_and_b32 v147, s60, v99
    s_waitcnt lgkmcnt(0)
    v_mfma_f32_32x32x16_bf16 v[76:91], v[120:123], v[96:99], v[76:91]
    v_add_f32 v124, v124, v146
    v_add_f32 v126, v126, v147
    v_fma_f32 v125, v146, v146, v125
    v_fma_f32 v127, v147, v147, v127
    v_and_b32 v11, 31, v1
    v_lshrrev_b32 v13, 5, v1
    s_lshl_b32 s52, s45, 5
    v_add_u32 v12, s52, v11
    v_lshlrev_b32 v154, 5, v12
    v_add_u32 v154, 0x21000, v154
    v_lshl_add_u32 v152, v13, 3, v154
    v_lshlrev_b32 v155, 2, v11
    v_add_u32 v155, 0x22200, v155
    v_and_b32 v12, 1, v1
    v_lshlrev_b32 v12, 6, v12
    v_lshrrev_b32 v13, 4, v1
    v_lshl_add_u32 v153, v13, 4, v12
    s_lshl_b32 s52, s45, 7
    s_add_u32 s52, s52, 0x22200
    v_add_u32 v153, s52, v153
    v_add_f32 v124, v124, v126
    v_add_f32 v125, v125, v127
    ds_write_b64 v152, v[124:125] offset:16
    s_mov_b32 exec_lo, 0x30003
    s_mov_b32 exec_hi, 0x30003
    ds_write_b128 v153, v[128:131]
    ds_write_b128 v153, v[132:135] offset:1024
    ds_write_b128 v153, v[136:139] offset:2048
    s_mov_b64 exec, -1
    s_waitcnt lgkmcnt(0)
    s_barrier
    ds_read_b128 v[156:159], v154
    ds_read_b128 v[160:163], v154 offset:16
    ds_read_b32 v172, v155
    ds_read_b32 v173, v155 offset:128
    ds_read_b32 v174, v155 offset:256
    ds_read_b32 v175, v155 offset:384
    ds_read_b32 v176, v155 offset:1024
    ds_read_b32 v177, v155 offset:1152
    ds_read_b32 v178, v155 offset:1280
    ds_read_b32 v179, v155 offset:1408
    ds_read_b32 v180, v155 offset:2048
    ds_read_b32 v181, v155 offset:2176
    ds_read_b32 v182, v155 offset:2304
    ds_read_b32 v183, v155 offset:2432
    s_waitcnt lgkmcnt(13)
    v_add_f32 v156, v156, v158
    v_add_f32 v157, v157, v159
    s_waitcnt lgkmcnt(12)
    v_add_f32 v160, v160, v162
    v_add_f32 v161, v161, v163
    v_add_f32 v156, v156, v160
    v_add_f32 v157, v157, v161
    v_mul_f32 v191, 0x3b000000, v156
    v_mul_f32 v189, 0x3b000000, v157
    v_fma_f32 v189, -v191, v191, v189
    v_cvt_pk_bf16_f32 v92, -v191, -v191
    v_cmp_gt_u32 vcc, 32, v1
    v_mov_b32 v94, 0
    v_mov_b32 v95, 0
    v_cndmask_b32 v92, v94, v92, vcc
    v_and_b32 v93, 0xffff, v92
    v_cvt_pk_bf16_f32 v189, v189, v189
    v_lshlrev_b32 v189, 16, v189
    v_add_f32 v189, 0x3727c5ac, v189
    v_cvt_pk_bf16_f32 v189, v189, v189
    v_lshlrev_b32 v189, 16, v189
    v_sqrt_f32 v189, v189
    s_nop 0
    v_cvt_pk_bf16_f32 v189, v189, v189
    v_lshlrev_b32 v189, 16, v189
    v_rcp_f32 v190, v189
    s_mov_b32 s55, 0x7060302
    s_waitcnt lgkmcnt(10)
    v_add_f32 v172, v172, v173
    s_waitcnt lgkmcnt(8)
    v_add_f32 v174, v174, v175
    v_add_f32 v172, v172, v174
    v_and_b32 v173, s60, v172
    v_sub_f32 v173, v172, v173
    v_and_b32 v174, s60, v173
    v_sub_f32 v174, v173, v174
    v_perm_b32 v100, v173, v172, s55
    v_lshrrev_b32 v101, 16, v174
    v_mov_b32 v102, 0
    v_mov_b32 v103, 0
    s_nop 1
    v_mfma_f32_32x32x16_bf16 v[44:59], v[100:103], v[92:95], v[44:59]
    s_waitcnt lgkmcnt(6)
    v_add_f32 v176, v176, v177
    s_waitcnt lgkmcnt(4)
    v_add_f32 v178, v178, v179
    v_add_f32 v176, v176, v178
    v_and_b32 v177, s60, v176
    v_sub_f32 v177, v176, v177
    v_and_b32 v178, s60, v177
    v_sub_f32 v178, v177, v178
    v_perm_b32 v104, v177, v176, s55
    v_lshrrev_b32 v105, 16, v178
    v_mov_b32 v106, 0
    v_mov_b32 v107, 0
    s_nop 1
    v_mfma_f32_32x32x16_bf16 v[60:75], v[104:107], v[92:95], v[60:75]
    s_waitcnt lgkmcnt(2)
    v_add_f32 v180, v180, v181
    s_waitcnt lgkmcnt(0)
    v_add_f32 v182, v182, v183
    v_add_f32 v180, v180, v182
    v_and_b32 v181, s60, v180
    v_sub_f32 v181, v180, v181
    v_and_b32 v182, s60, v181
    v_sub_f32 v182, v181, v182
    v_perm_b32 v108, v181, v180, s55
    v_lshrrev_b32 v109, 16, v182
    v_mov_b32 v110, 0
    v_mov_b32 v111, 0
    s_nop 1
    v_mfma_f32_32x32x16_bf16 v[76:91], v[108:111], v[92:95], v[76:91]
    v_mul_f32 v188, 0xbfb8aa3b, v190
    s_lshl_b32 s52, s47, 2
    s_add_u32 s52, s52, s45
    s_mul_i32 s52, s52, 0x70
    s_mul_i32 s53, s48, 14
    s_add_u32 s52, s52, s53
    s_add_u32 s52, s52, 2
    s_lshl_b32 s68, s52, 10
    s_mov_b32 s54, 0xbfb8aa3b
    v_mov_b32 v208, 0x30800000
    v_mov_b32 v209, 0x30800000
    v_mul_f32 v189, 0x4e800000, v189
    v_pk_mul_f32 v[192:193], v[188:189], v[44:45] op_sel_hi:[0,1]
    v_pk_mul_f32 v[194:195], v[188:189], v[46:47] op_sel_hi:[0,1]
    v_pk_mul_f32 v[196:197], v[188:189], v[48:49] op_sel_hi:[0,1]
    v_pk_mul_f32 v[198:199], v[188:189], v[50:51] op_sel_hi:[0,1]
    v_exp_f32 v192, v192
    v_exp_f32 v193, v193
    v_exp_f32 v194, v194
    v_exp_f32 v195, v195
    v_exp_f32 v196, v196
    v_exp_f32 v197, v197
    v_exp_f32 v198, v198
    v_exp_f32 v199, v199
    v_pk_fma_f32 v[192:193], v[192:193], v[208:209], v[208:209] clamp
    v_pk_fma_f32 v[194:195], v[194:195], v[208:209], v[208:209] clamp
    v_pk_fma_f32 v[196:197], v[196:197], v[208:209], v[208:209] clamp
    v_pk_fma_f32 v[198:199], v[198:199], v[208:209], v[208:209] clamp
    v_pk_mul_f32 v[210:211], v[192:193], v[194:195]
    v_pk_mul_f32 v[212:213], v[196:197], v[198:199]
    v_mul_f32 v214, v210, v211
    v_mul_f32 v216, v212, v213
    v_mul_f32 v214, v214, v189
    v_mul_f32 v216, v216, v189
    v_rcp_f32 v214, v214
    v_rcp_f32 v216, v216
    v_pk_mul_f32 v[44:45], v[44:45], v[194:195]
    v_pk_mul_f32 v[46:47], v[46:47], v[192:193]
    v_pk_mul_f32 v[48:49], v[48:49], v[198:199]
    v_pk_mul_f32 v[50:51], v[50:51], v[196:197]
    v_pk_mul_f32 v[210:211], v[210:211], v[214:215] op_sel:[1,0] op_sel_hi:[0,0]
    v_pk_mul_f32 v[212:213], v[212:213], v[216:217] op_sel:[1,0] op_sel_hi:[0,0]
    v_pk_mul_f32 v[44:45], v[44:45], v[210:211]
    v_pk_mul_f32 v[46:47], v[46:47], v[210:211]
    v_pk_mul_f32 v[48:49], v[48:49], v[212:213]
    v_pk_mul_f32 v[50:51], v[50:51], v[212:213]
    v_cvt_pk_bf16_f32 v200, v44, v45
    v_cvt_pk_bf16_f32 v201, v46, v47
    v_cvt_pk_bf16_f32 v202, v48, v49
    v_cvt_pk_bf16_f32 v203, v50, v51
    buffer_store_dwordx4 v[200:203], v28, s[28:31], s68 offen sc0 sc1
    v_pk_mul_f32 v[192:193], v[188:189], v[52:53] op_sel_hi:[0,1]
    v_pk_mul_f32 v[194:195], v[188:189], v[54:55] op_sel_hi:[0,1]
    v_pk_mul_f32 v[196:197], v[188:189], v[56:57] op_sel_hi:[0,1]
    v_pk_mul_f32 v[198:199], v[188:189], v[58:59] op_sel_hi:[0,1]
    v_exp_f32 v192, v192
    v_exp_f32 v193, v193
    v_exp_f32 v194, v194
    v_exp_f32 v195, v195
    v_exp_f32 v196, v196
    v_exp_f32 v197, v197
    v_exp_f32 v198, v198
    v_exp_f32 v199, v199
    v_pk_fma_f32 v[192:193], v[192:193], v[208:209], v[208:209] clamp
    v_pk_fma_f32 v[194:195], v[194:195], v[208:209], v[208:209] clamp
    v_pk_fma_f32 v[196:197], v[196:197], v[208:209], v[208:209] clamp
    v_pk_fma_f32 v[198:199], v[198:199], v[208:209], v[208:209] clamp
    v_pk_mul_f32 v[210:211], v[192:193], v[194:195]
    v_pk_mul_f32 v[212:213], v[196:197], v[198:199]
    v_mul_f32 v214, v210, v211
    v_mul_f32 v216, v212, v213
    v_mul_f32 v214, v214, v189
    v_mul_f32 v216, v216, v189
    v_rcp_f32 v214, v214
    v_rcp_f32 v216, v216
    v_pk_mul_f32 v[52:53], v[52:53], v[194:195]
    v_pk_mul_f32 v[54:55], v[54:55], v[192:193]
    v_pk_mul_f32 v[56:57], v[56:57], v[198:199]
    v_pk_mul_f32 v[58:59], v[58:59], v[196:197]
    v_pk_mul_f32 v[210:211], v[210:211], v[214:215] op_sel:[1,0] op_sel_hi:[0,0]
    v_pk_mul_f32 v[212:213], v[212:213], v[216:217] op_sel:[1,0] op_sel_hi:[0,0]
    v_pk_mul_f32 v[52:53], v[52:53], v[210:211]
    v_pk_mul_f32 v[54:55], v[54:55], v[210:211]
    v_pk_mul_f32 v[56:57], v[56:57], v[212:213]
    v_pk_mul_f32 v[58:59], v[58:59], v[212:213]
    v_cvt_pk_bf16_f32 v204, v52, v53
    v_cvt_pk_bf16_f32 v205, v54, v55
    v_cvt_pk_bf16_f32 v206, v56, v57
    v_cvt_pk_bf16_f32 v207, v58, v59
    buffer_store_dwordx4 v[204:207], v28, s[28:31], s68 offen offset:1024 sc0 sc1
    s_add_u32 s68, s68, 0x1000
    v_pk_mul_f32 v[192:193], v[188:189], v[60:61] op_sel_hi:[0,1]
    v_pk_mul_f32 v[194:195], v[188:189], v[62:63] op_sel_hi:[0,1]
    v_pk_mul_f32 v[196:197], v[188:189], v[64:65] op_sel_hi:[0,1]
    v_pk_mul_f32 v[198:199], v[188:189], v[66:67] op_sel_hi:[0,1]
    v_exp_f32 v192, v192
    v_exp_f32 v193, v193
    v_exp_f32 v194, v194
    v_exp_f32 v195, v195
    v_exp_f32 v196, v196
    v_exp_f32 v197, v197
    v_exp_f32 v198, v198
    v_exp_f32 v199, v199
    v_pk_fma_f32 v[192:193], v[192:193], v[208:209], v[208:209] clamp
    v_pk_fma_f32 v[194:195], v[194:195], v[208:209], v[208:209] clamp
    v_pk_fma_f32 v[196:197], v[196:197], v[208:209], v[208:209] clamp
    v_pk_fma_f32 v[198:199], v[198:199], v[208:209], v[208:209] clamp
    v_pk_mul_f32 v[210:211], v[192:193], v[194:195]
    v_pk_mul_f32 v[212:213], v[196:197], v[198:199]
    v_mul_f32 v214, v210, v211
    v_mul_f32 v216, v212, v213
    v_mul_f32 v214, v214, v189
    v_mul_f32 v216, v216, v189
    v_rcp_f32 v214, v214
    v_rcp_f32 v216, v216
    v_pk_mul_f32 v[60:61], v[60:61], v[194:195]
    v_pk_mul_f32 v[62:63], v[62:63], v[192:193]
    v_pk_mul_f32 v[64:65], v[64:65], v[198:199]
    v_pk_mul_f32 v[66:67], v[66:67], v[196:197]
    v_pk_mul_f32 v[210:211], v[210:211], v[214:215] op_sel:[1,0] op_sel_hi:[0,0]
    v_pk_mul_f32 v[212:213], v[212:213], v[216:217] op_sel:[1,0] op_sel_hi:[0,0]
    v_pk_mul_f32 v[60:61], v[60:61], v[210:211]
    v_pk_mul_f32 v[62:63], v[62:63], v[210:211]
    v_pk_mul_f32 v[64:65], v[64:65], v[212:213]
    v_pk_mul_f32 v[66:67], v[66:67], v[212:213]
    v_cvt_pk_bf16_f32 v200, v60, v61
    v_cvt_pk_bf16_f32 v201, v62, v63
    v_cvt_pk_bf16_f32 v202, v64, v65
    v_cvt_pk_bf16_f32 v203, v66, v67
    buffer_store_dwordx4 v[200:203], v28, s[28:31], s68 offen sc0 sc1
    v_pk_mul_f32 v[192:193], v[188:189], v[68:69] op_sel_hi:[0,1]
    v_pk_mul_f32 v[194:195], v[188:189], v[70:71] op_sel_hi:[0,1]
    v_pk_mul_f32 v[196:197], v[188:189], v[72:73] op_sel_hi:[0,1]
    v_pk_mul_f32 v[198:199], v[188:189], v[74:75] op_sel_hi:[0,1]
    v_exp_f32 v192, v192
    v_exp_f32 v193, v193
    v_exp_f32 v194, v194
    v_exp_f32 v195, v195
    v_exp_f32 v196, v196
    v_exp_f32 v197, v197
    v_exp_f32 v198, v198
    v_exp_f32 v199, v199
    v_pk_fma_f32 v[192:193], v[192:193], v[208:209], v[208:209] clamp
    v_pk_fma_f32 v[194:195], v[194:195], v[208:209], v[208:209] clamp
    v_pk_fma_f32 v[196:197], v[196:197], v[208:209], v[208:209] clamp
    v_pk_fma_f32 v[198:199], v[198:199], v[208:209], v[208:209] clamp
    v_pk_mul_f32 v[210:211], v[192:193], v[194:195]
    v_pk_mul_f32 v[212:213], v[196:197], v[198:199]
    v_mul_f32 v214, v210, v211
    v_mul_f32 v216, v212, v213
    v_mul_f32 v214, v214, v189
    v_mul_f32 v216, v216, v189
    v_rcp_f32 v214, v214
    v_rcp_f32 v216, v216
    v_pk_mul_f32 v[68:69], v[68:69], v[194:195]
    v_pk_mul_f32 v[70:71], v[70:71], v[192:193]
    v_pk_mul_f32 v[72:73], v[72:73], v[198:199]
    v_pk_mul_f32 v[74:75], v[74:75], v[196:197]
    v_pk_mul_f32 v[210:211], v[210:211], v[214:215] op_sel:[1,0] op_sel_hi:[0,0]
    v_pk_mul_f32 v[212:213], v[212:213], v[216:217] op_sel:[1,0] op_sel_hi:[0,0]
    v_pk_mul_f32 v[68:69], v[68:69], v[210:211]
    v_pk_mul_f32 v[70:71], v[70:71], v[210:211]
    v_pk_mul_f32 v[72:73], v[72:73], v[212:213]
    v_pk_mul_f32 v[74:75], v[74:75], v[212:213]
    v_cvt_pk_bf16_f32 v204, v68, v69
    v_cvt_pk_bf16_f32 v205, v70, v71
    v_cvt_pk_bf16_f32 v206, v72, v73
    v_cvt_pk_bf16_f32 v207, v74, v75
    buffer_store_dwordx4 v[204:207], v28, s[28:31], s68 offen offset:1024 sc0 sc1
    s_add_u32 s68, s68, 0x1000
    v_pk_mul_f32 v[192:193], v[188:189], v[76:77] op_sel_hi:[0,1]
    v_pk_mul_f32 v[194:195], v[188:189], v[78:79] op_sel_hi:[0,1]
    v_pk_mul_f32 v[196:197], v[188:189], v[80:81] op_sel_hi:[0,1]
    v_pk_mul_f32 v[198:199], v[188:189], v[82:83] op_sel_hi:[0,1]
    v_exp_f32 v192, v192
    v_exp_f32 v193, v193
    v_exp_f32 v194, v194
    v_exp_f32 v195, v195
    v_exp_f32 v196, v196
    v_exp_f32 v197, v197
    v_exp_f32 v198, v198
    v_exp_f32 v199, v199
    v_pk_fma_f32 v[192:193], v[192:193], v[208:209], v[208:209] clamp
    v_pk_fma_f32 v[194:195], v[194:195], v[208:209], v[208:209] clamp
    v_pk_fma_f32 v[196:197], v[196:197], v[208:209], v[208:209] clamp
    v_pk_fma_f32 v[198:199], v[198:199], v[208:209], v[208:209] clamp
    v_pk_mul_f32 v[210:211], v[192:193], v[194:195]
    v_pk_mul_f32 v[212:213], v[196:197], v[198:199]
    v_mul_f32 v214, v210, v211
    v_mul_f32 v216, v212, v213
    v_mul_f32 v214, v214, v189
    v_mul_f32 v216, v216, v189
    v_rcp_f32 v214, v214
    v_rcp_f32 v216, v216
    v_pk_mul_f32 v[76:77], v[76:77], v[194:195]
    v_pk_mul_f32 v[78:79], v[78:79], v[192:193]
    v_pk_mul_f32 v[80:81], v[80:81], v[198:199]
    v_pk_mul_f32 v[82:83], v[82:83], v[196:197]
    v_pk_mul_f32 v[210:211], v[210:211], v[214:215] op_sel:[1,0] op_sel_hi:[0,0]
    v_pk_mul_f32 v[212:213], v[212:213], v[216:217] op_sel:[1,0] op_sel_hi:[0,0]
    v_pk_mul_f32 v[76:77], v[76:77], v[210:211]
    v_pk_mul_f32 v[78:79], v[78:79], v[210:211]
    v_pk_mul_f32 v[80:81], v[80:81], v[212:213]
    v_pk_mul_f32 v[82:83], v[82:83], v[212:213]
    v_cvt_pk_bf16_f32 v200, v76, v77
    v_cvt_pk_bf16_f32 v201, v78, v79
    v_cvt_pk_bf16_f32 v202, v80, v81
    v_cvt_pk_bf16_f32 v203, v82, v83
    buffer_store_dwordx4 v[200:203], v28, s[28:31], s68 offen sc0 sc1
    v_pk_mul_f32 v[192:193], v[188:189], v[84:85] op_sel_hi:[0,1]
    v_pk_mul_f32 v[194:195], v[188:189], v[86:87] op_sel_hi:[0,1]
    v_pk_mul_f32 v[196:197], v[188:189], v[88:89] op_sel_hi:[0,1]
    v_pk_mul_f32 v[198:199], v[188:189], v[90:91] op_sel_hi:[0,1]
    v_exp_f32 v192, v192
    v_exp_f32 v193, v193
    v_exp_f32 v194, v194
    v_exp_f32 v195, v195
    v_exp_f32 v196, v196
    v_exp_f32 v197, v197
    v_exp_f32 v198, v198
    v_exp_f32 v199, v199
    v_pk_fma_f32 v[192:193], v[192:193], v[208:209], v[208:209] clamp
    v_pk_fma_f32 v[194:195], v[194:195], v[208:209], v[208:209] clamp
    v_pk_fma_f32 v[196:197], v[196:197], v[208:209], v[208:209] clamp
    v_pk_fma_f32 v[198:199], v[198:199], v[208:209], v[208:209] clamp
    v_pk_mul_f32 v[210:211], v[192:193], v[194:195]
    v_pk_mul_f32 v[212:213], v[196:197], v[198:199]
    v_mul_f32 v214, v210, v211
    v_mul_f32 v216, v212, v213
    v_mul_f32 v214, v214, v189
    v_mul_f32 v216, v216, v189
    v_rcp_f32 v214, v214
    v_rcp_f32 v216, v216
    v_pk_mul_f32 v[84:85], v[84:85], v[194:195]
    v_pk_mul_f32 v[86:87], v[86:87], v[192:193]
    v_pk_mul_f32 v[88:89], v[88:89], v[198:199]
    v_pk_mul_f32 v[90:91], v[90:91], v[196:197]
    v_pk_mul_f32 v[210:211], v[210:211], v[214:215] op_sel:[1,0] op_sel_hi:[0,0]
    v_pk_mul_f32 v[212:213], v[212:213], v[216:217] op_sel:[1,0] op_sel_hi:[0,0]
    v_pk_mul_f32 v[84:85], v[84:85], v[210:211]
    v_pk_mul_f32 v[86:87], v[86:87], v[210:211]
    v_pk_mul_f32 v[88:89], v[88:89], v[212:213]
    v_pk_mul_f32 v[90:91], v[90:91], v[212:213]
    v_cvt_pk_bf16_f32 v204, v84, v85
    v_cvt_pk_bf16_f32 v205, v86, v87
    v_cvt_pk_bf16_f32 v206, v88, v89
    v_cvt_pk_bf16_f32 v207, v90, v91
    buffer_store_dwordx4 v[204:207], v28, s[28:31], s68 offen offset:1024 sc0 sc1
    s_waitcnt vmcnt(0)
    s_endpgm
hh_k1_exit:
    s_endpgm
.globl hh_k2_kernel
.p2align 8
.type hh_k2_kernel,@function
hh_k2_kernel:
    s_cmp_ge_u32 s2, 0x100
    s_cbranch_scc1 hh_k2_exit
    s_load_dwordx2 s[6:7], s[0:1], 72
    s_load_dwordx2 s[4:5], s[0:1], 0
    s_load_dwordx4 s[8:11], s[0:1], 56
    v_lshrrev_b32 v2, 6, v0
    v_and_b32 v1, 63, v0
    v_readfirstlane_b32 s24, v2
    v_lshlrev_b32 v3, 4, v1
    s_cmp_ge_u32 s24, 4
    s_cbranch_scc1 hh_k2_aux
    s_and_b32 s32, s2, 1
    s_bfe_u32 s27, s2, 0x20001
    s_lshl_b32 s27, s27, 2
    s_bfe_u32 s28, s2, 0x20003
    s_or_b32 s25, s27, s28
    s_lshr_b32 s26, s2, 5
    s_mul_i32 s29, s32, 56
    s_lshl_b32 s27, s25, 2
    s_add_u32 s27, s27, s24
    s_mul_i32 s27, s27, 0x70
    s_add_u32 s27, s27, s29
    s_lshl_b32 s34, s27, 10
    s_lshl_b32 s35, s24, 12
    s_lshr_b32 s37, s24, 1
    s_and_b32 s38, s24, 1
    s_lshl_b32 s27, s26, 1
    s_add_u32 s27, s27, s38
    s_mul_i32 s27, s27, 0x90
    s_add_u32 s27, s27, s29
    s_lshl_b32 s28, s37, 1
    s_add_u32 s27, s27, s28
    s_lshl_b32 s27, s27, 10
    s_add_u32 s33, s27, 0xb00000
    s_lshl_b32 s36, s38, 12
    s_lshl_b32 s28, s37, 11
    s_add_u32 s36, s36, s28
    s_waitcnt lgkmcnt(0)
    s_mov_b32 s20, s6
    s_mov_b32 s21, s7
    s_mov_b32 s22, 0x1600000
    s_mov_b32 s23, 0x20000
    s_add_u32 m0, s36, 0x4000
    s_nop 0
    buffer_load_dwordx4 v3, s[20:23], s33 offen lds
    buffer_load_dwordx4 v3, s[20:23], s33 offen offset:1024 lds
    s_add_u32 s33, s33, 0x1000
    s_add_u32 m0, s35, 0
    s_nop 0
    buffer_load_dwordx4 v3, s[20:23], s34 offen lds
    buffer_load_dwordx4 v3, s[20:23], s34 offen offset:1024 lds
    buffer_load_dwordx4 v3, s[20:23], s34 offen offset:2048 lds
    buffer_load_dwordx4 v3, s[20:23], s34 offen offset:3072 lds
    s_add_u32 s34, s34, 0x1000
    s_add_u32 m0, s36, 0xa000
    s_nop 0
    buffer_load_dwordx4 v3, s[20:23], s33 offen lds
    buffer_load_dwordx4 v3, s[20:23], s33 offen offset:1024 lds
    s_add_u32 s33, s33, 0x1000
    s_add_u32 m0, s35, 0x6000
    s_nop 0
    buffer_load_dwordx4 v3, s[20:23], s34 offen lds
    buffer_load_dwordx4 v3, s[20:23], s34 offen offset:1024 lds
    buffer_load_dwordx4 v3, s[20:23], s34 offen offset:2048 lds
    buffer_load_dwordx4 v3, s[20:23], s34 offen offset:3072 lds
    s_add_u32 s34, s34, 0x1000
    s_lshl_b32 s27, s37, 12
    s_add_u32 s27, s27, 0x4000
    v_add_u32 v76, s27, v3
    s_lshl_b32 s27, s38, 1
    s_xor_b32 s28, s32, 0
    s_add_u32 s27, s27, s28
    s_lshl_b32 s27, s27, 12
    v_add_u32 v79, s27, v3
    s_lshl_b32 s27, s38, 1
    s_xor_b32 s28, s32, 1
    s_add_u32 s27, s27, s28
    s_lshl_b32 s27, s27, 12
    v_add_u32 v80, s27, v3
    s_waitcnt vmcnt(6)
    s_barrier
    ds_read_b128 v[36:39], v76
    ds_read_b128 v[56:59], v80
    ds_read_b128 v[52:55], v79
    s_waitcnt lgkmcnt(1)
    v_mfma_f32_32x32x16_bf16 v[20:35], v[36:39], v[56:59], 0
    ds_read_b128 v[40:43], v76 offset:1024
    ds_read_b128 v[64:67], v80 offset:1024
    ds_read_b128 v[60:63], v79 offset:1024
    s_add_u32 m0, s36, 0x10000
    s_nop 0
    buffer_load_dwordx4 v3, s[20:23], s33 offen lds
    buffer_load_dwordx4 v3, s[20:23], s33 offen offset:1024 lds
    s_add_u32 s33, s33, 0x1000
    s_waitcnt lgkmcnt(3)
    v_mfma_f32_32x32x16_bf16 v[4:19], v[36:39], v[52:55], 0
    s_add_u32 m0, s35, 0xc000
    s_nop 0
    buffer_load_dwordx4 v3, s[20:23], s34 offen lds
    buffer_load_dwordx4 v3, s[20:23], s34 offen offset:1024 lds
    s_waitcnt lgkmcnt(1)
    v_mfma_f32_32x32x16_bf16 v[20:35], v[40:43], v[64:67], v[20:35]
    ds_read_b128 v[36:39], v76 offset:2048
    ds_read_b128 v[56:59], v80 offset:2048
    ds_read_b128 v[52:55], v79 offset:2048
    buffer_load_dwordx4 v3, s[20:23], s34 offen offset:2048 lds
    buffer_load_dwordx4 v3, s[20:23], s34 offen offset:3072 lds
    s_add_u32 s34, s34, 0x1000
    s_waitcnt lgkmcnt(3)
    v_mfma_f32_32x32x16_bf16 v[4:19], v[40:43], v[60:63], v[4:19]
    s_add_u32 m0, s36, 0x16000
    s_nop 0
    buffer_load_dwordx4 v3, s[20:23], s33 offen lds
    buffer_load_dwordx4 v3, s[20:23], s33 offen offset:1024 lds
    s_add_u32 s33, s33, 0x1000
    v_add_u32 v77, 0xc000, v76
    v_add_u32 v81, 0xc000, v79
    v_add_u32 v82, 0xc000, v80
    v_add_u32 v78, 0x18000, v76
    v_add_u32 v83, 0x18000, v79
    v_add_u32 v84, 0x18000, v80
    s_waitcnt lgkmcnt(1)
    v_mfma_f32_32x32x16_bf16 v[20:35], v[36:39], v[56:59], v[20:35]
    ds_read_b128 v[40:43], v76 offset:3072
    ds_read_b128 v[64:67], v80 offset:3072
    ds_read_b128 v[60:63], v79 offset:3072
    s_add_u32 m0, s35, 0x12000
    s_nop 0
    buffer_load_dwordx4 v3, s[20:23], s34 offen lds
    buffer_load_dwordx4 v3, s[20:23], s34 offen offset:1024 lds
    s_waitcnt lgkmcnt(3)
    v_mfma_f32_32x32x16_bf16 v[4:19], v[36:39], v[52:55], v[4:19]
    buffer_load_dwordx4 v3, s[20:23], s34 offen offset:2048 lds
    buffer_load_dwordx4 v3, s[20:23], s34 offen offset:3072 lds
    s_add_u32 s34, s34, 0x1000
    s_waitcnt lgkmcnt(1)
    v_mfma_f32_32x32x16_bf16 v[20:35], v[40:43], v[64:67], v[20:35]
    s_waitcnt lgkmcnt(0)
    s_waitcnt vmcnt(12)
    s_barrier
    ds_read_b128 v[36:39], v76 offset:24576
    ds_read_b128 v[56:59], v80 offset:24576
    ds_read_b128 v[52:55], v79 offset:24576
    v_mfma_f32_32x32x16_bf16 v[4:19], v[40:43], v[60:63], v[4:19]
    s_add_u32 m0, s36, 0x1c000
    s_nop 0
    buffer_load_dwordx4 v3, s[20:23], s33 offen lds
    buffer_load_dwordx4 v3, s[20:23], s33 offen offset:1024 lds
    s_add_u32 s33, s33, 0x1000
    s_waitcnt lgkmcnt(1)
    v_mfma_f32_32x32x16_bf16 v[20:35], v[36:39], v[56:59], v[20:35]
    ds_read_b128 v[40:43], v76 offset:25600
    ds_read_b128 v[64:67], v80 offset:25600
    ds_read_b128 v[60:63], v79 offset:25600
    s_add_u32 m0, s35, 0x18000
    s_nop 0
    buffer_load_dwordx4 v3, s[20:23], s34 offen lds
    buffer_load_dwordx4 v3, s[20:23], s34 offen offset:1024 lds
    s_waitcnt lgkmcnt(3)
    v_mfma_f32_32x32x16_bf16 v[4:19], v[36:39], v[52:55], v[4:19]
    s_waitcnt lgkmcnt(1)
    v_mfma_f32_32x32x16_bf16 v[20:35], v[40:43], v[64:67], v[20:35]
    ds_read_b128 v[36:39], v76 offset:26624
    ds_read_b128 v[56:59], v80 offset:26624
    ds_read_b128 v[52:55], v79 offset:26624
    buffer_load_dwordx4 v3, s[20:23], s34 offen offset:2048 lds
    buffer_load_dwordx4 v3, s[20:23], s34 offen offset:3072 lds
    s_add_u32 s34, s34, 0x1000
    s_waitcnt lgkmcnt(3)
    v_mfma_f32_32x32x16_bf16 v[4:19], v[40:43], v[60:63], v[4:19]
    s_mov_b32 s12, s4
    s_mov_b32 s13, s5
    s_mov_b32 s14, 0x200000
    s_mov_b32 s15, 0x20000
    s_lshl_b32 s27, s26, 1
    s_add_u32 s27, s27, s38
    s_mul_i32 s27, s27, 0x90
    s_add_u32 s27, s27, 0x70
    s_lshl_b32 s27, s27, 10
    s_add_u32 s40, s27, 0xb00000
    s_mul_i32 s42, s24, 0x1800
    s_lshl_b32 s27, s25, 2
    s_add_u32 s27, s27, s32
    s_lshl_b32 s28, s27, 15
    s_add_u32 s28, s28, 0x1100000
    s_lshl_b32 s29, s38, 16
    s_add_u32 s43, s28, s29
    s_cmp_ge_u32 s24, 2
    s_cselect_b32 s40, s43, s40
    s_lshl_b32 s29, s38, 1
    s_add_u32 s27, s27, s29
    s_lshl_b32 s27, s27, 5
    v_and_b32 v86, 31, v1
    v_add_u32 v86, s27, v86
    v_lshlrev_b32 v86, 10, v86
    s_lshl_b32 s27, s26, 1
    s_add_u32 s27, s27, s37
    s_lshl_b32 s27, s27, 6
    v_add_u32 v86, s27, v86
    v_lshrrev_b32 v85, 5, v1
    v_lshl_add_u32 v86, v85, 3, v86
    s_waitcnt lgkmcnt(1)
    v_mfma_f32_32x32x16_bf16 v[20:35], v[36:39], v[56:59], v[20:35]
    ds_read_b128 v[40:43], v76 offset:27648
    ds_read_b128 v[64:67], v80 offset:27648
    ds_read_b128 v[60:63], v79 offset:27648
    s_waitcnt lgkmcnt(3)
    v_mfma_f32_32x32x16_bf16 v[4:19], v[36:39], v[52:55], v[4:19]
    s_waitcnt lgkmcnt(1)
    v_mfma_f32_32x32x16_bf16 v[20:35], v[40:43], v[64:67], v[20:35]
    s_waitcnt lgkmcnt(0)
    s_waitcnt vmcnt(12)
    s_barrier
    ds_read_b128 v[36:39], v77
    ds_read_b128 v[56:59], v82
    ds_read_b128 v[52:55], v81
    v_mfma_f32_32x32x16_bf16 v[4:19], v[40:43], v[60:63], v[4:19]
    s_add_u32 m0, s36, 0x22000
    s_nop 0
    buffer_load_dwordx4 v3, s[20:23], s33 offen lds
    buffer_load_dwordx4 v3, s[20:23], s33 offen offset:1024 lds
    s_add_u32 s33, s33, 0x1000
    s_waitcnt lgkmcnt(1)
    v_mfma_f32_32x32x16_bf16 v[20:35], v[36:39], v[56:59], v[20:35]
    ds_read_b128 v[40:43], v77 offset:1024
    ds_read_b128 v[64:67], v82 offset:1024
    ds_read_b128 v[60:63], v81 offset:1024
    s_add_u32 m0, s35, 0x1e000
    s_nop 0
    buffer_load_dwordx4 v3, s[20:23], s34 offen lds
    buffer_load_dwordx4 v3, s[20:23], s34 offen offset:1024 lds
    s_waitcnt lgkmcnt(3)
    v_mfma_f32_32x32x16_bf16 v[4:19], v[36:39], v[52:55], v[4:19]
    s_waitcnt lgkmcnt(1)
    v_mfma_f32_32x32x16_bf16 v[20:35], v[40:43], v[64:67], v[20:35]
    ds_read_b128 v[36:39], v77 offset:2048
    ds_read_b128 v[56:59], v82 offset:2048
    ds_read_b128 v[52:55], v81 offset:2048
    buffer_load_dwordx4 v3, s[20:23], s34 offen offset:2048 lds
    buffer_load_dwordx4 v3, s[20:23], s34 offen offset:3072 lds
    s_add_u32 s34, s34, 0x1000
    s_waitcnt lgkmcnt(3)
    v_mfma_f32_32x32x16_bf16 v[4:19], v[40:43], v[60:63], v[4:19]
    s_mov_b32 s16, s8
    s_mov_b32 s17, s9
    s_mov_b32 s18, 0x200000
    s_mov_b32 s19, 0x20000
    s_lshl_b32 s27, s2, 2
    s_add_u32 s27, s27, s24
    s_xor_b32 s28, s27, 4
    s_lshl_b32 s45, s27, 11
    s_add_u32 s45, s45, 0x1400000
    s_lshl_b32 s44, s28, 11
    s_add_u32 s44, s44, 0x1400000
    s_lshl_b32 s47, s27, 2
    s_add_u32 s47, s47, 0x1010000
    s_lshl_b32 s46, s28, 2
    s_add_u32 s46, s46, 0x1010000
    v_mov_b32 v88, 0
    s_lshl_b32 s27, s25, 1
    s_add_u32 s27, s27, s38
    s_lshl_b32 s41, s27, 7
    s_add_u32 s41, s41, 0x1011000
    v_and_b32 v104, 31, v1
    v_lshlrev_b32 v104, 2, v104
    s_mul_i32 s27, s37, 0x1800
    v_add_u32 v89, s27, v3
    s_mul_i32 s27, s38, 0x1800
    s_add_u32 s27, s27, 0x3000
    v_add_u32 v92, s27, v3
    v_add_u32 v90, 0xc000, v89
    v_add_u32 v93, 0xc000, v92
    v_add_u32 v91, 0x18000, v89
    v_add_u32 v94, 0x18000, v92
    s_waitcnt lgkmcnt(1)
    v_mfma_f32_32x32x16_bf16 v[20:35], v[36:39], v[56:59], v[20:35]
    ds_read_b128 v[40:43], v77 offset:3072
    ds_read_b128 v[64:67], v82 offset:3072
    ds_read_b128 v[60:63], v81 offset:3072
    s_waitcnt lgkmcnt(3)
    v_mfma_f32_32x32x16_bf16 v[4:19], v[36:39], v[52:55], v[4:19]
    s_waitcnt lgkmcnt(1)
    v_mfma_f32_32x32x16_bf16 v[20:35], v[40:43], v[64:67], v[20:35]
    s_waitcnt lgkmcnt(0)
    s_waitcnt vmcnt(12)
    s_barrier
    ds_read_b128 v[36:39], v77 offset:24576
    ds_read_b128 v[56:59], v82 offset:24576
    ds_read_b128 v[52:55], v81 offset:24576
    v_mfma_f32_32x32x16_bf16 v[4:19], v[40:43], v[60:63], v[4:19]
    s_add_u32 m0, s36, 0x4000
    s_nop 0
    buffer_load_dwordx4 v3, s[20:23], s33 offen lds
    buffer_load_dwordx4 v3, s[20:23], s33 offen offset:1024 lds
    s_add_u32 s33, s33, 0x1000
    s_waitcnt lgkmcnt(1)
    v_mfma_f32_32x32x16_bf16 v[20:35], v[36:39], v[56:59], v[20:35]
    ds_read_b128 v[40:43], v77 offset:25600
    ds_read_b128 v[64:67], v82 offset:25600
    ds_read_b128 v[60:63], v81 offset:25600
    s_add_u32 m0, s35, 0
    s_nop 0
    buffer_load_dwordx4 v3, s[20:23], s34 offen lds
    buffer_load_dwordx4 v3, s[20:23], s34 offen offset:1024 lds
    s_waitcnt lgkmcnt(3)
    v_mfma_f32_32x32x16_bf16 v[4:19], v[36:39], v[52:55], v[4:19]
    s_waitcnt lgkmcnt(1)
    v_mfma_f32_32x32x16_bf16 v[20:35], v[40:43], v[64:67], v[20:35]
    ds_read_b128 v[36:39], v77 offset:26624
    ds_read_b128 v[56:59], v82 offset:26624
    ds_read_b128 v[52:55], v81 offset:26624
    buffer_load_dwordx4 v3, s[20:23], s34 offen offset:2048 lds
    buffer_load_dwordx4 v3, s[20:23], s34 offen offset:3072 lds
    s_add_u32 s34, s34, 0x1000
    s_waitcnt lgkmcnt(3)
    v_mfma_f32_32x32x16_bf16 v[4:19], v[40:43], v[60:63], v[4:19]
    s_lshl_b32 s27, s25, 2
    s_add_u32 s27, s27, s32
    s_lshl_b32 s28, s37, 1
    s_add_u32 s27, s27, s28
    s_lshl_b32 s27, s27, 15
    s_lshl_b32 s28, s38, 14
    s_add_u32 s27, s27, s28
    s_lshl_b32 s28, s26, 7
    s_add_u32 s49, s27, s28
    v_lshrrev_b32 v85, 3, v1
    v_and_b32 v105, 7, v1
    v_xor_b32 v105, v105, v85
    v_lshlrev_b32 v105, 4, v105
    v_lshl_add_u32 v105, v85, 10, v105
    v_lshrrev_b32 v85, 5, v1
    s_lshl_b32 s27, s37, 2
    v_add_u32 v85, s27, v85
    v_and_b32 v106, 7, v1
    v_xor_b32 v85, v85, v106
    v_lshlrev_b32 v85, 4, v85
    v_and_b32 v106, 15, v1
    v_lshl_add_u32 v85, v106, 7, v85
    v_bfe_u32 v106, v1, 4, 1
    v_mul_u32_u24 v106, 0x1800, v106
    v_add_u32 v106, v106, v85
    s_mul_i32 s27, s38, 0x3000
    s_add_u32 s27, s27, 0x6800
    v_add_u32 v106, s27, v106
    s_waitcnt lgkmcnt(1)
    v_mfma_f32_32x32x16_bf16 v[20:35], v[36:39], v[56:59], v[20:35]
    ds_read_b128 v[40:43], v77 offset:27648
    ds_read_b128 v[64:67], v82 offset:27648
    ds_read_b128 v[60:63], v81 offset:27648
    s_waitcnt lgkmcnt(3)
    v_mfma_f32_32x32x16_bf16 v[4:19], v[36:39], v[52:55], v[4:19]
    s_waitcnt lgkmcnt(1)
    v_mfma_f32_32x32x16_bf16 v[20:35], v[40:43], v[64:67], v[20:35]
    s_waitcnt lgkmcnt(0)
    s_waitcnt vmcnt(12)
    s_barrier
    ds_read_b128 v[36:39], v78
    ds_read_b128 v[56:59], v84
    ds_read_b128 v[52:55], v83
    v_mfma_f32_32x32x16_bf16 v[4:19], v[40:43], v[60:63], v[4:19]
    s_add_u32 m0, s36, 0xa000
    s_nop 0
    buffer_load_dwordx4 v3, s[20:23], s33 offen lds
    buffer_load_dwordx4 v3, s[20:23], s33 offen offset:1024 lds
    s_add_u32 s33, s33, 0x1000
    s_waitcnt lgkmcnt(1)
    v_mfma_f32_32x32x16_bf16 v[20:35], v[36:39], v[56:59], v[20:35]
    ds_read_b128 v[40:43], v78 offset:1024
    ds_read_b128 v[64:67], v84 offset:1024
    ds_read_b128 v[60:63], v83 offset:1024
    s_add_u32 m0, s35, 0x6000
    s_nop 0
    buffer_load_dwordx4 v3, s[20:23], s34 offen lds
    buffer_load_dwordx4 v3, s[20:23], s34 offen offset:1024 lds
    s_waitcnt lgkmcnt(3)
    v_mfma_f32_32x32x16_bf16 v[4:19], v[36:39], v[52:55], v[4:19]
    s_waitcnt lgkmcnt(1)
    v_mfma_f32_32x32x16_bf16 v[20:35], v[40:43], v[64:67], v[20:35]
    ds_read_b128 v[36:39], v78 offset:2048
    ds_read_b128 v[56:59], v84 offset:2048
    ds_read_b128 v[52:55], v83 offset:2048
    buffer_load_dwordx4 v3, s[20:23], s34 offen offset:2048 lds
    buffer_load_dwordx4 v3, s[20:23], s34 offen offset:3072 lds
    s_add_u32 s34, s34, 0x1000
    s_waitcnt lgkmcnt(3)
    v_mfma_f32_32x32x16_bf16 v[4:19], v[40:43], v[60:63], v[4:19]
    v_and_b32 v85, 31, v1
    v_lshrrev_b32 v87, 5, v1
    v_lshlrev_b32 v87, 3, v87
    v_sub_u32 v85, v85, v87
    v_and_b32 v87, 1, v85
    v_lshlrev_b32 v87, 4, v87
    v_mov_b32 v108, 0x3f80
    v_lshlrev_b32 v87, v87, v108
    v_lshrrev_b32 v85, 1, v85
    v_cmp_eq_u32 vcc, 0, v85
    s_nop 1
    v_cndmask_b32 v108, 0, v87, vcc
    v_cmp_eq_u32 vcc, 1, v85
    s_nop 1
    v_cndmask_b32 v109, 0, v87, vcc
    v_cmp_eq_u32 vcc, 2, v85
    s_nop 1
    v_cndmask_b32 v110, 0, v87, vcc
    v_cmp_eq_u32 vcc, 3, v85
    s_nop 1
    v_cndmask_b32 v111, 0, v87, vcc
    v_cmp_eq_u32 vcc, 8, v85
    s_nop 1
    v_cndmask_b32 v112, 0, v87, vcc
    v_cmp_eq_u32 vcc, 9, v85
    s_nop 1
    v_cndmask_b32 v113, 0, v87, vcc
    v_cmp_eq_u32 vcc, 10, v85
    s_nop 1
    v_cndmask_b32 v114, 0, v87, vcc
    v_cmp_eq_u32 vcc, 11, v85
    s_nop 1
    v_cndmask_b32 v115, 0, v87, vcc
    s_waitcnt lgkmcnt(1)
    v_mfma_f32_32x32x16_bf16 v[20:35], v[36:39], v[56:59], v[20:35]
    ds_read_b128 v[40:43], v78 offset:3072
    ds_read_b128 v[64:67], v84 offset:3072
    ds_read_b128 v[60:63], v83 offset:3072
    s_waitcnt lgkmcnt(3)
    v_mfma_f32_32x32x16_bf16 v[4:19], v[36:39], v[52:55], v[4:19]
    s_waitcnt lgkmcnt(1)
    v_mfma_f32_32x32x16_bf16 v[20:35], v[40:43], v[64:67], v[20:35]
    s_waitcnt lgkmcnt(0)
    s_waitcnt vmcnt(12)
    s_barrier
    ds_read_b128 v[36:39], v78 offset:24576
    ds_read_b128 v[56:59], v84 offset:24576
    ds_read_b128 v[52:55], v83 offset:24576
    v_mfma_f32_32x32x16_bf16 v[4:19], v[40:43], v[60:63], v[4:19]
    s_add_u32 m0, s36, 0x10000
    s_nop 0
    buffer_load_dwordx4 v3, s[20:23], s33 offen lds
    buffer_load_dwordx4 v3, s[20:23], s33 offen offset:1024 lds
    s_add_u32 s33, s33, 0x1000
    s_waitcnt lgkmcnt(1)
    v_mfma_f32_32x32x16_bf16 v[20:35], v[36:39], v[56:59], v[20:35]
    ds_read_b128 v[40:43], v78 offset:25600
    ds_read_b128 v[64:67], v84 offset:25600
    ds_read_b128 v[60:63], v83 offset:25600
    s_add_u32 m0, s35, 0xc000
    s_nop 0
    buffer_load_dwordx4 v3, s[20:23], s34 offen lds
    buffer_load_dwordx4 v3, s[20:23], s34 offen offset:1024 lds
    s_waitcnt lgkmcnt(3)
    v_mfma_f32_32x32x16_bf16 v[4:19], v[36:39], v[52:55], v[4:19]
    s_waitcnt lgkmcnt(1)
    v_mfma_f32_32x32x16_bf16 v[20:35], v[40:43], v[64:67], v[20:35]
    ds_read_b128 v[36:39], v78 offset:26624
    ds_read_b128 v[56:59], v84 offset:26624
    ds_read_b128 v[52:55], v83 offset:26624
    buffer_load_dwordx4 v3, s[20:23], s34 offen offset:2048 lds
    buffer_load_dwordx4 v3, s[20:23], s34 offen offset:3072 lds
    s_add_u32 s34, s34, 0x1000
    s_waitcnt lgkmcnt(3)
    v_mfma_f32_32x32x16_bf16 v[4:19], v[40:43], v[60:63], v[4:19]
    s_waitcnt lgkmcnt(1)
    v_mfma_f32_32x32x16_bf16 v[20:35], v[36:39], v[56:59], v[20:35]
    ds_read_b128 v[40:43], v78 offset:27648
    ds_read_b128 v[64:67], v84 offset:27648
    ds_read_b128 v[60:63], v83 offset:27648
    s_waitcnt lgkmcnt(3)
    v_mfma_f32_32x32x16_bf16 v[4:19], v[36:39], v[52:55], v[4:19]
    s_waitcnt lgkmcnt(1)
    v_mfma_f32_32x32x16_bf16 v[20:35], v[40:43], v[64:67], v[20:35]
    s_waitcnt lgkmcnt(0)
    s_waitcnt vmcnt(12)
    s_barrier
    ds_read_b128 v[36:39], v76
    ds_read_b128 v[56:59], v80
    ds_read_b128 v[52:55], v79
    v_mfma_f32_32x32x16_bf16 v[4:19], v[40:43], v[60:63], v[4:19]
    s_add_u32 m0, s36, 0x16000
    s_nop 0
    buffer_load_dwordx4 v3, s[20:23], s33 offen lds
    buffer_load_dwordx4 v3, s[20:23], s33 offen offset:1024 lds
    s_add_u32 s33, s33, 0x1000
    s_waitcnt lgkmcnt(1)
    v_mfma_f32_32x32x16_bf16 v[20:35], v[36:39], v[56:59], v[20:35]
    ds_read_b128 v[40:43], v76 offset:1024
    ds_read_b128 v[64:67], v80 offset:1024
    ds_read_b128 v[60:63], v79 offset:1024
    s_add_u32 m0, s35, 0x12000
    s_nop 0
    buffer_load_dwordx4 v3, s[20:23], s34 offen lds
    buffer_load_dwordx4 v3, s[20:23], s34 offen offset:1024 lds
    s_waitcnt lgkmcnt(3)
    v_mfma_f32_32x32x16_bf16 v[4:19], v[36:39], v[52:55], v[4:19]
    s_waitcnt lgkmcnt(1)
    v_mfma_f32_32x32x16_bf16 v[20:35], v[40:43], v[64:67], v[20:35]
    ds_read_b128 v[36:39], v76 offset:2048
    ds_read_b128 v[56:59], v80 offset:2048
    ds_read_b128 v[52:55], v79 offset:2048
    buffer_load_dwordx4 v3, s[20:23], s34 offen offset:2048 lds
    buffer_load_dwordx4 v3, s[20:23], s34 offen offset:3072 lds
    s_add_u32 s34, s34, 0x1000
    s_waitcnt lgkmcnt(3)
    v_mfma_f32_32x32x16_bf16 v[4:19], v[40:43], v[60:63], v[4:19]
    s_waitcnt lgkmcnt(1)
    v_mfma_f32_32x32x16_bf16 v[20:35], v[36:39], v[56:59], v[20:35]
    ds_read_b128 v[40:43], v76 offset:3072
    ds_read_b128 v[64:67], v80 offset:3072
    ds_read_b128 v[60:63], v79 offset:3072
    s_waitcnt lgkmcnt(3)
    v_mfma_f32_32x32x16_bf16 v[4:19], v[36:39], v[52:55], v[4:19]
    s_waitcnt lgkmcnt(1)
    v_mfma_f32_32x32x16_bf16 v[20:35], v[40:43], v[64:67], v[20:35]
    s_waitcnt lgkmcnt(0)
    s_waitcnt vmcnt(12)
    s_barrier
    ds_read_b128 v[36:39], v76 offset:24576
    ds_read_b128 v[56:59], v80 offset:24576
    ds_read_b128 v[52:55], v79 offset:24576
    v_mfma_f32_32x32x16_bf16 v[4:19], v[40:43], v[60:63], v[4:19]
    s_add_u32 m0, s36, 0x1c000
    s_nop 0
    buffer_load_dwordx4 v3, s[20:23], s33 offen lds
    buffer_load_dwordx4 v3, s[20:23], s33 offen offset:1024 lds
    s_add_u32 s33, s33, 0x1000
    s_waitcnt lgkmcnt(1)
    v_mfma_f32_32x32x16_bf16 v[20:35], v[36:39], v[56:59], v[20:35]
    ds_read_b128 v[40:43], v76 offset:25600
    ds_read_b128 v[64:67], v80 offset:25600
    ds_read_b128 v[60:63], v79 offset:25600
    s_add_u32 m0, s35, 0x18000
    s_nop 0
    buffer_load_dwordx4 v3, s[20:23], s34 offen lds
    buffer_load_dwordx4 v3, s[20:23], s34 offen offset:1024 lds
    s_waitcnt lgkmcnt(3)
    v_mfma_f32_32x32x16_bf16 v[4:19], v[36:39], v[52:55], v[4:19]
    s_waitcnt lgkmcnt(1)
    v_mfma_f32_32x32x16_bf16 v[20:35], v[40:43], v[64:67], v[20:35]
    ds_read_b128 v[36:39], v76 offset:26624
    ds_read_b128 v[56:59], v80 offset:26624
    ds_read_b128 v[52:55], v79 offset:26624
    buffer_load_dwordx4 v3, s[20:23], s34 offen offset:2048 lds
    buffer_load_dwordx4 v3, s[20:23], s34 offen offset:3072 lds
    s_add_u32 s34, s34, 0x1000
    s_waitcnt lgkmcnt(3)
    v_mfma_f32_32x32x16_bf16 v[4:19], v[40:43], v[60:63], v[4:19]
    s_waitcnt lgkmcnt(1)
    v_mfma_f32_32x32x16_bf16 v[20:35], v[36:39], v[56:59], v[20:35]
    ds_read_b128 v[40:43], v76 offset:27648
    ds_read_b128 v[64:67], v80 offset:27648
    ds_read_b128 v[60:63], v79 offset:27648
    s_waitcnt lgkmcnt(3)
    v_mfma_f32_32x32x16_bf16 v[4:19], v[36:39], v[52:55], v[4:19]
    s_waitcnt lgkmcnt(1)
    v_mfma_f32_32x32x16_bf16 v[20:35], v[40:43], v[64:67], v[20:35]
    s_waitcnt lgkmcnt(0)
    s_waitcnt vmcnt(12)
    s_barrier
    ds_read_b128 v[36:39], v77
    ds_read_b128 v[56:59], v82
    ds_read_b128 v[52:55], v81
    v_mfma_f32_32x32x16_bf16 v[4:19], v[40:43], v[60:63], v[4:19]
    s_add_u32 m0, s36, 0x22000
    s_nop 0
    buffer_load_dwordx4 v3, s[20:23], s33 offen lds
    buffer_load_dwordx4 v3, s[20:23], s33 offen offset:1024 lds
    s_add_u32 s33, s33, 0x1000
    s_waitcnt lgkmcnt(1)
    v_mfma_f32_32x32x16_bf16 v[20:35], v[36:39], v[56:59], v[20:35]
    ds_read_b128 v[40:43], v77 offset:1024
    ds_read_b128 v[64:67], v82 offset:1024
    ds_read_b128 v[60:63], v81 offset:1024
    s_add_u32 m0, s35, 0x1e000
    s_nop 0
    buffer_load_dwordx4 v3, s[20:23], s34 offen lds
    buffer_load_dwordx4 v3, s[20:23], s34 offen offset:1024 lds
    s_waitcnt lgkmcnt(3)
    v_mfma_f32_32x32x16_bf16 v[4:19], v[36:39], v[52:55], v[4:19]
    s_waitcnt lgkmcnt(1)
    v_mfma_f32_32x32x16_bf16 v[20:35], v[40:43], v[64:67], v[20:35]
    ds_read_b128 v[36:39], v77 offset:2048
    ds_read_b128 v[56:59], v82 offset:2048
    ds_read_b128 v[52:55], v81 offset:2048
    buffer_load_dwordx4 v3, s[20:23], s34 offen offset:2048 lds
    buffer_load_dwordx4 v3, s[20:23], s34 offen offset:3072 lds
    s_add_u32 s34, s34, 0x1000
    s_waitcnt lgkmcnt(3)
    v_mfma_f32_32x32x16_bf16 v[4:19], v[40:43], v[60:63], v[4:19]
    s_waitcnt lgkmcnt(1)
    v_mfma_f32_32x32x16_bf16 v[20:35], v[36:39], v[56:59], v[20:35]
    ds_read_b128 v[40:43], v77 offset:3072
    ds_read_b128 v[64:67], v82 offset:3072
    ds_read_b128 v[60:63], v81 offset:3072
    s_waitcnt lgkmcnt(3)
    v_mfma_f32_32x32x16_bf16 v[4:19], v[36:39], v[52:55], v[4:19]
    s_waitcnt lgkmcnt(1)
    v_mfma_f32_32x32x16_bf16 v[20:35], v[40:43], v[64:67], v[20:35]
    s_waitcnt lgkmcnt(0)
    s_waitcnt vmcnt(12)
    s_barrier
    ds_read_b128 v[36:39], v77 offset:24576
    ds_read_b128 v[56:59], v82 offset:24576
    ds_read_b128 v[52:55], v81 offset:24576
    v_mfma_f32_32x32x16_bf16 v[4:19], v[40:43], v[60:63], v[4:19]
    s_add_u32 m0, s36, 0x4000
    s_nop 0
    buffer_load_dwordx4 v3, s[20:23], s33 offen lds
    buffer_load_dwordx4 v3, s[20:23], s33 offen offset:1024 lds
    s_add_u32 s33, s33, 0x1000
    s_waitcnt lgkmcnt(1)
    v_mfma_f32_32x32x16_bf16 v[20:35], v[36:39], v[56:59], v[20:35]
    ds_read_b128 v[40:43], v77 offset:25600
    ds_read_b128 v[64:67], v82 offset:25600
    ds_read_b128 v[60:63], v81 offset:25600
    s_add_u32 m0, s35, 0
    s_nop 0
    buffer_load_dwordx4 v3, s[20:23], s34 offen lds
    buffer_load_dwordx4 v3, s[20:23], s34 offen offset:1024 lds
    s_waitcnt lgkmcnt(3)
    v_mfma_f32_32x32x16_bf16 v[4:19], v[36:39], v[52:55], v[4:19]
    s_waitcnt lgkmcnt(1)
    v_mfma_f32_32x32x16_bf16 v[20:35], v[40:43], v[64:67], v[20:35]
    ds_read_b128 v[36:39], v77 offset:26624
    ds_read_b128 v[56:59], v82 offset:26624
    ds_read_b128 v[52:55], v81 offset:26624
    buffer_load_dwordx4 v3, s[20:23], s34 offen offset:2048 lds
    buffer_load_dwordx4 v3, s[20:23], s34 offen offset:3072 lds
    s_add_u32 s34, s34, 0x1000
    s_waitcnt lgkmcnt(3)
    v_mfma_f32_32x32x16_bf16 v[4:19], v[40:43], v[60:63], v[4:19]
    s_waitcnt lgkmcnt(1)
    v_mfma_f32_32x32x16_bf16 v[20:35], v[36:39], v[56:59], v[20:35]
    ds_read_b128 v[40:43], v77 offset:27648
    ds_read_b128 v[64:67], v82 offset:27648
    ds_read_b128 v[60:63], v81 offset:27648
    s_waitcnt lgkmcnt(3)
    v_mfma_f32_32x32x16_bf16 v[4:19], v[36:39], v[52:55], v[4:19]
    s_waitcnt lgkmcnt(1)
    v_mfma_f32_32x32x16_bf16 v[20:35], v[40:43], v[64:67], v[20:35]
    s_waitcnt lgkmcnt(0)
    s_waitcnt vmcnt(12)
    s_barrier
    ds_read_b128 v[36:39], v78
    ds_read_b128 v[56:59], v84
    ds_read_b128 v[52:55], v83
    v_mfma_f32_32x32x16_bf16 v[4:19], v[40:43], v[60:63], v[4:19]
    buffer_load_dword v87, v104, s[20:23], s41 offen sc1
    s_add_u32 m0, s36, 0xa000
    s_nop 0
    buffer_load_dwordx4 v3, s[20:23], s33 offen lds
    buffer_load_dwordx4 v3, s[20:23], s33 offen offset:1024 lds
    s_waitcnt lgkmcnt(1)
    v_mfma_f32_32x32x16_bf16 v[20:35], v[36:39], v[56:59], v[20:35]
    ds_read_b128 v[40:43], v78 offset:1024
    ds_read_b128 v[64:67], v84 offset:1024
    ds_read_b128 v[60:63], v83 offset:1024
    s_add_u32 m0, s35, 0x6000
    s_nop 0
    buffer_load_dwordx4 v3, s[20:23], s34 offen lds
    buffer_load_dwordx4 v3, s[20:23], s34 offen offset:1024 lds
    s_waitcnt lgkmcnt(3)
    v_mfma_f32_32x32x16_bf16 v[4:19], v[36:39], v[52:55], v[4:19]
    s_waitcnt lgkmcnt(1)
    v_mfma_f32_32x32x16_bf16 v[20:35], v[40:43], v[64:67], v[20:35]
    ds_read_b128 v[36:39], v78 offset:2048
    ds_read_b128 v[56:59], v84 offset:2048
    ds_read_b128 v[52:55], v83 offset:2048
    buffer_load_dwordx4 v3, s[20:23], s34 offen offset:2048 lds
    buffer_load_dwordx4 v3, s[20:23], s34 offen offset:3072 lds
    s_waitcnt lgkmcnt(3)
    v_mfma_f32_32x32x16_bf16 v[4:19], v[40:43], v[60:63], v[4:19]
    s_waitcnt lgkmcnt(1)
    v_mfma_f32_32x32x16_bf16 v[20:35], v[36:39], v[56:59], v[20:35]
    ds_read_b128 v[40:43], v78 offset:3072
    ds_read_b128 v[64:67], v84 offset:3072
    ds_read_b128 v[60:63], v83 offset:3072
    s_waitcnt lgkmcnt(3)
    v_mfma_f32_32x32x16_bf16 v[4:19], v[36:39], v[52:55], v[4:19]
    s_waitcnt lgkmcnt(1)
    v_mfma_f32_32x32x16_bf16 v[20:35], v[40:43], v[64:67], v[20:35]
    s_waitcnt lgkmcnt(0)
    s_waitcnt vmcnt(13)
    s_barrier
    ds_read_b128 v[36:39], v78 offset:24576
    ds_read_b128 v[56:59], v84 offset:24576
    ds_read_b128 v[52:55], v83 offset:24576
    v_mfma_f32_32x32x16_bf16 v[4:19], v[40:43], v[60:63], v[4:19]
    s_waitcnt vmcnt(6)
    v_cmp_eq_u32 vcc, -1, v87
    s_cbranch_vccnz hh_k2_slowo
hh_k2_backo:
    s_add_u32 m0, s42, 0xc000
    s_nop 0
    buffer_load_dwordx4 v3, s[20:23], s40 offen lds
    buffer_load_dwordx4 v3, s[20:23], s40 offen offset:1024 lds
    s_waitcnt lgkmcnt(1)
    v_mfma_f32_32x32x16_bf16 v[20:35], v[36:39], v[56:59], v[20:35]
    ds_read_b128 v[40:43], v78 offset:25600
    ds_read_b128 v[64:67], v84 offset:25600
    ds_read_b128 v[60:63], v83 offset:25600
    buffer_load_dwordx4 v3, s[20:23], s40 offen offset:2048 lds
    buffer_load_dwordx4 v3, s[20:23], s40 offen offset:3072 lds
    s_add_u32 s40, s40, 0x1000
    s_waitcnt lgkmcnt(3)
    v_mfma_f32_32x32x16_bf16 v[4:19], v[36:39], v[52:55], v[4:19]
    s_waitcnt lgkmcnt(1)
    v_mfma_f32_32x32x16_bf16 v[20:35], v[40:43], v[64:67], v[20:35]
    ds_read_b128 v[36:39], v78 offset:26624
    ds_read_b128 v[56:59], v84 offset:26624
    ds_read_b128 v[52:55], v83 offset:26624
    s_add_u32 m0, s42, 0xd000
    s_nop 0
    buffer_load_dwordx4 v3, s[20:23], s40 offen lds
    buffer_load_dwordx4 v3, s[20:23], s40 offen offset:1024 lds
    s_add_u32 s40, s40, 0x800
    s_waitcnt lgkmcnt(3)
    v_mfma_f32_32x32x16_bf16 v[4:19], v[40:43], v[60:63], v[4:19]
    s_waitcnt lgkmcnt(1)
    v_mfma_f32_32x32x16_bf16 v[20:35], v[36:39], v[56:59], v[20:35]
    ds_read_b128 v[40:43], v78 offset:27648
    ds_read_b128 v[64:67], v84 offset:27648
    ds_read_b128 v[60:63], v83 offset:27648
    s_waitcnt lgkmcnt(3)
    v_mfma_f32_32x32x16_bf16 v[4:19], v[36:39], v[52:55], v[4:19]
    s_waitcnt lgkmcnt(1)
    v_mfma_f32_32x32x16_bf16 v[20:35], v[40:43], v[64:67], v[20:35]
    s_waitcnt lgkmcnt(0)
    s_barrier
    ds_read_b128 v[36:39], v76
    ds_read_b128 v[56:59], v80
    ds_read_b128 v[52:55], v79
    v_mfma_f32_32x32x16_bf16 v[4:19], v[40:43], v[60:63], v[4:19]
    s_add_u32 m0, s42, 0x12000
    s_nop 0
    buffer_load_dwordx4 v3, s[20:23], s40 offen lds
    buffer_load_dwordx4 v3, s[20:23], s40 offen offset:1024 lds
    s_waitcnt lgkmcnt(1)
    v_mfma_f32_32x32x16_bf16 v[20:35], v[36:39], v[56:59], v[20:35]
    ds_read_b128 v[40:43], v76 offset:1024
    ds_read_b128 v[64:67], v80 offset:1024
    ds_read_b128 v[60:63], v79 offset:1024
    buffer_load_dwordx4 v3, s[20:23], s40 offen offset:2048 lds
    buffer_load_dwordx4 v3, s[20:23], s40 offen offset:3072 lds
    s_add_u32 s40, s40, 0x1000
    s_waitcnt lgkmcnt(3)
    v_mfma_f32_32x32x16_bf16 v[4:19], v[36:39], v[52:55], v[4:19]
    s_waitcnt lgkmcnt(1)
    v_mfma_f32_32x32x16_bf16 v[20:35], v[40:43], v[64:67], v[20:35]
    ds_read_b128 v[36:39], v76 offset:2048
    ds_read_b128 v[56:59], v80 offset:2048
    ds_read_b128 v[52:55], v79 offset:2048
    s_add_u32 m0, s42, 0x13000
    s_nop 0
    buffer_load_dwordx4 v3, s[20:23], s40 offen lds
    buffer_load_dwordx4 v3, s[20:23], s40 offen offset:1024 lds
    s_add_u32 s40, s40, 0x800
    s_waitcnt lgkmcnt(3)
    v_mfma_f32_32x32x16_bf16 v[4:19], v[40:43], v[60:63], v[4:19]
    s_waitcnt lgkmcnt(1)
    v_mfma_f32_32x32x16_bf16 v[20:35], v[36:39], v[56:59], v[20:35]
    ds_read_b128 v[40:43], v76 offset:3072
    ds_read_b128 v[64:67], v80 offset:3072
    ds_read_b128 v[60:63], v79 offset:3072
    s_waitcnt lgkmcnt(3)
    v_mfma_f32_32x32x16_bf16 v[4:19], v[36:39], v[52:55], v[4:19]
    s_waitcnt lgkmcnt(1)
    v_mfma_f32_32x32x16_bf16 v[20:35], v[40:43], v[64:67], v[20:35]
    s_waitcnt lgkmcnt(0)
    s_waitcnt vmcnt(12)
    s_barrier
    ds_read_b128 v[36:39], v76 offset:24576
    ds_read_b128 v[56:59], v80 offset:24576
    ds_read_b128 v[52:55], v79 offset:24576
    v_mfma_f32_32x32x16_bf16 v[4:19], v[40:43], v[60:63], v[4:19]
    s_add_u32 m0, s42, 0x18000
    s_nop 0
    buffer_load_dwordx4 v3, s[20:23], s40 offen lds
    buffer_load_dwordx4 v3, s[20:23], s40 offen offset:1024 lds
    s_waitcnt lgkmcnt(1)
    v_mfma_f32_32x32x16_bf16 v[20:35], v[36:39], v[56:59], v[20:35]
    ds_read_b128 v[40:43], v76 offset:25600
    ds_read_b128 v[64:67], v80 offset:25600
    ds_read_b128 v[60:63], v79 offset:25600
    buffer_load_dwordx4 v3, s[20:23], s40 offen offset:2048 lds
    buffer_load_dwordx4 v3, s[20:23], s40 offen offset:3072 lds
    s_add_u32 s40, s40, 0x1000
    s_waitcnt lgkmcnt(3)
    v_mfma_f32_32x32x16_bf16 v[4:19], v[36:39], v[52:55], v[4:19]
    s_waitcnt lgkmcnt(1)
    v_mfma_f32_32x32x16_bf16 v[20:35], v[40:43], v[64:67], v[20:35]
    ds_read_b128 v[36:39], v76 offset:26624
    ds_read_b128 v[56:59], v80 offset:26624
    ds_read_b128 v[52:55], v79 offset:26624
    s_add_u32 m0, s42, 0x19000
    s_nop 0
    buffer_load_dwordx4 v3, s[20:23], s40 offen lds
    buffer_load_dwordx4 v3, s[20:23], s40 offen offset:1024 lds
    s_add_u32 s40, s40, 0x800
    s_waitcnt lgkmcnt(3)
    v_mfma_f32_32x32x16_bf16 v[4:19], v[40:43], v[60:63], v[4:19]
    s_waitcnt lgkmcnt(1)
    v_mfma_f32_32x32x16_bf16 v[20:35], v[36:39], v[56:59], v[20:35]
    ds_read_b128 v[40:43], v76 offset:27648
    ds_read_b128 v[64:67], v80 offset:27648
    ds_read_b128 v[60:63], v79 offset:27648
    s_waitcnt lgkmcnt(3)
    v_mfma_f32_32x32x16_bf16 v[4:19], v[36:39], v[52:55], v[4:19]
    s_waitcnt lgkmcnt(1)
    v_mfma_f32_32x32x16_bf16 v[20:35], v[40:43], v[64:67], v[20:35]
    s_waitcnt lgkmcnt(0)
    s_waitcnt vmcnt(12)
    s_barrier
    ds_read_b128 v[116:119], v93
    ds_read_b128 v[120:123], v93 offset:1024
    ds_read_b128 v[124:127], v93 offset:2048
    ds_read_b128 v[128:131], v93 offset:3072
    ds_read_b128 v[132:135], v93 offset:4096
    ds_read_b128 v[136:139], v93 offset:5120
    ds_read_b128 v[164:167], v90
    ds_read_b128 v[168:171], v90 offset:1024
    ds_read_b128 v[172:175], v90 offset:2048
    ds_read_b128 v[176:179], v90 offset:3072
    ds_read_b128 v[180:183], v90 offset:4096
    ds_read_b128 v[184:187], v90 offset:5120
    v_mfma_f32_32x32x16_bf16 v[4:19], v[40:43], v[60:63], v[4:19]
    v_cvt_pk_bf16_f32 v96, v20, v21
    v_cvt_pk_bf16_f32 v97, v22, v23
    v_cvt_pk_bf16_f32 v98, v24, v25
    v_cvt_pk_bf16_f32 v99, v26, v27
    v_cvt_pk_bf16_f32 v100, v28, v29
    v_cvt_pk_bf16_f32 v101, v30, v31
    v_cvt_pk_bf16_f32 v102, v32, v33
    v_cvt_pk_bf16_f32 v103, v34, v35
    buffer_store_dwordx4 v[96:99], v3, s[20:23], s44 offen sc1
    buffer_store_dwordx4 v[100:103], v3, s[20:23], s44 offen offset:1024 sc1
    s_add_u32 m0, s42, 0x1e000
    s_nop 0
    buffer_load_dwordx4 v3, s[20:23], s40 offen lds
    buffer_load_dwordx4 v3, s[20:23], s40 offen offset:1024 lds
    buffer_load_dwordx4 v3, s[20:23], s40 offen offset:2048 lds
    buffer_load_dwordx4 v3, s[20:23], s40 offen offset:3072 lds
    s_add_u32 s40, s40, 0x1000
    s_add_u32 m0, s42, 0x1f000
    s_nop 0
    buffer_load_dwordx4 v3, s[20:23], s40 offen lds
    buffer_load_dwordx4 v3, s[20:23], s40 offen offset:1024 lds
    s_add_u32 s40, s40, 0x800
    s_add_u32 m0, s42, 0x6800
    s_nop 0
    buffer_load_dwordx4 v105, s[12:15], s49 offen lds
    s_add_u32 s49, s49, 0x2000
    s_add_u32 m0, s42, 0x6c00
    s_nop 0
    buffer_load_dwordx4 v105, s[12:15], s49 offen lds
    s_waitcnt lgkmcnt(5)
    v_mfma_f32_32x32x16_bf16 v[4:19], v[164:167], v[116:119], v[4:19]
    s_waitcnt lgkmcnt(4)
    v_mfma_f32_32x32x16_bf16 v[4:19], v[168:171], v[120:123], v[4:19]
    s_waitcnt lgkmcnt(0)
    s_waitcnt vmcnt(16)
    s_barrier
    ds_read_b128 v[140:143], v93 offset:24576
    ds_read_b128 v[144:147], v93 offset:25600
    ds_read_b128 v[148:151], v93 offset:26624
    ds_read_b128 v[152:155], v93 offset:27648
    ds_read_b128 v[156:159], v93 offset:28672
    ds_read_b128 v[160:163], v93 offset:29696
    ds_read_b128 v[188:191], v90 offset:24576
    ds_read_b128 v[192:195], v90 offset:25600
    ds_read_b128 v[196:199], v90 offset:26624
    ds_read_b128 v[200:203], v90 offset:27648
    ds_read_b128 v[204:207], v90 offset:28672
    ds_read_b128 v[208:211], v90 offset:29696
    v_mfma_f32_32x32x16_bf16 v[4:19], v[172:175], v[124:127], v[4:19]
    s_add_u32 m0, s42, 0
    s_nop 0
    buffer_load_dwordx4 v3, s[20:23], s40 offen lds
    buffer_load_dwordx4 v3, s[20:23], s40 offen offset:1024 lds
    v_mfma_f32_32x32x16_bf16 v[4:19], v[176:179], v[128:131], v[4:19]
    buffer_load_dwordx4 v3, s[20:23], s40 offen offset:2048 lds
    buffer_load_dwordx4 v3, s[20:23], s40 offen offset:3072 lds
    s_add_u32 s40, s40, 0x1000
    v_mfma_f32_32x32x16_bf16 v[4:19], v[180:183], v[132:135], v[4:19]
    s_add_u32 m0, s42, 0x1000
    s_nop 0
    buffer_load_dwordx4 v3, s[20:23], s40 offen lds
    buffer_load_dwordx4 v3, s[20:23], s40 offen offset:1024 lds
    s_add_u32 s40, s40, 0x800
    v_mfma_f32_32x32x16_bf16 v[4:19], v[184:187], v[136:139], v[4:19]
    s_waitcnt lgkmcnt(5)
    v_mfma_f32_32x32x16_bf16 v[4:19], v[188:191], v[140:143], v[4:19]
    s_waitcnt lgkmcnt(4)
    v_mfma_f32_32x32x16_bf16 v[4:19], v[192:195], v[144:147], v[4:19]
    s_waitcnt lgkmcnt(0)
    s_waitcnt vmcnt(16)
    s_barrier
    ds_read_b128 v[116:119], v94
    ds_read_b128 v[120:123], v94 offset:1024
    ds_read_b128 v[124:127], v94 offset:2048
    ds_read_b128 v[128:131], v94 offset:3072
    ds_read_b128 v[132:135], v94 offset:4096
    ds_read_b128 v[136:139], v94 offset:5120
    ds_read_b128 v[164:167], v91
    ds_read_b128 v[168:171], v91 offset:1024
    ds_read_b128 v[172:175], v91 offset:2048
    ds_read_b128 v[176:179], v91 offset:3072
    ds_read_b128 v[180:183], v91 offset:4096
    ds_read_b128 v[184:187], v91 offset:5120
    v_mfma_f32_32x32x16_bf16 v[4:19], v[196:199], v[148:151], v[4:19]
    s_add_u32 m0, s42, 0x6000
    s_nop 0
    buffer_load_dwordx4 v3, s[20:23], s40 offen lds
    buffer_load_dwordx4 v3, s[20:23], s40 offen offset:1024 lds
    v_mfma_f32_32x32x16_bf16 v[4:19], v[200:203], v[152:155], v[4:19]
    v_mfma_f32_32x32x16_bf16 v[4:19], v[204:207], v[156:159], v[4:19]
    v_mfma_f32_32x32x16_bf16 v[4:19], v[208:211], v[160:163], v[4:19]
    s_waitcnt lgkmcnt(5)
    v_mfma_f32_32x32x16_bf16 v[4:19], v[164:167], v[116:119], v[4:19]
    s_waitcnt lgkmcnt(4)
    v_mfma_f32_32x32x16_bf16 v[4:19], v[168:171], v[120:123], v[4:19]
    s_waitcnt lgkmcnt(0)
    s_waitcnt vmcnt(10)
    s_barrier
    ds_read_b128 v[140:143], v94 offset:24576
    ds_read_b128 v[144:147], v94 offset:25600
    ds_read_b128 v[148:151], v94 offset:26624
    ds_read_b128 v[152:155], v94 offset:27648
    ds_read_b128 v[156:159], v94 offset:28672
    ds_read_b128 v[160:163], v94 offset:29696
    ds_read_b128 v[188:191], v91 offset:24576
    ds_read_b128 v[192:195], v91 offset:25600
    ds_read_b128 v[196:199], v91 offset:26624
    ds_read_b128 v[200:203], v91 offset:27648
    ds_read_b128 v[204:207], v91 offset:28672
    ds_read_b128 v[208:211], v91 offset:29696
    v_mfma_f32_32x32x16_bf16 v[4:19], v[172:175], v[124:127], v[4:19]
    v_mfma_f32_32x32x16_bf16 v[4:19], v[176:179], v[128:131], v[4:19]
    v_mfma_f32_32x32x16_bf16 v[4:19], v[180:183], v[132:135], v[4:19]
    v_mfma_f32_32x32x16_bf16 v[4:19], v[184:187], v[136:139], v[4:19]
    buffer_load_dwordx4 v[96:99], v3, s[20:23], s45 offen sc1
    buffer_load_dwordx4 v[100:103], v3, s[20:23], s45 offen offset:1024 sc1
    s_waitcnt lgkmcnt(5)
    v_mfma_f32_32x32x16_bf16 v[4:19], v[188:191], v[140:143], v[4:19]
    s_waitcnt lgkmcnt(4)
    v_mfma_f32_32x32x16_bf16 v[4:19], v[192:195], v[144:147], v[4:19]
    s_waitcnt lgkmcnt(0)
    s_waitcnt vmcnt(4)
    s_barrier
    ds_read_b128 v[116:119], v92
    ds_read_b128 v[120:123], v92 offset:1024
    ds_read_b128 v[124:127], v92 offset:2048
    ds_read_b128 v[128:131], v92 offset:3072
    ds_read_b128 v[132:135], v92 offset:4096
    ds_read_b128 v[136:139], v92 offset:5120
    ds_read_b128 v[164:167], v89
    ds_read_b128 v[168:171], v89 offset:1024
    ds_read_b128 v[172:175], v89 offset:2048
    ds_read_b128 v[176:179], v89 offset:3072
    ds_read_b128 v[180:183], v89 offset:4096
    ds_read_b128 v[184:187], v89 offset:5120
    v_mfma_f32_32x32x16_bf16 v[4:19], v[196:199], v[148:151], v[4:19]
    v_mfma_f32_32x32x16_bf16 v[4:19], v[200:203], v[152:155], v[4:19]
    v_mfma_f32_32x32x16_bf16 v[4:19], v[204:207], v[156:159], v[4:19]
    v_mfma_f32_32x32x16_bf16 v[4:19], v[208:211], v[160:163], v[4:19]
    s_waitcnt lgkmcnt(5)
    v_mfma_f32_32x32x16_bf16 v[4:19], v[164:167], v[116:119], v[4:19]
    s_waitcnt lgkmcnt(4)
    v_mfma_f32_32x32x16_bf16 v[4:19], v[168:171], v[120:123], v[4:19]
    s_waitcnt lgkmcnt(0)
    s_waitcnt vmcnt(2)
    s_barrier
    ds_read_b128 v[140:143], v92 offset:24576
    ds_read_b128 v[144:147], v92 offset:25600
    ds_read_b128 v[188:191], v89 offset:24576
    ds_read_b128 v[192:195], v89 offset:25600
    v_xor_b32 v105, 32, v106
    ds_read_b128 v[68:71], v106
    ds_read_b128 v[72:75], v105
    v_mfma_f32_32x32x16_bf16 v[4:19], v[172:175], v[124:127], v[4:19]
    v_mfma_f32_32x32x16_bf16 v[4:19], v[176:179], v[128:131], v[4:19]
    v_mfma_f32_32x32x16_bf16 v[4:19], v[180:183], v[132:135], v[4:19]
    v_mfma_f32_32x32x16_bf16 v[4:19], v[184:187], v[136:139], v[4:19]
    s_waitcnt lgkmcnt(3)
    v_mfma_f32_32x32x16_bf16 v[4:19], v[188:191], v[140:143], v[4:19]
    s_waitcnt lgkmcnt(2)
    v_mfma_f32_32x32x16_bf16 v[4:19], v[192:195], v[144:147], v[4:19]
    s_waitcnt lgkmcnt(1)
    v_mfma_f32_32x32x16_bf16 v[4:19], v[108:111], v[68:71], v[4:19]
    s_waitcnt lgkmcnt(0)
    v_mfma_f32_32x32x16_bf16 v[4:19], v[112:115], v[72:75], v[4:19]
    s_waitcnt vmcnt(1)
    v_max3_u32 v85, v96, v97, v98
    s_waitcnt vmcnt(0)
    v_max3_u32 v85, v85, v99, v100
    v_max3_u32 v85, v85, v101, v102
    v_max_u32 v85, v85, v103
    v_cmp_eq_u32 vcc, -1, v85
    s_cbranch_vccnz hh_k2_slowx
hh_k2_backx:
    v_lshlrev_b32 v20, 16, v96
    v_and_b32 v21, 0xffff0000, v96
    v_lshlrev_b32 v22, 16, v97
    v_and_b32 v23, 0xffff0000, v97
    v_lshlrev_b32 v24, 16, v98
    v_and_b32 v25, 0xffff0000, v98
    v_lshlrev_b32 v26, 16, v99
    v_and_b32 v27, 0xffff0000, v99
    v_lshlrev_b32 v28, 16, v100
    v_and_b32 v29, 0xffff0000, v100
    v_lshlrev_b32 v30, 16, v101
    v_and_b32 v31, 0xffff0000, v101
    v_lshlrev_b32 v32, 16, v102
    v_and_b32 v33, 0xffff0000, v102
    v_lshlrev_b32 v34, 16, v103
    v_and_b32 v35, 0xffff0000, v103
    v_add_f32 v20, v20, v4
    v_add_f32 v21, v21, v5
    v_add_f32 v22, v22, v6
    v_add_f32 v23, v23, v7
    v_add_f32 v24, v24, v8
    v_add_f32 v25, v25, v9
    v_add_f32 v26, v26, v10
    v_add_f32 v27, v27, v11
    v_add_f32 v28, v28, v12
    v_add_f32 v29, v29, v13
    v_add_f32 v30, v30, v14
    v_add_f32 v31, v31, v15
    v_add_f32 v32, v32, v16
    v_add_f32 v33, v33, v17
    v_add_f32 v34, v34, v18
    v_add_f32 v35, v35, v19
    v_cvt_pk_bf16_f32 v52, v20, v21
    v_cvt_pk_bf16_f32 v53, v22, v23
    v_cvt_pk_bf16_f32 v54, v24, v25
    v_cvt_pk_bf16_f32 v55, v26, v27
    v_cvt_pk_bf16_f32 v56, v28, v29
    v_cvt_pk_bf16_f32 v57, v30, v31
    v_cvt_pk_bf16_f32 v58, v32, v33
    v_cvt_pk_bf16_f32 v59, v34, v35
    v_permlane32_swap_b32 v52, v54
    v_permlane32_swap_b32 v56, v58
    v_permlane32_swap_b32 v53, v55
    v_permlane32_swap_b32 v57, v59
    v_lshrrev_b32 v85, 5, v1
    v_lshl_add_u32 v86, v85, 3, v86
    buffer_store_dwordx4 v[52:55], v86, s[16:19], 0 offen
    buffer_store_dwordx4 v[56:59], v86, s[16:19], 0 offen offset:32
    s_lshl_b32 s29, s2, 3
    s_add_u32 s29, s29, s24
    s_endpgm
hh_k2_aux:
    s_setprio 3
    v_and_b32 v4, 3, v1
    v_lshlrev_b32 v4, 4, v4
    v_lshrrev_b32 v2, 2, v1
    v_lshl_add_u32 v6, v2, 16, v4
    s_lshl_b32 s32, s2, 8
    s_lshl_b32 s29, s24, 6
    s_add_u32 s32, s32, s29
    s_add_u32 s32, s32, 0xdfff00
    s_waitcnt lgkmcnt(0)
    s_mov_b32 s20, s6
    s_mov_b32 s21, s7
    s_mov_b32 s22, 0x1600000
    s_mov_b32 s23, 0x20000
    buffer_load_dwordx4 v[8:11], v6, s[20:23], s32 offen
    s_mov_b32 s41, s27
    s_and_b32 s27, s2, 7
    s_lshl_b32 s27, s27, 2
    s_bfe_u32 s28, s2, 0x20003
    s_or_b32 s25, s27, s28
    s_lshr_b32 s26, s2, 5
    s_lshl_b32 s33, s26, 2
    s_add_u32 s33, s33, s24
    s_sub_u32 s33, s33, 4
    s_lshl_b32 s27, s25, 1
    s_lshl_b32 s27, s27, 5
    s_add_u32 s27, s27, s33
    s_lshl_b32 s28, s27, 10
    s_add_u32 s36, s28, 0x700000
    s_add_u32 s38, s28, 0x1100000
    s_lshl_b32 s27, s25, 1
    s_add_u32 s27, s27, 1
    s_lshl_b32 s27, s27, 5
    s_add_u32 s27, s27, s33
    s_lshl_b32 s28, s27, 10
    s_add_u32 s37, s28, 0x700000
    s_add_u32 s39, s28, 0x1100000
    s_lshl_b32 s34, s33, 11
    s_add_u32 s34, s34, 0x1000000
    s_lshl_b32 s32, s2, 8
    s_add_u32 s32, s32, s29
    s_add_u32 s32, s32, 0xffff00
    s_waitcnt vmcnt(0)
    v_lshlrev_b32 v64, 16, v8
    v_and_b32 v65, 0xffff0000, v8
    v_lshlrev_b32 v66, 16, v9
    v_and_b32 v67, 0xffff0000, v9
    v_lshlrev_b32 v68, 16, v10
    v_and_b32 v69, 0xffff0000, v10
    v_lshlrev_b32 v70, 16, v11
    v_and_b32 v71, 0xffff0000, v11
    v_mov_b32 v72, v64
    v_mov_b32 v73, v65
    v_mov_b32 v74, v66
    v_mov_b32 v75, v67
    v_mov_b32 v76, v68
    v_mov_b32 v77, v69
    v_mov_b32 v78, v70
    v_mov_b32 v79, v71
    v_permlane32_swap_b32 v64, v72
    v_permlane32_swap_b32 v65, v73
    v_permlane32_swap_b32 v66, v74
    v_permlane32_swap_b32 v67, v75
    v_permlane32_swap_b32 v68, v76
    v_permlane32_swap_b32 v69, v77
    v_permlane32_swap_b32 v70, v78
    v_permlane32_swap_b32 v71, v79
    v_add_f32 v64, v64, v72
    v_add_f32 v65, v65, v73
    v_add_f32 v66, v66, v74
    v_add_f32 v67, v67, v75
    v_add_f32 v68, v68, v76
    v_add_f32 v69, v69, v77
    v_add_f32 v70, v70, v78
    v_add_f32 v71, v71, v79
    v_mov_b32 v72, v64
    v_mov_b32 v73, v65
    v_mov_b32 v74, v66
    v_mov_b32 v75, v67
    v_mov_b32 v76, v68
    v_mov_b32 v77, v69
    v_mov_b32 v78, v70
    v_mov_b32 v79, v71
    v_permlane16_swap_b32 v64, v72
    v_permlane16_swap_b32 v65, v73
    v_permlane16_swap_b32 v66, v74
    v_permlane16_swap_b32 v67, v75
    v_permlane16_swap_b32 v68, v76
    v_permlane16_swap_b32 v69, v77
    v_permlane16_swap_b32 v70, v78
    v_permlane16_swap_b32 v71, v79
    v_add_f32 v64, v64, v72
    v_add_f32 v65, v65, v73
    v_add_f32 v66, v66, v74
    v_add_f32 v67, v67, v75
    v_add_f32 v68, v68, v76
    v_add_f32 v69, v69, v77
    v_add_f32 v70, v70, v78
    v_add_f32 v71, v71, v79
    v_add_f32_dpp v72, v64, v64 row_ror:8 row_mask:0xf bank_mask:0xf
    v_add_f32_dpp v73, v65, v65 row_ror:8 row_mask:0xf bank_mask:0xf
    v_add_f32_dpp v74, v66, v66 row_ror:8 row_mask:0xf bank_mask:0xf
    v_add_f32_dpp v75, v67, v67 row_ror:8 row_mask:0xf bank_mask:0xf
    v_add_f32_dpp v76, v68, v68 row_ror:8 row_mask:0xf bank_mask:0xf
    v_add_f32_dpp v77, v69, v69 row_ror:8 row_mask:0xf bank_mask:0xf
    v_add_f32_dpp v78, v70, v70 row_ror:8 row_mask:0xf bank_mask:0xf
    v_add_f32_dpp v79, v71, v71 row_ror:8 row_mask:0xf bank_mask:0xf
    v_add_f32_dpp v64, v72, v72 row_ror:4 row_mask:0xf bank_mask:0xf
    v_add_f32_dpp v65, v73, v73 row_ror:4 row_mask:0xf bank_mask:0xf
    v_add_f32_dpp v66, v74, v74 row_ror:4 row_mask:0xf bank_mask:0xf
    v_add_f32_dpp v67, v75, v75 row_ror:4 row_mask:0xf bank_mask:0xf
    v_add_f32_dpp v68, v76, v76 row_ror:4 row_mask:0xf bank_mask:0xf
    v_add_f32_dpp v69, v77, v77 row_ror:4 row_mask:0xf bank_mask:0xf
    v_add_f32_dpp v70, v78, v78 row_ror:4 row_mask:0xf bank_mask:0xf
    v_add_f32_dpp v71, v79, v79 row_ror:4 row_mask:0xf bank_mask:0xf
    v_cvt_pk_bf16_f32 v104, v64, v65
    v_cvt_pk_bf16_f32 v105, v66, v67
    v_cvt_pk_bf16_f32 v106, v68, v69
    v_cvt_pk_bf16_f32 v107, v70, v71
    s_mov_b64 exec, 15
    buffer_store_dwordx4 v[104:107], v4, s[20:23], s32 offen sc1
    s_mov_b64 exec, -1
    s_lshl_b32 s27, s33, 10
    s_add_u32 s27, s27, 0x900000
    buffer_load_dwordx4 v[24:27], v3, s[20:23], s27 offen
    buffer_load_dwordx4 v[16:19], v3, s[20:23], s36 offen
    buffer_load_dwordx4 v[20:23], v3, s[20:23], s37 offen
    s_mov_b32 s42, 0x3fb8aa3b
    s_lshl_b32 s43, s25, 5
    s_add_u32 s43, s43, s33
    s_lshl_b32 s43, s43, 2
    s_add_u32 s43, s43, 0x1011000
    s_barrier
    s_barrier
    s_waitcnt vmcnt(1)
    v_mfma_f32_32x32x16_bf16 v[64:79], v[24:27], v[16:19], 0
    s_waitcnt vmcnt(0)
    v_mfma_f32_32x32x16_bf16 v[80:95], v[24:27], v[20:23], 0
    s_nop 9
    v_max3_f32 v28, v64, v65, v66
    v_max3_f32 v28, v28, v67, v68
    v_max3_f32 v28, v28, v69, v70
    v_max3_f32 v28, v28, v71, v72
    v_max3_f32 v28, v28, v73, v74
    v_max3_f32 v28, v28, v75, v76
    v_max3_f32 v28, v28, v77, v78
    v_max_f32 v28, v28, v79
    v_mul_f32 v28, 0xbfb8aa3b, v28
    v_fma_f32 v64, v64, s42, v28
    v_fma_f32 v65, v65, s42, v28
    v_fma_f32 v66, v66, s42, v28
    v_fma_f32 v67, v67, s42, v28
    v_fma_f32 v68, v68, s42, v28
    v_fma_f32 v69, v69, s42, v28
    v_fma_f32 v70, v70, s42, v28
    v_fma_f32 v71, v71, s42, v28
    v_fma_f32 v72, v72, s42, v28
    v_fma_f32 v73, v73, s42, v28
    v_fma_f32 v74, v74, s42, v28
    v_fma_f32 v75, v75, s42, v28
    v_fma_f32 v76, v76, s42, v28
    v_fma_f32 v77, v77, s42, v28
    v_fma_f32 v78, v78, s42, v28
    v_fma_f32 v79, v79, s42, v28
    v_exp_f32 v64, v64
    v_exp_f32 v65, v65
    v_exp_f32 v66, v66
    v_exp_f32 v67, v67
    v_exp_f32 v68, v68
    v_exp_f32 v69, v69
    v_exp_f32 v70, v70
    v_exp_f32 v71, v71
    v_exp_f32 v72, v72
    v_exp_f32 v73, v73
    v_exp_f32 v74, v74
    v_exp_f32 v75, v75
    v_exp_f32 v76, v76
    v_exp_f32 v77, v77
    v_exp_f32 v78, v78
    v_exp_f32 v79, v79
    v_add_f32 v29, v64, v65
    v_add_f32 v29, v29, v66
    v_add_f32 v29, v29, v67
    v_add_f32 v29, v29, v68
    v_add_f32 v29, v29, v69
    v_add_f32 v29, v29, v70
    v_add_f32 v29, v29, v71
    v_add_f32 v29, v29, v72
    v_add_f32 v29, v29, v73
    v_add_f32 v29, v29, v74
    v_add_f32 v29, v29, v75
    v_add_f32 v29, v29, v76
    v_add_f32 v29, v29, v77
    v_add_f32 v29, v29, v78
    v_add_f32 v29, v29, v79
    v_rcp_f32 v29, v29
    s_nop 0
    v_mul_f32 v64, v29, v64
    v_mul_f32 v65, v29, v65
    v_mul_f32 v66, v29, v66
    v_mul_f32 v67, v29, v67
    v_mul_f32 v68, v29, v68
    v_mul_f32 v69, v29, v69
    v_mul_f32 v70, v29, v70
    v_mul_f32 v71, v29, v71
    v_mul_f32 v72, v29, v72
    v_mul_f32 v73, v29, v73
    v_mul_f32 v74, v29, v74
    v_mul_f32 v75, v29, v75
    v_mul_f32 v76, v29, v76
    v_mul_f32 v77, v29, v77
    v_mul_f32 v78, v29, v78
    v_mul_f32 v79, v29, v79
    v_cvt_pk_bf16_f32 v40, v64, v65
    v_cvt_pk_bf16_f32 v41, v66, v67
    v_cvt_pk_bf16_f32 v42, v68, v69
    v_cvt_pk_bf16_f32 v43, v70, v71
    v_cvt_pk_bf16_f32 v44, v72, v73
    v_cvt_pk_bf16_f32 v45, v74, v75
    v_cvt_pk_bf16_f32 v46, v76, v77
    v_cvt_pk_bf16_f32 v47, v78, v79
    s_barrier
    v_max3_f32 v28, v80, v81, v82
    v_max3_f32 v28, v28, v83, v84
    v_max3_f32 v28, v28, v85, v86
    v_max3_f32 v28, v28, v87, v88
    v_max3_f32 v28, v28, v89, v90
    v_max3_f32 v28, v28, v91, v92
    v_max3_f32 v28, v28, v93, v94
    v_max_f32 v28, v28, v95
    v_mul_f32 v28, 0xbfb8aa3b, v28
    v_fma_f32 v80, v80, s42, v28
    v_fma_f32 v81, v81, s42, v28
    v_fma_f32 v82, v82, s42, v28
    v_fma_f32 v83, v83, s42, v28
    v_fma_f32 v84, v84, s42, v28
    v_fma_f32 v85, v85, s42, v28
    v_fma_f32 v86, v86, s42, v28
    v_fma_f32 v87, v87, s42, v28
    v_fma_f32 v88, v88, s42, v28
    v_fma_f32 v89, v89, s42, v28
    v_fma_f32 v90, v90, s42, v28
    v_fma_f32 v91, v91, s42, v28
    v_fma_f32 v92, v92, s42, v28
    v_fma_f32 v93, v93, s42, v28
    v_fma_f32 v94, v94, s42, v28
    v_fma_f32 v95, v95, s42, v28
    v_exp_f32 v80, v80
    v_exp_f32 v81, v81
    v_exp_f32 v82, v82
    v_exp_f32 v83, v83
    v_exp_f32 v84, v84
    v_exp_f32 v85, v85
    v_exp_f32 v86, v86
    v_exp_f32 v87, v87
    v_exp_f32 v88, v88
    v_exp_f32 v89, v89
    v_exp_f32 v90, v90
    v_exp_f32 v91, v91
    v_exp_f32 v92, v92
    v_exp_f32 v93, v93
    v_exp_f32 v94, v94
    v_exp_f32 v95, v95
    v_add_f32 v29, v80, v81
    v_add_f32 v29, v29, v82
    v_add_f32 v29, v29, v83
    v_add_f32 v29, v29, v84
    v_add_f32 v29, v29, v85
    v_add_f32 v29, v29, v86
    v_add_f32 v29, v29, v87
    v_add_f32 v29, v29, v88
    v_add_f32 v29, v29, v89
    v_add_f32 v29, v29, v90
    v_add_f32 v29, v29, v91
    v_add_f32 v29, v29, v92
    v_add_f32 v29, v29, v93
    v_add_f32 v29, v29, v94
    v_add_f32 v29, v29, v95
    v_rcp_f32 v29, v29
    s_nop 0
    v_mul_f32 v80, v29, v80
    v_mul_f32 v81, v29, v81
    v_mul_f32 v82, v29, v82
    v_mul_f32 v83, v29, v83
    v_mul_f32 v84, v29, v84
    v_mul_f32 v85, v29, v85
    v_mul_f32 v86, v29, v86
    v_mul_f32 v87, v29, v87
    v_mul_f32 v88, v29, v88
    v_mul_f32 v89, v29, v89
    v_mul_f32 v90, v29, v90
    v_mul_f32 v91, v29, v91
    v_mul_f32 v92, v29, v92
    v_mul_f32 v93, v29, v93
    v_mul_f32 v94, v29, v94
    v_mul_f32 v95, v29, v95
    v_cvt_pk_bf16_f32 v48, v80, v81
    v_cvt_pk_bf16_f32 v49, v82, v83
    v_cvt_pk_bf16_f32 v50, v84, v85
    v_cvt_pk_bf16_f32 v51, v86, v87
    v_cvt_pk_bf16_f32 v52, v88, v89
    v_cvt_pk_bf16_f32 v53, v90, v91
    v_cvt_pk_bf16_f32 v54, v92, v93
    v_cvt_pk_bf16_f32 v55, v94, v95
    s_mov_b32 s35, 0
    buffer_load_dwordx4 v[56:59], v3, s[20:23], s34 offen
    buffer_load_dwordx4 v[60:63], v3, s[20:23], s34 offen offset:1024
    s_barrier
    s_barrier
hh_k2_kvchk:
    s_add_u32 s35, s35, 1
    s_waitcnt vmcnt(0)
    v_max3_u32 v6, v56, v57, v58
    v_max3_u32 v6, v6, v59, v60
    v_max3_u32 v6, v6, v61, v62
    v_max_u32 v6, v6, v63
    v_cmp_eq_u32 vcc, -1, v6
    s_cmp_ge_u32 s35, 0x1000
    s_cbranch_scc1 hh_k2_kvok
    s_cmp_eq_u64 vcc, 0
    s_cbranch_scc1 hh_k2_kvok
    s_sleep 4
    buffer_load_dwordx4 v[56:59], v3, s[20:23], s34 offen sc1
    buffer_load_dwordx4 v[60:63], v3, s[20:23], s34 offen offset:1024 sc1
    s_branch hh_k2_kvchk
hh_k2_kvok:
    v_mfma_f32_32x32x16_bf16 v[64:79], v[56:59], v[40:43], 0
    v_mfma_f32_32x32x16_bf16 v[80:95], v[56:59], v[48:51], 0
    v_mfma_f32_32x32x16_bf16 v[64:79], v[60:63], v[44:47], v[64:79]
    v_mfma_f32_32x32x16_bf16 v[80:95], v[60:63], v[52:55], v[80:95]
    s_nop 10
    v_add_f32 v7, 0x358637bd, v72
    v_rcp_f32 v7, v7
    s_nop 0
    v_mul_f32 v64, v7, v64
    v_mul_f32 v65, v7, v65
    v_mul_f32 v66, v7, v66
    v_mul_f32 v67, v7, v67
    v_mul_f32 v68, v7, v68
    v_mul_f32 v69, v7, v69
    v_mul_f32 v70, v7, v70
    v_mul_f32 v71, v7, v71
    v_cvt_pk_bf16_f32 v96, v64, v65
    v_cvt_pk_bf16_f32 v97, v66, v67
    v_cvt_pk_bf16_f32 v98, v68, v69
    v_cvt_pk_bf16_f32 v99, v70, v71
    buffer_store_dwordx4 v[96:99], v3, s[20:23], s38 offen sc1
    v_add_f32 v7, 0x358637bd, v88
    v_rcp_f32 v7, v7
    s_nop 0
    v_mul_f32 v80, v7, v80
    v_mul_f32 v81, v7, v81
    v_mul_f32 v82, v7, v82
    v_mul_f32 v83, v7, v83
    v_mul_f32 v84, v7, v84
    v_mul_f32 v85, v7, v85
    v_mul_f32 v86, v7, v86
    v_mul_f32 v87, v7, v87
    v_cvt_pk_bf16_f32 v100, v80, v81
    v_cvt_pk_bf16_f32 v101, v82, v83
    v_cvt_pk_bf16_f32 v102, v84, v85
    v_cvt_pk_bf16_f32 v103, v86, v87
    buffer_store_dwordx4 v[100:103], v3, s[20:23], s39 offen sc1
    v_mov_b32 v7, 0
    s_barrier
    s_barrier
    s_waitcnt vmcnt(0)
    s_mov_b64 exec, 1
    buffer_store_dword v7, v7, s[20:23], s43 offen sc1
    s_mov_b64 exec, -1
    s_endpgm
hh_k2_slowo:
    s_mov_b32 s48, 0
hh_k2_spino:
    buffer_load_dword v87, v104, s[20:23], s41 offen sc1
    s_add_u32 s48, s48, 1
    s_waitcnt vmcnt(0)
    v_cmp_eq_u32 vcc, -1, v87
    s_cmp_ge_u32 s48, 0x1000
    s_cbranch_scc1 hh_k2_backo
    s_cbranch_vccnz hh_k2_spino
    s_branch hh_k2_backo
hh_k2_slowx:
    s_mov_b32 s48, 0
hh_k2_spinx:
    s_sleep 2
    buffer_load_dwordx4 v[96:99], v3, s[20:23], s45 offen sc1
    buffer_load_dwordx4 v[100:103], v3, s[20:23], s45 offen offset:1024 sc1
    s_add_u32 s48, s48, 1
    s_waitcnt vmcnt(0)
    v_max3_u32 v85, v96, v97, v98
    v_max3_u32 v85, v85, v99, v100
    v_max3_u32 v85, v85, v101, v102
    v_max_u32 v85, v85, v103
    v_cmp_eq_u32 vcc, -1, v85
    s_cmp_ge_u32 s48, 0x1000
    s_cbranch_scc1 hh_k2_backx
    s_cbranch_vccnz hh_k2_spinx
    s_branch hh_k2_backx
hh_k2_exit:
    s_endpgm
hh_code_end:
.section .rodata,"a"
.p2align 6
.amdhsa_kernel hh_k1_kernel
  .amdhsa_next_free_vgpr 248
  .amdhsa_next_free_sgpr 102
  .amdhsa_accum_offset 248
  .amdhsa_group_segment_fixed_size 0
  .amdhsa_kernarg_size 80
  .amdhsa_user_sgpr_count 2
  .amdhsa_user_sgpr_kernarg_segment_ptr 1
  .amdhsa_system_sgpr_workgroup_id_x 1
.end_amdhsa_kernel
.p2align 6
.amdhsa_kernel hh_k2_kernel
  .amdhsa_next_free_vgpr 212
  .amdhsa_next_free_sgpr 102
  .amdhsa_accum_offset 212
  .amdhsa_group_segment_fixed_size 0
  .amdhsa_kernarg_size 80
  .amdhsa_user_sgpr_count 2
  .amdhsa_user_sgpr_kernarg_segment_ptr 1
  .amdhsa_system_sgpr_workgroup_id_x 1
.end_amdhsa_kernel
```
